```python
import torch

def _softmax(x, axis=-1):
    return torch.softmax(x, dim=axis)

def _gelu(x):
    return torch.nn.functional.gelu(x, approximate='tanh')

def _silu(x):
    return torch.nn.functional.silu(x)

def _sigmoid(x):
    return torch.sigmoid(x)

def _layernorm(x, axis=-1, eps=1e-05):
    m = x.mean(dim=axis, keepdim=True)
    v = x.var(dim=axis, keepdim=True, unbiased=False)
    return (x - m) / torch.sqrt(v + eps)

def _scatter_add(tgt, idx, src, axis=0):
    return tgt.clone().index_add_(axis, idx, src)

def _segment_sum(src, seg, n):
    out = torch.zeros((n,) + src.shape[1:], dtype=src.dtype)
    return out.index_add_(0, seg, src)

def _pad(x, pw):
    flat = tuple((v for pair in reversed(pw) for v in pair))
    return torch.nn.functional.pad(x, flat)
kernel_name = 'gated_mix__memory_aug_recurrent_mem_tr__sliding_block__prompt'

def setup_inputs():

    _w = lambda a: (lambda t: t.to(torch.bfloat16) if t.is_floating_point() else t)(torch.as_tensor(a))

    def _A_setup():
        B, S, Dm = (1, 2048, 640)
        H, Dh = (32, 128)
        M, seg = (8, 32)
        seg = min(seg, S)
        S = S // seg * seg
        return {'x': _w((lambda *s: torch.randn(*s, dtype=torch.bfloat16) * 0.05)(B, S, Dm)), 'mem0': _w((lambda *s: torch.randn(*s, dtype=torch.bfloat16) * 1.6)(B, M, Dm)), 'Wq': _w((lambda *s: torch.randn(*s, dtype=torch.bfloat16) * 0.8)(Dm, H, Dh) * Dm ** (-0.5)), 'Wk': _w((lambda *s: torch.randn(*s, dtype=torch.bfloat16) * 0.8)(Dm, H, Dh) * Dm ** (-0.5)), 'Wv': _w((lambda *s: torch.randn(*s, dtype=torch.bfloat16) * 1.6)(Dm, H, Dh) * Dm ** (-0.5)), 'Wo': _w((lambda *s: torch.randn(*s, dtype=torch.bfloat16) * 1.6)(H, Dh, Dm) * (H * Dh) ** (-0.5)), 'seg_len': seg}
    _A_in = _A_setup()

    def _B_setup():
        B, S, D = (1, 2048, 640)
        return {'x': _w((lambda *s: torch.randn(*s, dtype=torch.bfloat16) * 0.05)(B, S, D)), 'wqkv': _w((lambda *s: torch.randn(*s, dtype=torch.bfloat16) * 0.8)(D, 3 * D)), 'wo': _w((lambda *s: torch.randn(*s, dtype=torch.bfloat16) * 0.05)(D, D))}
    _B_in = _B_setup()
    return {'A_x': _A_in['x'], 'A_mem0': _A_in['mem0'], 'A_Wq': _A_in['Wq'], 'A_Wk': _A_in['Wk'], 'A_Wv': _A_in['Wv'], 'A_Wo': _A_in['Wo'], 'A_seg_len': _A_in['seg_len'], 'B_x': _B_in['x'], 'B_wqkv': _B_in['wqkv'], 'B_wo': _B_in['wo'], 'gate_w': _w((lambda *s: torch.randn(*s, dtype=torch.bfloat16) * 0.05)(640) * 16.0)}

def reference(A_x, A_mem0, A_Wq, A_Wk, A_Wv, A_Wo, A_seg_len, B_x, B_wqkv, B_wo, gate_w):

    def _A_ref(x, mem0, Wq, Wk, Wv, Wo, seg_len):
        B, S, Dm = x.shape
        H, Dh = (Wq.shape[1], Wq.shape[2])
        M = mem0.shape[1]
        scale = Dh ** (-0.5)
        n_seg = S // seg_len
        L = M + seg_len
        idx = torch.arange(L)
        mask = (idx[:, None] < M) | (idx[:, None] >= idx[None, :])
        mem = mem0
        outs = []
        for s in range(n_seg):
            xs = x[:, s * seg_len:(s + 1) * seg_len, :].clone()
            h = torch.concatenate([mem, xs], axis=1)
            q = torch.einsum('btd,dhe->bhte', h, Wq)
            k = torch.einsum('btd,dhe->bhte', h, Wk)
            v = torch.einsum('btd,dhe->bhte', h, Wv)
            scores = torch.einsum('bhqe,bhke->bhqk', q, k) * scale
            scores = torch.where(mask[None, None], scores, -1000000000.0)
            p = _softmax(scores, axis=-1)
            o = torch.einsum('bhqk,bhke->bhqe', p, v)
            o = torch.einsum('bhte,hed->btd', o, Wo)
            mem = o[:, :M, :].clone()
            outs.append(o[:, M:, :])
        return torch.concatenate(outs, axis=1)

    def _B_ref(x, wqkv, wo):
        B, S, D = x.shape
        H = 32
        Dh = D // H
        W = 256
        qkv = (lambda x, *d: x.permute(*d))((x @ wqkv).reshape(B, S, 3, H, Dh), 2, 0, 3, 1, 4)
        q, k, v = (qkv[0], qkv[1], qkv[2])
        scores = torch.einsum('bhqd,bhkd->bhqk', q, k) * Dh ** (-0.5)
        idx = torch.arange(S)
        mask = (idx[:, None] - idx[None, :] >= 0) & (idx[:, None] - idx[None, :] < W)
        scores = torch.where(mask[None, None], scores, -1000000000.0)
        p = _softmax(scores, axis=-1)
        o = torch.einsum('bhqk,bhkd->bhqd', p, v)
        return (lambda x, *d: x.permute(*d))(o, 0, 2, 1, 3).reshape(B, S, D) @ wo
    x = A_x
    g = _sigmoid((x * gate_w).sum(-1, keepdims=True))
    a = _A_ref(x, A_mem0, A_Wq, A_Wk, A_Wv, A_Wo, A_seg_len)
    b = _B_ref(x, B_wqkv, B_wo)
    return g * a + (1 - g) * b
```

```asm
; @launch grid=(256,1,1) block=(256,1,1) lds=163840
.amdgcn_target "amdgcn-amd-amdhsa--gfx950"
.text
.globl gated_mix__memory_aug_recurrent_mem_tr__sliding_block__prompt_kernel
.p2align 8
.type gated_mix__memory_aug_recurrent_mem_tr__sliding_block__prompt_kernel,@function
gated_mix__memory_aug_recurrent_mem_tr__sliding_block__prompt_kernel:
  s_cmp_ge_u32 s2, 256
  s_cbranch_scc1 K_end
  s_load_dwordx2 s[4:5], s[0:1], 104
  s_mov_b32 s6, 268435456
  s_mov_b32 s7, 0x20000
  s_load_dwordx2 s[24:25], s[0:1], 96
  s_mov_b32 s26, 256
  s_mov_b32 s27, 0x20000
  v_lshrrev_b32 v1, 6, v0
  v_and_b32 v0, 63, v0
  v_readfirstlane_b32 s32, v1
  s_getreg_b32 s33, hwreg(HW_REG_XCC_ID, 0, 4)
  s_and_b32 s33, s33, 7
  s_waitcnt lgkmcnt(0)
  s_mov_b32 s56, 30000000
  s_cmp_eq_u32 s32, 0
  s_cbranch_scc0 K_noticket
  s_memrealtime s[60:61]
  s_lshl_b32 s62, s33, 5
  v_mov_b32 v2, 1
  v_mov_b32 v3, s62
  s_mov_b64 exec, 1
  buffer_atomic_add v2, v3, s[24:27], 0 offen sc0
  s_waitcnt lgkmcnt(0)
  s_and_b32 s60, s60, 0x7fffff
  s_add_u32 s60, s60, 1
  s_lshl_b32 s60, s60, 8
  v_mov_b32 v4, s60
  v_mov_b32 v5, 0
  v_mov_b32 v6, 112
  buffer_atomic_cmpswap v[4:5], v6, s[24:27], 0 offen sc0
  s_waitcnt vmcnt(0)
  s_nop 0
  v_mov_b32 v5, s60
  v_cmp_eq_u32 vcc, 0, v4
  s_nop 1
  v_cndmask_b32 v3, v4, v5, vcc
  v_mov_b32 v6, 163584
  ds_write_b64 v6, v[2:3]
  s_waitcnt lgkmcnt(0)
  s_mov_b64 exec, -1
K_noticket:
  s_barrier
  v_mov_b32 v6, 163584
  ds_read_b64 v[2:3], v6
  s_waitcnt lgkmcnt(0)
  v_readfirstlane_b32 s34, v2
  v_readfirstlane_b32 s3, v3
  s_barrier
  s_cmp_lt_u32 s34, 32
  s_cbranch_scc1 K_role
  s_mov_b32 s59, 0
  v_lshlrev_b32 v3, 5, v0
K_ov_w:
  s_mov_b64 exec, 0xff
  buffer_load_dword v2, v3, s[24:27], 0 offen sc1
  s_waitcnt vmcnt(0)
  s_mov_b64 exec, -1
  s_mov_b32 s60, 0
  v_readlane_b32 s64, v2, 0
  v_readlane_b32 s65, v2, 1
  v_readlane_b32 s66, v2, 2
  v_readlane_b32 s67, v2, 3
  v_readlane_b32 s68, v2, 4
  v_readlane_b32 s69, v2, 5
  v_readlane_b32 s70, v2, 6
  v_readlane_b32 s71, v2, 7
  s_add_u32 s60, s60, s64
  s_add_u32 s60, s60, s65
  s_add_u32 s60, s60, s66
  s_add_u32 s60, s60, s67
  s_add_u32 s60, s60, s68
  s_add_u32 s60, s60, s69
  s_add_u32 s60, s60, s70
  s_add_u32 s60, s60, s71
  s_cmp_ge_u32 s60, 256
  s_cbranch_scc1 K_ov_d
  s_mov_b64 exec, 0xff
  s_mov_b64 exec, -1
  s_sleep 4
  s_add_u32 s59, s59, 4
  s_cmp_lt_u32 s59, s56
  s_cbranch_scc1 K_ov_w
  s_endpgm
K_ov_d:
  s_cmp_eq_u32 s32, 0
  s_cbranch_scc0 K_ov_nt
  v_mov_b32 v2, 1
  v_mov_b32 v3, 80
  s_mov_b64 exec, 1
  buffer_atomic_add v2, v3, s[24:27], 0 offen sc0
  s_waitcnt vmcnt(0)
  v_mov_b32 v3, 163584
  ds_write_b32 v3, v2
  s_waitcnt lgkmcnt(0)
  s_mov_b64 exec, -1
K_ov_nt:
  s_barrier
  v_mov_b32 v3, 163584
  ds_read_b32 v2, v3
  s_waitcnt lgkmcnt(0)
  v_readfirstlane_b32 s61, v2
  s_barrier
  s_min_u32 s62, s64, 32
  s_sub_u32 s63, 32, s62
  s_cmp_lt_u32 s61, s63
  s_cbranch_scc0 K_ov_n0
  s_mov_b32 s33, 0
  s_add_u32 s34, s62, s61
  s_branch K_role
K_ov_n0:
  s_sub_u32 s61, s61, s63
  s_min_u32 s62, s65, 32
  s_sub_u32 s63, 32, s62
  s_cmp_lt_u32 s61, s63
  s_cbranch_scc0 K_ov_n1
  s_mov_b32 s33, 1
  s_add_u32 s34, s62, s61
  s_branch K_role
K_ov_n1:
  s_sub_u32 s61, s61, s63
  s_min_u32 s62, s66, 32
  s_sub_u32 s63, 32, s62
  s_cmp_lt_u32 s61, s63
  s_cbranch_scc0 K_ov_n2
  s_mov_b32 s33, 2
  s_add_u32 s34, s62, s61
  s_branch K_role
K_ov_n2:
  s_sub_u32 s61, s61, s63
  s_min_u32 s62, s67, 32
  s_sub_u32 s63, 32, s62
  s_cmp_lt_u32 s61, s63
  s_cbranch_scc0 K_ov_n3
  s_mov_b32 s33, 3
  s_add_u32 s34, s62, s61
  s_branch K_role
K_ov_n3:
  s_sub_u32 s61, s61, s63
  s_min_u32 s62, s68, 32
  s_sub_u32 s63, 32, s62
  s_cmp_lt_u32 s61, s63
  s_cbranch_scc0 K_ov_n4
  s_mov_b32 s33, 4
  s_add_u32 s34, s62, s61
  s_branch K_role
K_ov_n4:
  s_sub_u32 s61, s61, s63
  s_min_u32 s62, s69, 32
  s_sub_u32 s63, 32, s62
  s_cmp_lt_u32 s61, s63
  s_cbranch_scc0 K_ov_n5
  s_mov_b32 s33, 5
  s_add_u32 s34, s62, s61
  s_branch K_role
K_ov_n5:
  s_sub_u32 s61, s61, s63
  s_min_u32 s62, s70, 32
  s_sub_u32 s63, 32, s62
  s_cmp_lt_u32 s61, s63
  s_cbranch_scc0 K_ov_n6
  s_mov_b32 s33, 6
  s_add_u32 s34, s62, s61
  s_branch K_role
K_ov_n6:
  s_sub_u32 s61, s61, s63
  s_min_u32 s62, s71, 32
  s_sub_u32 s63, 32, s62
  s_cmp_lt_u32 s61, s63
  s_cbranch_scc0 K_ov_n7
  s_mov_b32 s33, 7
  s_add_u32 s34, s62, s61
  s_branch K_role
K_ov_n7:
  s_sub_u32 s61, s61, s63
  s_endpgm
K_role:
  s_cmp_lt_u32 s33, 4
  s_cbranch_scc0 K_big
  s_cmp_lt_u32 s34, 16
  s_cbranch_scc1 K_chain
  s_lshl_b32 s97, s33, 4
  s_add_u32 s97, s97, s34
  s_sub_u32 s97, s97, 16
  s_cmp_eq_u32 s97, 0
  s_cbranch_scc0 K_b_nocls
  s_cmp_eq_u32 s32, 0
  s_cbranch_scc0 K_cal_e
  s_mov_b32 s62, -1
  s_mov_b32 s63, -1
  v_mov_b32 v2, 0
  s_mov_b64 exec, 1
  v_mov_b32 v3, 786432
  s_memtime s[64:65]
  s_waitcnt lgkmcnt(0)
  buffer_store_dword v2, v3, s[4:7], 0 offen sc1
  s_waitcnt vmcnt(0)
  s_memtime s[66:67]
  s_waitcnt lgkmcnt(0)
  s_sub_u32 s66, s66, s64
  s_min_u32 s62, s62, s66
  v_mov_b32 v3, 794624
  s_memtime s[64:65]
  s_waitcnt lgkmcnt(0)
  buffer_store_dword v2, v3, s[4:7], 0 offen sc1
  s_waitcnt vmcnt(0)
  s_memtime s[66:67]
  s_waitcnt lgkmcnt(0)
  s_sub_u32 s66, s66, s64
  s_min_u32 s63, s63, s66
  v_mov_b32 v3, 802816
  s_memtime s[64:65]
  s_waitcnt lgkmcnt(0)
  buffer_store_dword v2, v3, s[4:7], 0 offen sc1
  s_waitcnt vmcnt(0)
  s_memtime s[66:67]
  s_waitcnt lgkmcnt(0)
  s_sub_u32 s66, s66, s64
  s_min_u32 s62, s62, s66
  v_mov_b32 v3, 811008
  s_memtime s[64:65]
  s_waitcnt lgkmcnt(0)
  buffer_store_dword v2, v3, s[4:7], 0 offen sc1
  s_waitcnt vmcnt(0)
  s_memtime s[66:67]
  s_waitcnt lgkmcnt(0)
  s_sub_u32 s66, s66, s64
  s_min_u32 s63, s63, s66
  v_mov_b32 v3, 819200
  s_memtime s[64:65]
  s_waitcnt lgkmcnt(0)
  buffer_store_dword v2, v3, s[4:7], 0 offen sc1
  s_waitcnt vmcnt(0)
  s_memtime s[66:67]
  s_waitcnt lgkmcnt(0)
  s_sub_u32 s66, s66, s64
  s_min_u32 s62, s62, s66
  v_mov_b32 v3, 827392
  s_memtime s[64:65]
  s_waitcnt lgkmcnt(0)
  buffer_store_dword v2, v3, s[4:7], 0 offen sc1
  s_waitcnt vmcnt(0)
  s_memtime s[66:67]
  s_waitcnt lgkmcnt(0)
  s_sub_u32 s66, s66, s64
  s_min_u32 s63, s63, s66
  v_mov_b32 v3, 835584
  s_memtime s[64:65]
  s_waitcnt lgkmcnt(0)
  buffer_store_dword v2, v3, s[4:7], 0 offen sc1
  s_waitcnt vmcnt(0)
  s_memtime s[66:67]
  s_waitcnt lgkmcnt(0)
  s_sub_u32 s66, s66, s64
  s_min_u32 s62, s62, s66
  v_mov_b32 v3, 843776
  s_memtime s[64:65]
  s_waitcnt lgkmcnt(0)
  buffer_store_dword v2, v3, s[4:7], 0 offen sc1
  s_waitcnt vmcnt(0)
  s_memtime s[66:67]
  s_waitcnt lgkmcnt(0)
  s_sub_u32 s66, s66, s64
  s_min_u32 s63, s63, s66
  v_mov_b32 v3, 851968
  s_memtime s[64:65]
  s_waitcnt lgkmcnt(0)
  buffer_store_dword v2, v3, s[4:7], 0 offen sc1
  s_waitcnt vmcnt(0)
  s_memtime s[66:67]
  s_waitcnt lgkmcnt(0)
  s_sub_u32 s66, s66, s64
  s_min_u32 s62, s62, s66
  v_mov_b32 v3, 860160
  s_memtime s[64:65]
  s_waitcnt lgkmcnt(0)
  buffer_store_dword v2, v3, s[4:7], 0 offen sc1
  s_waitcnt vmcnt(0)
  s_memtime s[66:67]
  s_waitcnt lgkmcnt(0)
  s_sub_u32 s66, s66, s64
  s_min_u32 s63, s63, s66
  s_cmp_lt_u32 s63, s62
  s_cselect_b32 s63, 2, 1
  s_mov_b32 s62, 1904640
  s_mov_b64 exec, -1
  v_mov_b32 v2, s63
  v_add_u32 v2, s3, v2
  v_mov_b32 v3, 0
  s_mov_b64 exec, 1
  buffer_store_dword v2, v3, s[4:7], s62 offen sc1
  s_mov_b64 exec, -1
K_cal_e:
K_b_nocls:
  s_lshr_b32 s70, s97, 3
  s_and_b32 s71, s97, 7
  s_load_dwordx2 s[8:9], s[0:1], 64
  s_mov_b32 s10, 2457600
  s_mov_b32 s11, 0x20000
  s_load_dwordx2 s[12:13], s[0:1], 0
  s_mov_b32 s14, 2621440
  s_mov_b32 s15, 0x20000
  s_mov_b32 s40, 3840
  s_lshl_b32 s41, s70, 9
  s_mul_i32 s46, s71, 327680
  s_mov_b32 s47, 8
  s_cmp_eq_u32 s70, 7
  s_cselect_b32 s53, 2, 4
  s_lshl_b32 s62, s70, 3
  s_add_u32 s62, s62, s71
  s_lshl_b32 s62, s62, 7
  s_add_u32 s52, s62, 1859584
  s_cmp_lt_u32 s70, 5
  s_cbranch_scc0 P3_v
  s_mov_b32 s45, 0
  s_mov_b32 s42, 4
  s_mov_b32 s43, 16
  s_mov_b32 s44, 8
  s_mov_b32 s50, 2560
  s_mov_b32 s51, 64
  s_mul_i32 s48, s71, 655360
  s_lshl_b32 s62, s70, 9
  s_add_u32 s48, s48, s62
  s_lshl_b32 s62, s32, 7
  s_add_u32 s48, s48, s62
  s_add_u32 s48, s48, 83886080
  s_mov_b32 s49, 81920
  s_branch P3_e
P3_v:
  s_mov_b32 s45, 1
  s_mov_b32 s42, 8
  s_mov_b32 s43, 16
  s_mov_b32 s44, 4
  s_mov_b32 s50, 4096
  s_mov_b32 s51, 131072
  s_sub_u32 s62, s70, 5
  s_lshl_b32 s62, s62, 8
  s_lshl_b32 s63, s32, 6
  s_add_u32 s62, s62, s63
  s_lshl_b32 s48, s62, 12
  s_lshl_b32 s62, s71, 9
  s_add_u32 s48, s48, s62
  s_add_u32 s48, s48, 90177536
  s_mov_b32 s49, 64
P3_e:
  s_waitcnt lgkmcnt(0)
  s_mov_b32 s96, 1
  s_branch K_wsg
K_b_after_p3:
  s_mov_b32 s40, s97
  s_mov_b32 s52, 0x3ea52b5c
  v_mov_b32 v5, 0xf149f2ca
  s_lshr_b32 s60, s40, 3
  s_max_u32 s61, s60, 1
  s_sub_u32 s61, s61, 1
  v_and_b32 v6, 7, v0
  v_lshlrev_b32 v6, 10, v6
  v_mov_b32 v7, s60
  v_mov_b32 v8, s61
  v_cmp_gt_u32 vcc, 8, v0
  s_nop 1
  v_cndmask_b32 v7, v7, v8, vcc
  v_lshl_add_u32 v6, v7, 7, v6
  v_add_u32 v6, 1859584, v6
  s_mov_b32 s62, 8
  s_add_u32 s62, s62, s3
  s_mov_b32 s59, 0
  s_mov_b64 exec, 0xffff
BA_p3_w:
  buffer_load_dword v7, v6, s[4:7], 0 offen sc1
  s_waitcnt vmcnt(0)
  v_subrev_u32 v7, s62, v7
  v_cmp_lt_u32 vcc, 0x7f, v7
  s_cbranch_vccz BA_p3_d
  s_sleep 2
  s_add_u32 s59, s59, 4
  s_cmp_lt_u32 s59, s56
  s_cbranch_scc1 BA_p3_w
  s_mov_b32 s56, 0
BA_p3_d:
  s_mov_b64 exec, -1
  v_and_b32 v6, 31, v0
  v_lshrrev_b32 v7, 5, v0
  v_bfe_u32 v9, v6, 4, 1
  v_lshlrev_b32 v8, 4, v9
  v_bfe_u32 v9, v6, 2, 1
  v_lshl_add_u32 v8, v9, 3, v8
  v_bfe_u32 v9, v6, 3, 1
  v_lshl_add_u32 v8, v9, 2, v8
  v_and_b32 v9, 3, v6
  v_add_u32 v8, v8, v9
  v_mul_u32_u24 v2, 2560, v8
  v_lshl_add_u32 v2, v7, 4, v2
  v_mul_u32_u24 v3, 2560, v6
  v_lshl_add_u32 v3, v7, 4, v3
  v_mul_u32_u24 v14, 2560, v8
  v_mul_u32_u24 v15, 2560, v6
  v_lshlrev_b32 v4, 12, v6
  v_lshl_add_u32 v4, v7, 4, v4
  v_lshlrev_b32 v8, 3, v7
  v_sub_u32 v8, v6, v8
  v_cmp_le_i32 s[64:65], 0, v8
  v_cmp_le_i32 s[66:67], 1, v8
  v_cmp_le_i32 s[68:69], 2, v8
  v_cmp_le_i32 s[70:71], 3, v8
  v_cmp_le_i32 s[72:73], 4, v8
  v_cmp_le_i32 s[74:75], 5, v8
  v_cmp_le_i32 s[76:77], 6, v8
  v_cmp_le_i32 s[78:79], 7, v8
  v_cmp_le_i32 s[80:81], 16, v8
  v_cmp_le_i32 s[82:83], 17, v8
  v_cmp_le_i32 s[84:85], 18, v8
  v_cmp_le_i32 s[86:87], 19, v8
  v_cmp_le_i32 s[88:89], 20, v8
  v_cmp_le_i32 s[90:91], 21, v8
  v_cmp_le_i32 s[92:93], 22, v8
  v_cmp_le_i32 s[94:95], 23, v8
  s_lshl_b32 s60, s40, 5
  s_add_i32 s60, s60, -256
  s_max_i32 s43, s60, 0
  s_lshl_b32 s60, s40, 5
  s_add_i32 s60, s60, -224
  s_max_i32 s44, s60, 0
  s_lshl_b32 s60, s40, 5
  s_add_i32 s60, s60, -192
  s_max_i32 s45, s60, 0
  s_lshl_b32 s60, s40, 5
  s_add_i32 s60, s60, -160
  s_max_i32 s46, s60, 0
  s_lshl_b32 s60, s40, 5
  s_add_i32 s60, s60, -128
  s_max_i32 s47, s60, 0
  s_lshl_b32 s60, s40, 5
  s_add_i32 s60, s60, -96
  s_max_i32 s48, s60, 0
  s_lshl_b32 s60, s40, 5
  s_add_i32 s60, s60, -64
  s_max_i32 s49, s60, 0
  s_lshl_b32 s60, s40, 5
  s_add_i32 s60, s60, -32
  s_max_i32 s50, s60, 0
  s_lshl_b32 s60, s40, 5
  s_add_i32 s60, s60, 0
  s_max_i32 s51, s60, 0
  s_sub_i32 s60, 8, s40
  s_max_i32 s96, s60, 0
  s_lshl_b32 s41, s32, 3
  s_mov_b32 s42, 0
BA_item:
  s_mul_i32 s60, s40, 81920
  s_mul_i32 s61, s41, 40
  s_add_u32 s60, s60, s61
  s_add_u32 s60, s60, 83886080
  buffer_load_dwordx4 v[232:235], v3, s[4:7], s60 offen
  buffer_load_dwordx2 v[236:237], v15, s[4:7], s60 offen offset:32
  s_add_u32 s61, s61, 83887360
  s_mul_i32 s62, s43, 2560
  s_add_u32 s62, s62, s61
  buffer_load_dwordx4 v[240:243], v2, s[4:7], s62 offen
  s_mul_i32 s62, s43, 2560
  s_add_u32 s62, s62, s61
  buffer_load_dwordx2 v[244:245], v14, s[4:7], s62 offen offset:32
  s_mul_i32 s62, s44, 2560
  s_add_u32 s62, s62, s61
  buffer_load_dwordx4 v[248:251], v2, s[4:7], s62 offen
  s_mul_i32 s62, s44, 2560
  s_add_u32 s62, s62, s61
  buffer_load_dwordx2 v[252:253], v14, s[4:7], s62 offen offset:32
  s_waitcnt vmcnt(4)
  s_mov_b32 exec_lo, 0
  v_mov_b32 v236, 0
  v_mov_b32 v237, 0
  s_mov_b64 exec, -1
  s_waitcnt vmcnt(3)
  v_mfma_f32_32x32x16_bf16 v[16:31], v[240:243], v[232:235], 0
  s_nop 1
  s_mul_i32 s62, s45, 2560
  s_add_u32 s62, s62, s61
  buffer_load_dwordx4 v[240:243], v2, s[4:7], s62 offen
  s_waitcnt vmcnt(3)
  v_mfma_f32_32x32x8_bf16 v[16:31], v[244:245], v[236:237], v[16:31]
  s_nop 1
  s_mul_i32 s62, s45, 2560
  s_add_u32 s62, s62, s61
  buffer_load_dwordx2 v[244:245], v14, s[4:7], s62 offen offset:32
  s_waitcnt vmcnt(3)
  v_mfma_f32_32x32x16_bf16 v[32:47], v[248:251], v[232:235], 0
  s_nop 1
  s_mul_i32 s62, s46, 2560
  s_add_u32 s62, s62, s61
  buffer_load_dwordx4 v[248:251], v2, s[4:7], s62 offen
  s_waitcnt vmcnt(3)
  v_mfma_f32_32x32x8_bf16 v[32:47], v[252:253], v[236:237], v[32:47]
  s_nop 1
  s_mul_i32 s62, s46, 2560
  s_add_u32 s62, s62, s61
  buffer_load_dwordx2 v[252:253], v14, s[4:7], s62 offen offset:32
  s_waitcnt vmcnt(3)
  v_mfma_f32_32x32x16_bf16 v[48:63], v[240:243], v[232:235], 0
  s_nop 1
  s_mul_i32 s62, s47, 2560
  s_add_u32 s62, s62, s61
  buffer_load_dwordx4 v[240:243], v2, s[4:7], s62 offen
  s_waitcnt vmcnt(3)
  v_mfma_f32_32x32x8_bf16 v[48:63], v[244:245], v[236:237], v[48:63]
  s_nop 1
  s_mul_i32 s62, s47, 2560
  s_add_u32 s62, s62, s61
  buffer_load_dwordx2 v[244:245], v14, s[4:7], s62 offen offset:32
  s_waitcnt vmcnt(3)
  v_mfma_f32_32x32x16_bf16 v[64:79], v[248:251], v[232:235], 0
  s_nop 1
  s_mul_i32 s62, s48, 2560
  s_add_u32 s62, s62, s61
  buffer_load_dwordx4 v[248:251], v2, s[4:7], s62 offen
  s_waitcnt vmcnt(3)
  v_mfma_f32_32x32x8_bf16 v[64:79], v[252:253], v[236:237], v[64:79]
  s_nop 1
  s_mul_i32 s62, s48, 2560
  s_add_u32 s62, s62, s61
  buffer_load_dwordx2 v[252:253], v14, s[4:7], s62 offen offset:32
  s_waitcnt vmcnt(3)
  v_mfma_f32_32x32x16_bf16 v[80:95], v[240:243], v[232:235], 0
  s_nop 1
  s_mul_i32 s62, s49, 2560
  s_add_u32 s62, s62, s61
  buffer_load_dwordx4 v[240:243], v2, s[4:7], s62 offen
  s_waitcnt vmcnt(3)
  v_mfma_f32_32x32x8_bf16 v[80:95], v[244:245], v[236:237], v[80:95]
  s_nop 1
  s_mul_i32 s62, s49, 2560
  s_add_u32 s62, s62, s61
  buffer_load_dwordx2 v[244:245], v14, s[4:7], s62 offen offset:32
  s_waitcnt vmcnt(3)
  v_mfma_f32_32x32x16_bf16 v[96:111], v[248:251], v[232:235], 0
  s_nop 1
  s_mul_i32 s62, s50, 2560
  s_add_u32 s62, s62, s61
  buffer_load_dwordx4 v[248:251], v2, s[4:7], s62 offen
  s_waitcnt vmcnt(3)
  v_mfma_f32_32x32x8_bf16 v[96:111], v[252:253], v[236:237], v[96:111]
  s_nop 1
  s_mul_i32 s62, s50, 2560
  s_add_u32 s62, s62, s61
  buffer_load_dwordx2 v[252:253], v14, s[4:7], s62 offen offset:32
  s_waitcnt vmcnt(3)
  v_mfma_f32_32x32x16_bf16 v[112:127], v[240:243], v[232:235], 0
  s_nop 1
  s_mul_i32 s62, s51, 2560
  s_add_u32 s62, s62, s61
  buffer_load_dwordx4 v[240:243], v2, s[4:7], s62 offen
  s_waitcnt vmcnt(3)
  v_mfma_f32_32x32x8_bf16 v[112:127], v[244:245], v[236:237], v[112:127]
  s_nop 1
  s_mul_i32 s62, s51, 2560
  s_add_u32 s62, s62, s61
  buffer_load_dwordx2 v[244:245], v14, s[4:7], s62 offen offset:32
  s_waitcnt vmcnt(3)
  v_mfma_f32_32x32x16_bf16 v[128:143], v[248:251], v[232:235], 0
  s_waitcnt vmcnt(2)
  v_mfma_f32_32x32x8_bf16 v[128:143], v[252:253], v[236:237], v[128:143]
  s_waitcnt vmcnt(1)
  v_mfma_f32_32x32x16_bf16 v[144:159], v[240:243], v[232:235], 0
  s_waitcnt vmcnt(0)
  v_mfma_f32_32x32x8_bf16 v[144:159], v[244:245], v[236:237], v[144:159]
  s_mul_i32 s61, s41, 81920
  s_add_u32 s61, s61, 90177536
  s_lshl_b32 s62, s43, 1
  s_add_u32 s62, s62, s61
  buffer_load_dwordx4 v[160:163], v4, s[4:7], s62 offen offset:0
  s_lshl_b32 s62, s43, 1
  s_add_u32 s62, s62, s61
  buffer_load_dwordx4 v[164:167], v4, s[4:7], s62 offen offset:32
  s_lshl_b32 s62, s44, 1
  s_add_u32 s62, s62, s61
  buffer_load_dwordx4 v[168:171], v4, s[4:7], s62 offen offset:0
  s_lshl_b32 s62, s44, 1
  s_add_u32 s62, s62, s61
  buffer_load_dwordx4 v[172:175], v4, s[4:7], s62 offen offset:32
  s_lshl_b32 s62, s45, 1
  s_add_u32 s62, s62, s61
  buffer_load_dwordx4 v[176:179], v4, s[4:7], s62 offen offset:0
  s_lshl_b32 s62, s45, 1
  s_add_u32 s62, s62, s61
  buffer_load_dwordx4 v[180:183], v4, s[4:7], s62 offen offset:32
  s_lshl_b32 s62, s46, 1
  s_add_u32 s62, s62, s61
  buffer_load_dwordx4 v[184:187], v4, s[4:7], s62 offen offset:0
  s_lshl_b32 s62, s46, 1
  s_add_u32 s62, s62, s61
  buffer_load_dwordx4 v[188:191], v4, s[4:7], s62 offen offset:32
  s_lshl_b32 s62, s47, 1
  s_add_u32 s62, s62, s61
  buffer_load_dwordx4 v[192:195], v4, s[4:7], s62 offen offset:0
  s_lshl_b32 s62, s47, 1
  s_add_u32 s62, s62, s61
  buffer_load_dwordx4 v[196:199], v4, s[4:7], s62 offen offset:32
  s_lshl_b32 s62, s48, 1
  s_add_u32 s62, s62, s61
  buffer_load_dwordx4 v[200:203], v4, s[4:7], s62 offen offset:0
  s_lshl_b32 s62, s48, 1
  s_add_u32 s62, s62, s61
  buffer_load_dwordx4 v[204:207], v4, s[4:7], s62 offen offset:32
  s_lshl_b32 s62, s49, 1
  s_add_u32 s62, s62, s61
  buffer_load_dwordx4 v[208:211], v4, s[4:7], s62 offen offset:0
  s_lshl_b32 s62, s49, 1
  s_add_u32 s62, s62, s61
  buffer_load_dwordx4 v[212:215], v4, s[4:7], s62 offen offset:32
  s_lshl_b32 s62, s50, 1
  s_add_u32 s62, s62, s61
  buffer_load_dwordx4 v[216:219], v4, s[4:7], s62 offen offset:0
  s_lshl_b32 s62, s50, 1
  s_add_u32 s62, s62, s61
  buffer_load_dwordx4 v[220:223], v4, s[4:7], s62 offen offset:32
  s_lshl_b32 s62, s51, 1
  s_add_u32 s62, s62, s61
  buffer_load_dwordx4 v[224:227], v4, s[4:7], s62 offen offset:0
  s_lshl_b32 s62, s51, 1
  s_add_u32 s62, s62, s61
  buffer_load_dwordx4 v[228:231], v4, s[4:7], s62 offen offset:32
  s_nop 11
  v_cndmask_b32 v16, v16, v5, s[64:65]
  v_cndmask_b32 v144, v5, v144, s[64:65]
  v_cndmask_b32 v17, v17, v5, s[66:67]
  v_cndmask_b32 v145, v5, v145, s[66:67]
  v_cndmask_b32 v18, v18, v5, s[68:69]
  v_cndmask_b32 v146, v5, v146, s[68:69]
  v_cndmask_b32 v19, v19, v5, s[70:71]
  v_cndmask_b32 v147, v5, v147, s[70:71]
  v_cndmask_b32 v20, v20, v5, s[72:73]
  v_cndmask_b32 v148, v5, v148, s[72:73]
  v_cndmask_b32 v21, v21, v5, s[74:75]
  v_cndmask_b32 v149, v5, v149, s[74:75]
  v_cndmask_b32 v22, v22, v5, s[76:77]
  v_cndmask_b32 v150, v5, v150, s[76:77]
  v_cndmask_b32 v23, v23, v5, s[78:79]
  v_cndmask_b32 v151, v5, v151, s[78:79]
  v_cndmask_b32 v24, v24, v5, s[80:81]
  v_cndmask_b32 v152, v5, v152, s[80:81]
  v_cndmask_b32 v25, v25, v5, s[82:83]
  v_cndmask_b32 v153, v5, v153, s[82:83]
  v_cndmask_b32 v26, v26, v5, s[84:85]
  v_cndmask_b32 v154, v5, v154, s[84:85]
  v_cndmask_b32 v27, v27, v5, s[86:87]
  v_cndmask_b32 v155, v5, v155, s[86:87]
  v_cndmask_b32 v28, v28, v5, s[88:89]
  v_cndmask_b32 v156, v5, v156, s[88:89]
  v_cndmask_b32 v29, v29, v5, s[90:91]
  v_cndmask_b32 v157, v5, v157, s[90:91]
  v_cndmask_b32 v30, v30, v5, s[92:93]
  v_cndmask_b32 v158, v5, v158, s[92:93]
  v_cndmask_b32 v31, v31, v5, s[94:95]
  v_cndmask_b32 v159, v5, v159, s[94:95]
  s_cmp_gt_u32 s96, 0
  s_cbranch_scc0 BA_v0
  v_mov_b32 v16, v5
  v_mov_b32 v17, v5
  v_mov_b32 v18, v5
  v_mov_b32 v19, v5
  v_mov_b32 v20, v5
  v_mov_b32 v21, v5
  v_mov_b32 v22, v5
  v_mov_b32 v23, v5
  v_mov_b32 v24, v5
  v_mov_b32 v25, v5
  v_mov_b32 v26, v5
  v_mov_b32 v27, v5
  v_mov_b32 v28, v5
  v_mov_b32 v29, v5
  v_mov_b32 v30, v5
  v_mov_b32 v31, v5
BA_v0:
  s_cmp_gt_u32 s96, 1
  s_cbranch_scc0 BA_v1
  v_mov_b32 v32, v5
  v_mov_b32 v33, v5
  v_mov_b32 v34, v5
  v_mov_b32 v35, v5
  v_mov_b32 v36, v5
  v_mov_b32 v37, v5
  v_mov_b32 v38, v5
  v_mov_b32 v39, v5
  v_mov_b32 v40, v5
  v_mov_b32 v41, v5
  v_mov_b32 v42, v5
  v_mov_b32 v43, v5
  v_mov_b32 v44, v5
  v_mov_b32 v45, v5
  v_mov_b32 v46, v5
  v_mov_b32 v47, v5
BA_v1:
  s_cmp_gt_u32 s96, 2
  s_cbranch_scc0 BA_v2
  v_mov_b32 v48, v5
  v_mov_b32 v49, v5
  v_mov_b32 v50, v5
  v_mov_b32 v51, v5
  v_mov_b32 v52, v5
  v_mov_b32 v53, v5
  v_mov_b32 v54, v5
  v_mov_b32 v55, v5
  v_mov_b32 v56, v5
  v_mov_b32 v57, v5
  v_mov_b32 v58, v5
  v_mov_b32 v59, v5
  v_mov_b32 v60, v5
  v_mov_b32 v61, v5
  v_mov_b32 v62, v5
  v_mov_b32 v63, v5
BA_v2:
  s_cmp_gt_u32 s96, 3
  s_cbranch_scc0 BA_v3
  v_mov_b32 v64, v5
  v_mov_b32 v65, v5
  v_mov_b32 v66, v5
  v_mov_b32 v67, v5
  v_mov_b32 v68, v5
  v_mov_b32 v69, v5
  v_mov_b32 v70, v5
  v_mov_b32 v71, v5
  v_mov_b32 v72, v5
  v_mov_b32 v73, v5
  v_mov_b32 v74, v5
  v_mov_b32 v75, v5
  v_mov_b32 v76, v5
  v_mov_b32 v77, v5
  v_mov_b32 v78, v5
  v_mov_b32 v79, v5
BA_v3:
  s_cmp_gt_u32 s96, 4
  s_cbranch_scc0 BA_v4
  v_mov_b32 v80, v5
  v_mov_b32 v81, v5
  v_mov_b32 v82, v5
  v_mov_b32 v83, v5
  v_mov_b32 v84, v5
  v_mov_b32 v85, v5
  v_mov_b32 v86, v5
  v_mov_b32 v87, v5
  v_mov_b32 v88, v5
  v_mov_b32 v89, v5
  v_mov_b32 v90, v5
  v_mov_b32 v91, v5
  v_mov_b32 v92, v5
  v_mov_b32 v93, v5
  v_mov_b32 v94, v5
  v_mov_b32 v95, v5
BA_v4:
  s_cmp_gt_u32 s96, 5
  s_cbranch_scc0 BA_v5
  v_mov_b32 v96, v5
  v_mov_b32 v97, v5
  v_mov_b32 v98, v5
  v_mov_b32 v99, v5
  v_mov_b32 v100, v5
  v_mov_b32 v101, v5
  v_mov_b32 v102, v5
  v_mov_b32 v103, v5
  v_mov_b32 v104, v5
  v_mov_b32 v105, v5
  v_mov_b32 v106, v5
  v_mov_b32 v107, v5
  v_mov_b32 v108, v5
  v_mov_b32 v109, v5
  v_mov_b32 v110, v5
  v_mov_b32 v111, v5
BA_v5:
  s_cmp_gt_u32 s96, 6
  s_cbranch_scc0 BA_v6
  v_mov_b32 v112, v5
  v_mov_b32 v113, v5
  v_mov_b32 v114, v5
  v_mov_b32 v115, v5
  v_mov_b32 v116, v5
  v_mov_b32 v117, v5
  v_mov_b32 v118, v5
  v_mov_b32 v119, v5
  v_mov_b32 v120, v5
  v_mov_b32 v121, v5
  v_mov_b32 v122, v5
  v_mov_b32 v123, v5
  v_mov_b32 v124, v5
  v_mov_b32 v125, v5
  v_mov_b32 v126, v5
  v_mov_b32 v127, v5
BA_v6:
  s_cmp_gt_u32 s96, 7
  s_cbranch_scc0 BA_v7
  v_mov_b32 v128, v5
  v_mov_b32 v129, v5
  v_mov_b32 v130, v5
  v_mov_b32 v131, v5
  v_mov_b32 v132, v5
  v_mov_b32 v133, v5
  v_mov_b32 v134, v5
  v_mov_b32 v135, v5
  v_mov_b32 v136, v5
  v_mov_b32 v137, v5
  v_mov_b32 v138, v5
  v_mov_b32 v139, v5
  v_mov_b32 v140, v5
  v_mov_b32 v141, v5
  v_mov_b32 v142, v5
  v_mov_b32 v143, v5
BA_v7:
  v_max3_f32 v6, v16, v17, v18
  v_max3_f32 v6, v6, v19, v20
  v_max3_f32 v6, v6, v21, v22
  v_max3_f32 v6, v6, v23, v24
  v_max3_f32 v6, v6, v25, v26
  v_max3_f32 v6, v6, v27, v28
  v_max3_f32 v6, v6, v29, v30
  v_max3_f32 v6, v6, v31, v32
  v_max3_f32 v6, v6, v33, v34
  v_max3_f32 v6, v6, v35, v36
  v_max3_f32 v6, v6, v37, v38
  v_max3_f32 v6, v6, v39, v40
  v_max3_f32 v6, v6, v41, v42
  v_max3_f32 v6, v6, v43, v44
  v_max3_f32 v6, v6, v45, v46
  v_max3_f32 v6, v6, v47, v48
  v_max3_f32 v6, v6, v49, v50
  v_max3_f32 v6, v6, v51, v52
  v_max3_f32 v6, v6, v53, v54
  v_max3_f32 v6, v6, v55, v56
  v_max3_f32 v6, v6, v57, v58
  v_max3_f32 v6, v6, v59, v60
  v_max3_f32 v6, v6, v61, v62
  v_max3_f32 v6, v6, v63, v64
  v_max3_f32 v6, v6, v65, v66
  v_max3_f32 v6, v6, v67, v68
  v_max3_f32 v6, v6, v69, v70
  v_max3_f32 v6, v6, v71, v72
  v_max3_f32 v6, v6, v73, v74
  v_max3_f32 v6, v6, v75, v76
  v_max3_f32 v6, v6, v77, v78
  v_max3_f32 v6, v6, v79, v80
  v_max3_f32 v6, v6, v81, v82
  v_max3_f32 v6, v6, v83, v84
  v_max3_f32 v6, v6, v85, v86
  v_max3_f32 v6, v6, v87, v88
  v_max3_f32 v6, v6, v89, v90
  v_max3_f32 v6, v6, v91, v92
  v_max3_f32 v6, v6, v93, v94
  v_max3_f32 v6, v6, v95, v96
  v_max3_f32 v6, v6, v97, v98
  v_max3_f32 v6, v6, v99, v100
  v_max3_f32 v6, v6, v101, v102
  v_max3_f32 v6, v6, v103, v104
  v_max3_f32 v6, v6, v105, v106
  v_max3_f32 v6, v6, v107, v108
  v_max3_f32 v6, v6, v109, v110
  v_max3_f32 v6, v6, v111, v112
  v_max3_f32 v6, v6, v113, v114
  v_max3_f32 v6, v6, v115, v116
  v_max3_f32 v6, v6, v117, v118
  v_max3_f32 v6, v6, v119, v120
  v_max3_f32 v6, v6, v121, v122
  v_max3_f32 v6, v6, v123, v124
  v_max3_f32 v6, v6, v125, v126
  v_max3_f32 v6, v6, v127, v128
  v_max3_f32 v6, v6, v129, v130
  v_max3_f32 v6, v6, v131, v132
  v_max3_f32 v6, v6, v133, v134
  v_max3_f32 v6, v6, v135, v136
  v_max3_f32 v6, v6, v137, v138
  v_max3_f32 v6, v6, v139, v140
  v_max3_f32 v6, v6, v141, v142
  v_max3_f32 v6, v6, v143, v144
  v_max3_f32 v6, v6, v145, v146
  v_max3_f32 v6, v6, v147, v148
  v_max3_f32 v6, v6, v149, v150
  v_max3_f32 v6, v6, v151, v152
  v_max3_f32 v6, v6, v153, v154
  v_max3_f32 v6, v6, v155, v156
  v_max3_f32 v6, v6, v157, v158
  v_max_f32 v6, v6, v159
  v_mov_b32 v7, v6
  s_nop 1
  v_permlane32_swap_b32 v6, v7
  v_max_f32 v6, v6, v7
  v_mul_f32 v6, s52, v6
  v_sub_f32 v6, 0, v6
  v_mov_b32 v7, 0
  v_pk_fma_f32 v[16:17], v[16:17], s[52:53], v[6:7] op_sel_hi:[1,0,0]
  v_pk_fma_f32 v[18:19], v[18:19], s[52:53], v[6:7] op_sel_hi:[1,0,0]
  v_pk_fma_f32 v[20:21], v[20:21], s[52:53], v[6:7] op_sel_hi:[1,0,0]
  v_pk_fma_f32 v[22:23], v[22:23], s[52:53], v[6:7] op_sel_hi:[1,0,0]
  v_pk_fma_f32 v[24:25], v[24:25], s[52:53], v[6:7] op_sel_hi:[1,0,0]
  v_pk_fma_f32 v[26:27], v[26:27], s[52:53], v[6:7] op_sel_hi:[1,0,0]
  v_pk_fma_f32 v[28:29], v[28:29], s[52:53], v[6:7] op_sel_hi:[1,0,0]
  v_pk_fma_f32 v[30:31], v[30:31], s[52:53], v[6:7] op_sel_hi:[1,0,0]
  v_exp_f32 v16, v16
  v_exp_f32 v17, v17
  v_exp_f32 v18, v18
  v_exp_f32 v19, v19
  v_exp_f32 v20, v20
  v_exp_f32 v21, v21
  v_exp_f32 v22, v22
  v_exp_f32 v23, v23
  v_exp_f32 v24, v24
  v_exp_f32 v25, v25
  v_exp_f32 v26, v26
  v_exp_f32 v27, v27
  v_exp_f32 v28, v28
  v_exp_f32 v29, v29
  v_exp_f32 v30, v30
  v_exp_f32 v31, v31
  v_cvt_pk_bf16_f32 v16, v16, v17
  v_cvt_pk_bf16_f32 v17, v18, v19
  v_cvt_pk_bf16_f32 v18, v20, v21
  v_cvt_pk_bf16_f32 v19, v22, v23
  v_cvt_pk_bf16_f32 v20, v24, v25
  v_cvt_pk_bf16_f32 v21, v26, v27
  v_cvt_pk_bf16_f32 v22, v28, v29
  v_cvt_pk_bf16_f32 v23, v30, v31
  v_lshlrev_b32 v8, 16, v16
  v_and_b32 v9, 0xffff0000, v16
  v_add_f32 v7, v7, v8
  v_add_f32 v7, v7, v9
  v_lshlrev_b32 v8, 16, v17
  v_and_b32 v9, 0xffff0000, v17
  v_add_f32 v7, v7, v8
  v_add_f32 v7, v7, v9
  v_lshlrev_b32 v8, 16, v18
  v_and_b32 v9, 0xffff0000, v18
  v_add_f32 v7, v7, v8
  v_add_f32 v7, v7, v9
  v_lshlrev_b32 v8, 16, v19
  v_and_b32 v9, 0xffff0000, v19
  v_add_f32 v7, v7, v8
  v_add_f32 v7, v7, v9
  v_lshlrev_b32 v8, 16, v20
  v_and_b32 v9, 0xffff0000, v20
  v_add_f32 v7, v7, v8
  v_add_f32 v7, v7, v9
  v_lshlrev_b32 v8, 16, v21
  v_and_b32 v9, 0xffff0000, v21
  v_add_f32 v7, v7, v8
  v_add_f32 v7, v7, v9
  v_lshlrev_b32 v8, 16, v22
  v_and_b32 v9, 0xffff0000, v22
  v_add_f32 v7, v7, v8
  v_add_f32 v7, v7, v9
  v_lshlrev_b32 v8, 16, v23
  v_and_b32 v9, 0xffff0000, v23
  v_add_f32 v7, v7, v8
  v_add_f32 v7, v7, v9
  v_pk_fma_f32 v[32:33], v[32:33], s[52:53], v[6:7] op_sel_hi:[1,0,0]
  v_pk_fma_f32 v[34:35], v[34:35], s[52:53], v[6:7] op_sel_hi:[1,0,0]
  v_pk_fma_f32 v[36:37], v[36:37], s[52:53], v[6:7] op_sel_hi:[1,0,0]
  v_pk_fma_f32 v[38:39], v[38:39], s[52:53], v[6:7] op_sel_hi:[1,0,0]
  v_pk_fma_f32 v[40:41], v[40:41], s[52:53], v[6:7] op_sel_hi:[1,0,0]
  v_pk_fma_f32 v[42:43], v[42:43], s[52:53], v[6:7] op_sel_hi:[1,0,0]
  v_pk_fma_f32 v[44:45], v[44:45], s[52:53], v[6:7] op_sel_hi:[1,0,0]
  v_pk_fma_f32 v[46:47], v[46:47], s[52:53], v[6:7] op_sel_hi:[1,0,0]
  v_exp_f32 v32, v32
  v_exp_f32 v33, v33
  v_exp_f32 v34, v34
  v_exp_f32 v35, v35
  v_exp_f32 v36, v36
  v_exp_f32 v37, v37
  v_exp_f32 v38, v38
  v_exp_f32 v39, v39
  v_exp_f32 v40, v40
  v_exp_f32 v41, v41
  v_exp_f32 v42, v42
  v_exp_f32 v43, v43
  v_exp_f32 v44, v44
  v_exp_f32 v45, v45
  v_exp_f32 v46, v46
  v_exp_f32 v47, v47
  v_cvt_pk_bf16_f32 v32, v32, v33
  v_cvt_pk_bf16_f32 v33, v34, v35
  v_cvt_pk_bf16_f32 v34, v36, v37
  v_cvt_pk_bf16_f32 v35, v38, v39
  v_cvt_pk_bf16_f32 v36, v40, v41
  v_cvt_pk_bf16_f32 v37, v42, v43
  v_cvt_pk_bf16_f32 v38, v44, v45
  v_cvt_pk_bf16_f32 v39, v46, v47
  v_lshlrev_b32 v8, 16, v32
  v_and_b32 v9, 0xffff0000, v32
  v_add_f32 v7, v7, v8
  v_add_f32 v7, v7, v9
  v_lshlrev_b32 v8, 16, v33
  v_and_b32 v9, 0xffff0000, v33
  v_add_f32 v7, v7, v8
  v_add_f32 v7, v7, v9
  v_lshlrev_b32 v8, 16, v34
  v_and_b32 v9, 0xffff0000, v34
  v_add_f32 v7, v7, v8
  v_add_f32 v7, v7, v9
  v_lshlrev_b32 v8, 16, v35
  v_and_b32 v9, 0xffff0000, v35
  v_add_f32 v7, v7, v8
  v_add_f32 v7, v7, v9
  v_lshlrev_b32 v8, 16, v36
  v_and_b32 v9, 0xffff0000, v36
  v_add_f32 v7, v7, v8
  v_add_f32 v7, v7, v9
  v_lshlrev_b32 v8, 16, v37
  v_and_b32 v9, 0xffff0000, v37
  v_add_f32 v7, v7, v8
  v_add_f32 v7, v7, v9
  v_lshlrev_b32 v8, 16, v38
  v_and_b32 v9, 0xffff0000, v38
  v_add_f32 v7, v7, v8
  v_add_f32 v7, v7, v9
  v_lshlrev_b32 v8, 16, v39
  v_and_b32 v9, 0xffff0000, v39
  v_add_f32 v7, v7, v8
  v_add_f32 v7, v7, v9
  v_pk_fma_f32 v[48:49], v[48:49], s[52:53], v[6:7] op_sel_hi:[1,0,0]
  v_pk_fma_f32 v[50:51], v[50:51], s[52:53], v[6:7] op_sel_hi:[1,0,0]
  v_pk_fma_f32 v[52:53], v[52:53], s[52:53], v[6:7] op_sel_hi:[1,0,0]
  v_pk_fma_f32 v[54:55], v[54:55], s[52:53], v[6:7] op_sel_hi:[1,0,0]
  v_pk_fma_f32 v[56:57], v[56:57], s[52:53], v[6:7] op_sel_hi:[1,0,0]
  v_pk_fma_f32 v[58:59], v[58:59], s[52:53], v[6:7] op_sel_hi:[1,0,0]
  v_pk_fma_f32 v[60:61], v[60:61], s[52:53], v[6:7] op_sel_hi:[1,0,0]
  v_pk_fma_f32 v[62:63], v[62:63], s[52:53], v[6:7] op_sel_hi:[1,0,0]
  v_exp_f32 v48, v48
  v_exp_f32 v49, v49
  v_exp_f32 v50, v50
  v_exp_f32 v51, v51
  v_exp_f32 v52, v52
  v_exp_f32 v53, v53
  v_exp_f32 v54, v54
  v_exp_f32 v55, v55
  v_exp_f32 v56, v56
  v_exp_f32 v57, v57
  v_exp_f32 v58, v58
  v_exp_f32 v59, v59
  v_exp_f32 v60, v60
  v_exp_f32 v61, v61
  v_exp_f32 v62, v62
  v_exp_f32 v63, v63
  v_cvt_pk_bf16_f32 v48, v48, v49
  v_cvt_pk_bf16_f32 v49, v50, v51
  v_cvt_pk_bf16_f32 v50, v52, v53
  v_cvt_pk_bf16_f32 v51, v54, v55
  v_cvt_pk_bf16_f32 v52, v56, v57
  v_cvt_pk_bf16_f32 v53, v58, v59
  v_cvt_pk_bf16_f32 v54, v60, v61
  v_cvt_pk_bf16_f32 v55, v62, v63
  v_lshlrev_b32 v8, 16, v48
  v_and_b32 v9, 0xffff0000, v48
  v_add_f32 v7, v7, v8
  v_add_f32 v7, v7, v9
  v_lshlrev_b32 v8, 16, v49
  v_and_b32 v9, 0xffff0000, v49
  v_add_f32 v7, v7, v8
  v_add_f32 v7, v7, v9
  v_lshlrev_b32 v8, 16, v50
  v_and_b32 v9, 0xffff0000, v50
  v_add_f32 v7, v7, v8
  v_add_f32 v7, v7, v9
  v_lshlrev_b32 v8, 16, v51
  v_and_b32 v9, 0xffff0000, v51
  v_add_f32 v7, v7, v8
  v_add_f32 v7, v7, v9
  v_lshlrev_b32 v8, 16, v52
  v_and_b32 v9, 0xffff0000, v52
  v_add_f32 v7, v7, v8
  v_add_f32 v7, v7, v9
  v_lshlrev_b32 v8, 16, v53
  v_and_b32 v9, 0xffff0000, v53
  v_add_f32 v7, v7, v8
  v_add_f32 v7, v7, v9
  v_lshlrev_b32 v8, 16, v54
  v_and_b32 v9, 0xffff0000, v54
  v_add_f32 v7, v7, v8
  v_add_f32 v7, v7, v9
  v_lshlrev_b32 v8, 16, v55
  v_and_b32 v9, 0xffff0000, v55
  v_add_f32 v7, v7, v8
  v_add_f32 v7, v7, v9
  v_pk_fma_f32 v[64:65], v[64:65], s[52:53], v[6:7] op_sel_hi:[1,0,0]
  v_pk_fma_f32 v[66:67], v[66:67], s[52:53], v[6:7] op_sel_hi:[1,0,0]
  v_pk_fma_f32 v[68:69], v[68:69], s[52:53], v[6:7] op_sel_hi:[1,0,0]
  v_pk_fma_f32 v[70:71], v[70:71], s[52:53], v[6:7] op_sel_hi:[1,0,0]
  v_pk_fma_f32 v[72:73], v[72:73], s[52:53], v[6:7] op_sel_hi:[1,0,0]
  v_pk_fma_f32 v[74:75], v[74:75], s[52:53], v[6:7] op_sel_hi:[1,0,0]
  v_pk_fma_f32 v[76:77], v[76:77], s[52:53], v[6:7] op_sel_hi:[1,0,0]
  v_pk_fma_f32 v[78:79], v[78:79], s[52:53], v[6:7] op_sel_hi:[1,0,0]
  v_exp_f32 v64, v64
  v_exp_f32 v65, v65
  v_exp_f32 v66, v66
  v_exp_f32 v67, v67
  v_exp_f32 v68, v68
  v_exp_f32 v69, v69
  v_exp_f32 v70, v70
  v_exp_f32 v71, v71
  v_exp_f32 v72, v72
  v_exp_f32 v73, v73
  v_exp_f32 v74, v74
  v_exp_f32 v75, v75
  v_exp_f32 v76, v76
  v_exp_f32 v77, v77
  v_exp_f32 v78, v78
  v_exp_f32 v79, v79
  v_cvt_pk_bf16_f32 v64, v64, v65
  v_cvt_pk_bf16_f32 v65, v66, v67
  v_cvt_pk_bf16_f32 v66, v68, v69
  v_cvt_pk_bf16_f32 v67, v70, v71
  v_cvt_pk_bf16_f32 v68, v72, v73
  v_cvt_pk_bf16_f32 v69, v74, v75
  v_cvt_pk_bf16_f32 v70, v76, v77
  v_cvt_pk_bf16_f32 v71, v78, v79
  v_lshlrev_b32 v8, 16, v64
  v_and_b32 v9, 0xffff0000, v64
  v_add_f32 v7, v7, v8
  v_add_f32 v7, v7, v9
  v_lshlrev_b32 v8, 16, v65
  v_and_b32 v9, 0xffff0000, v65
  v_add_f32 v7, v7, v8
  v_add_f32 v7, v7, v9
  v_lshlrev_b32 v8, 16, v66
  v_and_b32 v9, 0xffff0000, v66
  v_add_f32 v7, v7, v8
  v_add_f32 v7, v7, v9
  v_lshlrev_b32 v8, 16, v67
  v_and_b32 v9, 0xffff0000, v67
  v_add_f32 v7, v7, v8
  v_add_f32 v7, v7, v9
  v_lshlrev_b32 v8, 16, v68
  v_and_b32 v9, 0xffff0000, v68
  v_add_f32 v7, v7, v8
  v_add_f32 v7, v7, v9
  v_lshlrev_b32 v8, 16, v69
  v_and_b32 v9, 0xffff0000, v69
  v_add_f32 v7, v7, v8
  v_add_f32 v7, v7, v9
  v_lshlrev_b32 v8, 16, v70
  v_and_b32 v9, 0xffff0000, v70
  v_add_f32 v7, v7, v8
  v_add_f32 v7, v7, v9
  v_lshlrev_b32 v8, 16, v71
  v_and_b32 v9, 0xffff0000, v71
  v_add_f32 v7, v7, v8
  v_add_f32 v7, v7, v9
  v_pk_fma_f32 v[80:81], v[80:81], s[52:53], v[6:7] op_sel_hi:[1,0,0]
  v_pk_fma_f32 v[82:83], v[82:83], s[52:53], v[6:7] op_sel_hi:[1,0,0]
  v_pk_fma_f32 v[84:85], v[84:85], s[52:53], v[6:7] op_sel_hi:[1,0,0]
  v_pk_fma_f32 v[86:87], v[86:87], s[52:53], v[6:7] op_sel_hi:[1,0,0]
  v_pk_fma_f32 v[88:89], v[88:89], s[52:53], v[6:7] op_sel_hi:[1,0,0]
  v_pk_fma_f32 v[90:91], v[90:91], s[52:53], v[6:7] op_sel_hi:[1,0,0]
  v_pk_fma_f32 v[92:93], v[92:93], s[52:53], v[6:7] op_sel_hi:[1,0,0]
  v_pk_fma_f32 v[94:95], v[94:95], s[52:53], v[6:7] op_sel_hi:[1,0,0]
  v_exp_f32 v80, v80
  v_exp_f32 v81, v81
  v_exp_f32 v82, v82
  v_exp_f32 v83, v83
  v_exp_f32 v84, v84
  v_exp_f32 v85, v85
  v_exp_f32 v86, v86
  v_exp_f32 v87, v87
  v_exp_f32 v88, v88
  v_exp_f32 v89, v89
  v_exp_f32 v90, v90
  v_exp_f32 v91, v91
  v_exp_f32 v92, v92
  v_exp_f32 v93, v93
  v_exp_f32 v94, v94
  v_exp_f32 v95, v95
  v_cvt_pk_bf16_f32 v80, v80, v81
  v_cvt_pk_bf16_f32 v81, v82, v83
  v_cvt_pk_bf16_f32 v82, v84, v85
  v_cvt_pk_bf16_f32 v83, v86, v87
  v_cvt_pk_bf16_f32 v84, v88, v89
  v_cvt_pk_bf16_f32 v85, v90, v91
  v_cvt_pk_bf16_f32 v86, v92, v93
  v_cvt_pk_bf16_f32 v87, v94, v95
  v_lshlrev_b32 v8, 16, v80
  v_and_b32 v9, 0xffff0000, v80
  v_add_f32 v7, v7, v8
  v_add_f32 v7, v7, v9
  v_lshlrev_b32 v8, 16, v81
  v_and_b32 v9, 0xffff0000, v81
  v_add_f32 v7, v7, v8
  v_add_f32 v7, v7, v9
  v_lshlrev_b32 v8, 16, v82
  v_and_b32 v9, 0xffff0000, v82
  v_add_f32 v7, v7, v8
  v_add_f32 v7, v7, v9
  v_lshlrev_b32 v8, 16, v83
  v_and_b32 v9, 0xffff0000, v83
  v_add_f32 v7, v7, v8
  v_add_f32 v7, v7, v9
  v_lshlrev_b32 v8, 16, v84
  v_and_b32 v9, 0xffff0000, v84
  v_add_f32 v7, v7, v8
  v_add_f32 v7, v7, v9
  v_lshlrev_b32 v8, 16, v85
  v_and_b32 v9, 0xffff0000, v85
  v_add_f32 v7, v7, v8
  v_add_f32 v7, v7, v9
  v_lshlrev_b32 v8, 16, v86
  v_and_b32 v9, 0xffff0000, v86
  v_add_f32 v7, v7, v8
  v_add_f32 v7, v7, v9
  v_lshlrev_b32 v8, 16, v87
  v_and_b32 v9, 0xffff0000, v87
  v_add_f32 v7, v7, v8
  v_add_f32 v7, v7, v9
  v_pk_fma_f32 v[96:97], v[96:97], s[52:53], v[6:7] op_sel_hi:[1,0,0]
  v_pk_fma_f32 v[98:99], v[98:99], s[52:53], v[6:7] op_sel_hi:[1,0,0]
  v_pk_fma_f32 v[100:101], v[100:101], s[52:53], v[6:7] op_sel_hi:[1,0,0]
  v_pk_fma_f32 v[102:103], v[102:103], s[52:53], v[6:7] op_sel_hi:[1,0,0]
  v_pk_fma_f32 v[104:105], v[104:105], s[52:53], v[6:7] op_sel_hi:[1,0,0]
  v_pk_fma_f32 v[106:107], v[106:107], s[52:53], v[6:7] op_sel_hi:[1,0,0]
  v_pk_fma_f32 v[108:109], v[108:109], s[52:53], v[6:7] op_sel_hi:[1,0,0]
  v_pk_fma_f32 v[110:111], v[110:111], s[52:53], v[6:7] op_sel_hi:[1,0,0]
  v_exp_f32 v96, v96
  v_exp_f32 v97, v97
  v_exp_f32 v98, v98
  v_exp_f32 v99, v99
  v_exp_f32 v100, v100
  v_exp_f32 v101, v101
  v_exp_f32 v102, v102
  v_exp_f32 v103, v103
  v_exp_f32 v104, v104
  v_exp_f32 v105, v105
  v_exp_f32 v106, v106
  v_exp_f32 v107, v107
  v_exp_f32 v108, v108
  v_exp_f32 v109, v109
  v_exp_f32 v110, v110
  v_exp_f32 v111, v111
  v_cvt_pk_bf16_f32 v96, v96, v97
  v_cvt_pk_bf16_f32 v97, v98, v99
  v_cvt_pk_bf16_f32 v98, v100, v101
  v_cvt_pk_bf16_f32 v99, v102, v103
  v_cvt_pk_bf16_f32 v100, v104, v105
  v_cvt_pk_bf16_f32 v101, v106, v107
  v_cvt_pk_bf16_f32 v102, v108, v109
  v_cvt_pk_bf16_f32 v103, v110, v111
  v_lshlrev_b32 v8, 16, v96
  v_and_b32 v9, 0xffff0000, v96
  v_add_f32 v7, v7, v8
  v_add_f32 v7, v7, v9
  v_lshlrev_b32 v8, 16, v97
  v_and_b32 v9, 0xffff0000, v97
  v_add_f32 v7, v7, v8
  v_add_f32 v7, v7, v9
  v_lshlrev_b32 v8, 16, v98
  v_and_b32 v9, 0xffff0000, v98
  v_add_f32 v7, v7, v8
  v_add_f32 v7, v7, v9
  v_lshlrev_b32 v8, 16, v99
  v_and_b32 v9, 0xffff0000, v99
  v_add_f32 v7, v7, v8
  v_add_f32 v7, v7, v9
  v_lshlrev_b32 v8, 16, v100
  v_and_b32 v9, 0xffff0000, v100
  v_add_f32 v7, v7, v8
  v_add_f32 v7, v7, v9
  v_lshlrev_b32 v8, 16, v101
  v_and_b32 v9, 0xffff0000, v101
  v_add_f32 v7, v7, v8
  v_add_f32 v7, v7, v9
  v_lshlrev_b32 v8, 16, v102
  v_and_b32 v9, 0xffff0000, v102
  v_add_f32 v7, v7, v8
  v_add_f32 v7, v7, v9
  v_lshlrev_b32 v8, 16, v103
  v_and_b32 v9, 0xffff0000, v103
  v_add_f32 v7, v7, v8
  v_add_f32 v7, v7, v9
  v_pk_fma_f32 v[112:113], v[112:113], s[52:53], v[6:7] op_sel_hi:[1,0,0]
  v_pk_fma_f32 v[114:115], v[114:115], s[52:53], v[6:7] op_sel_hi:[1,0,0]
  v_pk_fma_f32 v[116:117], v[116:117], s[52:53], v[6:7] op_sel_hi:[1,0,0]
  v_pk_fma_f32 v[118:119], v[118:119], s[52:53], v[6:7] op_sel_hi:[1,0,0]
  v_pk_fma_f32 v[120:121], v[120:121], s[52:53], v[6:7] op_sel_hi:[1,0,0]
  v_pk_fma_f32 v[122:123], v[122:123], s[52:53], v[6:7] op_sel_hi:[1,0,0]
  v_pk_fma_f32 v[124:125], v[124:125], s[52:53], v[6:7] op_sel_hi:[1,0,0]
  v_pk_fma_f32 v[126:127], v[126:127], s[52:53], v[6:7] op_sel_hi:[1,0,0]
  v_exp_f32 v112, v112
  v_exp_f32 v113, v113
  v_exp_f32 v114, v114
  v_exp_f32 v115, v115
  v_exp_f32 v116, v116
  v_exp_f32 v117, v117
  v_exp_f32 v118, v118
  v_exp_f32 v119, v119
  v_exp_f32 v120, v120
  v_exp_f32 v121, v121
  v_exp_f32 v122, v122
  v_exp_f32 v123, v123
  v_exp_f32 v124, v124
  v_exp_f32 v125, v125
  v_exp_f32 v126, v126
  v_exp_f32 v127, v127
  v_cvt_pk_bf16_f32 v112, v112, v113
  v_cvt_pk_bf16_f32 v113, v114, v115
  v_cvt_pk_bf16_f32 v114, v116, v117
  v_cvt_pk_bf16_f32 v115, v118, v119
  v_cvt_pk_bf16_f32 v116, v120, v121
  v_cvt_pk_bf16_f32 v117, v122, v123
  v_cvt_pk_bf16_f32 v118, v124, v125
  v_cvt_pk_bf16_f32 v119, v126, v127
  v_lshlrev_b32 v8, 16, v112
  v_and_b32 v9, 0xffff0000, v112
  v_add_f32 v7, v7, v8
  v_add_f32 v7, v7, v9
  v_lshlrev_b32 v8, 16, v113
  v_and_b32 v9, 0xffff0000, v113
  v_add_f32 v7, v7, v8
  v_add_f32 v7, v7, v9
  v_lshlrev_b32 v8, 16, v114
  v_and_b32 v9, 0xffff0000, v114
  v_add_f32 v7, v7, v8
  v_add_f32 v7, v7, v9
  v_lshlrev_b32 v8, 16, v115
  v_and_b32 v9, 0xffff0000, v115
  v_add_f32 v7, v7, v8
  v_add_f32 v7, v7, v9
  v_lshlrev_b32 v8, 16, v116
  v_and_b32 v9, 0xffff0000, v116
  v_add_f32 v7, v7, v8
  v_add_f32 v7, v7, v9
  v_lshlrev_b32 v8, 16, v117
  v_and_b32 v9, 0xffff0000, v117
  v_add_f32 v7, v7, v8
  v_add_f32 v7, v7, v9
  v_lshlrev_b32 v8, 16, v118
  v_and_b32 v9, 0xffff0000, v118
  v_add_f32 v7, v7, v8
  v_add_f32 v7, v7, v9
  v_lshlrev_b32 v8, 16, v119
  v_and_b32 v9, 0xffff0000, v119
  v_add_f32 v7, v7, v8
  v_add_f32 v7, v7, v9
  v_pk_fma_f32 v[128:129], v[128:129], s[52:53], v[6:7] op_sel_hi:[1,0,0]
  v_pk_fma_f32 v[130:131], v[130:131], s[52:53], v[6:7] op_sel_hi:[1,0,0]
  v_pk_fma_f32 v[132:133], v[132:133], s[52:53], v[6:7] op_sel_hi:[1,0,0]
  v_pk_fma_f32 v[134:135], v[134:135], s[52:53], v[6:7] op_sel_hi:[1,0,0]
  v_pk_fma_f32 v[136:137], v[136:137], s[52:53], v[6:7] op_sel_hi:[1,0,0]
  v_pk_fma_f32 v[138:139], v[138:139], s[52:53], v[6:7] op_sel_hi:[1,0,0]
  v_pk_fma_f32 v[140:141], v[140:141], s[52:53], v[6:7] op_sel_hi:[1,0,0]
  v_pk_fma_f32 v[142:143], v[142:143], s[52:53], v[6:7] op_sel_hi:[1,0,0]
  v_exp_f32 v128, v128
  v_exp_f32 v129, v129
  v_exp_f32 v130, v130
  v_exp_f32 v131, v131
  v_exp_f32 v132, v132
  v_exp_f32 v133, v133
  v_exp_f32 v134, v134
  v_exp_f32 v135, v135
  v_exp_f32 v136, v136
  v_exp_f32 v137, v137
  v_exp_f32 v138, v138
  v_exp_f32 v139, v139
  v_exp_f32 v140, v140
  v_exp_f32 v141, v141
  v_exp_f32 v142, v142
  v_exp_f32 v143, v143
  v_cvt_pk_bf16_f32 v128, v128, v129
  v_cvt_pk_bf16_f32 v129, v130, v131
  v_cvt_pk_bf16_f32 v130, v132, v133
  v_cvt_pk_bf16_f32 v131, v134, v135
  v_cvt_pk_bf16_f32 v132, v136, v137
  v_cvt_pk_bf16_f32 v133, v138, v139
  v_cvt_pk_bf16_f32 v134, v140, v141
  v_cvt_pk_bf16_f32 v135, v142, v143
  v_lshlrev_b32 v8, 16, v128
  v_and_b32 v9, 0xffff0000, v128
  v_add_f32 v7, v7, v8
  v_add_f32 v7, v7, v9
  v_lshlrev_b32 v8, 16, v129
  v_and_b32 v9, 0xffff0000, v129
  v_add_f32 v7, v7, v8
  v_add_f32 v7, v7, v9
  v_lshlrev_b32 v8, 16, v130
  v_and_b32 v9, 0xffff0000, v130
  v_add_f32 v7, v7, v8
  v_add_f32 v7, v7, v9
  v_lshlrev_b32 v8, 16, v131
  v_and_b32 v9, 0xffff0000, v131
  v_add_f32 v7, v7, v8
  v_add_f32 v7, v7, v9
  v_lshlrev_b32 v8, 16, v132
  v_and_b32 v9, 0xffff0000, v132
  v_add_f32 v7, v7, v8
  v_add_f32 v7, v7, v9
  v_lshlrev_b32 v8, 16, v133
  v_and_b32 v9, 0xffff0000, v133
  v_add_f32 v7, v7, v8
  v_add_f32 v7, v7, v9
  v_lshlrev_b32 v8, 16, v134
  v_and_b32 v9, 0xffff0000, v134
  v_add_f32 v7, v7, v8
  v_add_f32 v7, v7, v9
  v_lshlrev_b32 v8, 16, v135
  v_and_b32 v9, 0xffff0000, v135
  v_add_f32 v7, v7, v8
  v_add_f32 v7, v7, v9
  v_pk_fma_f32 v[144:145], v[144:145], s[52:53], v[6:7] op_sel_hi:[1,0,0]
  v_pk_fma_f32 v[146:147], v[146:147], s[52:53], v[6:7] op_sel_hi:[1,0,0]
  v_pk_fma_f32 v[148:149], v[148:149], s[52:53], v[6:7] op_sel_hi:[1,0,0]
  v_pk_fma_f32 v[150:151], v[150:151], s[52:53], v[6:7] op_sel_hi:[1,0,0]
  v_pk_fma_f32 v[152:153], v[152:153], s[52:53], v[6:7] op_sel_hi:[1,0,0]
  v_pk_fma_f32 v[154:155], v[154:155], s[52:53], v[6:7] op_sel_hi:[1,0,0]
  v_pk_fma_f32 v[156:157], v[156:157], s[52:53], v[6:7] op_sel_hi:[1,0,0]
  v_pk_fma_f32 v[158:159], v[158:159], s[52:53], v[6:7] op_sel_hi:[1,0,0]
  v_exp_f32 v144, v144
  v_exp_f32 v145, v145
  v_exp_f32 v146, v146
  v_exp_f32 v147, v147
  v_exp_f32 v148, v148
  v_exp_f32 v149, v149
  v_exp_f32 v150, v150
  v_exp_f32 v151, v151
  v_exp_f32 v152, v152
  v_exp_f32 v153, v153
  v_exp_f32 v154, v154
  v_exp_f32 v155, v155
  v_exp_f32 v156, v156
  v_exp_f32 v157, v157
  v_exp_f32 v158, v158
  v_exp_f32 v159, v159
  v_cvt_pk_bf16_f32 v144, v144, v145
  v_cvt_pk_bf16_f32 v145, v146, v147
  v_cvt_pk_bf16_f32 v146, v148, v149
  v_cvt_pk_bf16_f32 v147, v150, v151
  v_cvt_pk_bf16_f32 v148, v152, v153
  v_cvt_pk_bf16_f32 v149, v154, v155
  v_cvt_pk_bf16_f32 v150, v156, v157
  v_cvt_pk_bf16_f32 v151, v158, v159
  v_lshlrev_b32 v8, 16, v144
  v_and_b32 v9, 0xffff0000, v144
  v_add_f32 v7, v7, v8
  v_add_f32 v7, v7, v9
  v_lshlrev_b32 v8, 16, v145
  v_and_b32 v9, 0xffff0000, v145
  v_add_f32 v7, v7, v8
  v_add_f32 v7, v7, v9
  v_lshlrev_b32 v8, 16, v146
  v_and_b32 v9, 0xffff0000, v146
  v_add_f32 v7, v7, v8
  v_add_f32 v7, v7, v9
  v_lshlrev_b32 v8, 16, v147
  v_and_b32 v9, 0xffff0000, v147
  v_add_f32 v7, v7, v8
  v_add_f32 v7, v7, v9
  v_lshlrev_b32 v8, 16, v148
  v_and_b32 v9, 0xffff0000, v148
  v_add_f32 v7, v7, v8
  v_add_f32 v7, v7, v9
  v_lshlrev_b32 v8, 16, v149
  v_and_b32 v9, 0xffff0000, v149
  v_add_f32 v7, v7, v8
  v_add_f32 v7, v7, v9
  v_lshlrev_b32 v8, 16, v150
  v_and_b32 v9, 0xffff0000, v150
  v_add_f32 v7, v7, v8
  v_add_f32 v7, v7, v9
  v_lshlrev_b32 v8, 16, v151
  v_and_b32 v9, 0xffff0000, v151
  v_add_f32 v7, v7, v8
  v_add_f32 v7, v7, v9
  v_mov_b32 v8, v7
  s_nop 1
  v_permlane32_swap_b32 v7, v8
  v_add_f32 v7, v7, v8
  v_rcp_f32 v7, v7
  s_waitcnt vmcnt(17)
  v_mfma_f32_32x32x16_bf16 a[0:15], v[160:163], v[16:19], 0
  s_waitcnt vmcnt(16)
  v_mfma_f32_32x32x16_bf16 a[0:15], v[164:167], v[20:23], a[0:15]
  s_waitcnt vmcnt(15)
  v_mfma_f32_32x32x16_bf16 a[0:15], v[168:171], v[32:35], a[0:15]
  s_waitcnt vmcnt(14)
  v_mfma_f32_32x32x16_bf16 a[0:15], v[172:175], v[36:39], a[0:15]
  s_waitcnt vmcnt(13)
  v_mfma_f32_32x32x16_bf16 a[0:15], v[176:179], v[48:51], a[0:15]
  s_waitcnt vmcnt(12)
  v_mfma_f32_32x32x16_bf16 a[0:15], v[180:183], v[52:55], a[0:15]
  s_waitcnt vmcnt(11)
  v_mfma_f32_32x32x16_bf16 a[0:15], v[184:187], v[64:67], a[0:15]
  s_waitcnt vmcnt(10)
  v_mfma_f32_32x32x16_bf16 a[0:15], v[188:191], v[68:71], a[0:15]
  s_waitcnt vmcnt(9)
  v_mfma_f32_32x32x16_bf16 a[0:15], v[192:195], v[80:83], a[0:15]
  s_waitcnt vmcnt(8)
  v_mfma_f32_32x32x16_bf16 a[0:15], v[196:199], v[84:87], a[0:15]
  s_waitcnt vmcnt(7)
  v_mfma_f32_32x32x16_bf16 a[0:15], v[200:203], v[96:99], a[0:15]
  s_waitcnt vmcnt(6)
  v_mfma_f32_32x32x16_bf16 a[0:15], v[204:207], v[100:103], a[0:15]
  s_waitcnt vmcnt(5)
  v_mfma_f32_32x32x16_bf16 a[0:15], v[208:211], v[112:115], a[0:15]
  s_waitcnt vmcnt(4)
  v_mfma_f32_32x32x16_bf16 a[0:15], v[212:215], v[116:119], a[0:15]
  s_waitcnt vmcnt(3)
  v_mfma_f32_32x32x16_bf16 a[0:15], v[216:219], v[128:131], a[0:15]
  s_waitcnt vmcnt(2)
  v_mfma_f32_32x32x16_bf16 a[0:15], v[220:223], v[132:135], a[0:15]
  s_waitcnt vmcnt(1)
  v_mfma_f32_32x32x16_bf16 a[0:15], v[224:227], v[144:147], a[0:15]
  s_waitcnt vmcnt(0)
  v_mfma_f32_32x32x16_bf16 a[0:15], v[228:231], v[148:151], a[0:15]
  s_nop 11
  v_lshrrev_b32 v8, 5, v0
  s_mul_i32 s60, s41, 5
  s_mul_i32 s61, s40, 40960
  s_add_u32 s61, s61, 94371840
  v_accvgpr_read_b32 v240, a0
  v_accvgpr_read_b32 v241, a1
  v_accvgpr_read_b32 v242, a2
  v_accvgpr_read_b32 v243, a3
  v_mul_f32 v240, v240, v7
  v_mul_f32 v241, v241, v7
  v_mul_f32 v242, v242, v7
  v_mul_f32 v243, v243, v7
  v_cvt_pk_bf16_f32 v244, v240, v241
  v_cvt_pk_bf16_f32 v245, v242, v243
  v_add_u32 v9, s60, v8
  v_add_u32 v9, 0, v9
  v_lshrrev_b32 v10, 2, v9
  v_lshlrev_b32 v10, 10, v10
  v_and_b32 v13, 1, v9
  v_lshl_add_u32 v10, v13, 9, v10
  v_bfe_u32 v13, v9, 1, 1
  v_lshl_add_u32 v10, v13, 3, v10
  v_and_b32 v13, 31, v0
  v_lshl_add_u32 v10, v13, 4, v10
  buffer_store_dwordx2 v[244:245], v10, s[4:7], s61 offen sc1
  v_accvgpr_read_b32 v240, a4
  v_accvgpr_read_b32 v241, a5
  v_accvgpr_read_b32 v242, a6
  v_accvgpr_read_b32 v243, a7
  v_mul_f32 v240, v240, v7
  v_mul_f32 v241, v241, v7
  v_mul_f32 v242, v242, v7
  v_mul_f32 v243, v243, v7
  v_cvt_pk_bf16_f32 v246, v240, v241
  v_cvt_pk_bf16_f32 v247, v242, v243
  v_add_u32 v9, s60, v8
  v_add_u32 v9, 2, v9
  v_lshrrev_b32 v11, 2, v9
  v_lshlrev_b32 v11, 10, v11
  v_and_b32 v13, 1, v9
  v_lshl_add_u32 v11, v13, 9, v11
  v_bfe_u32 v13, v9, 1, 1
  v_lshl_add_u32 v11, v13, 3, v11
  v_and_b32 v13, 31, v0
  v_lshl_add_u32 v11, v13, 4, v11
  buffer_store_dwordx2 v[246:247], v11, s[4:7], s61 offen sc1
  v_accvgpr_read_b32 v240, a8
  v_accvgpr_read_b32 v241, a9
  v_accvgpr_read_b32 v242, a10
  v_accvgpr_read_b32 v243, a11
  v_mul_f32 v240, v240, v7
  v_mul_f32 v241, v241, v7
  v_mul_f32 v242, v242, v7
  v_mul_f32 v243, v243, v7
  v_cvt_pk_bf16_f32 v248, v240, v241
  v_cvt_pk_bf16_f32 v249, v242, v243
  v_add_u32 v9, s60, v8
  v_add_u32 v9, 4, v9
  v_lshrrev_b32 v12, 2, v9
  v_lshlrev_b32 v12, 10, v12
  v_and_b32 v13, 1, v9
  v_lshl_add_u32 v12, v13, 9, v12
  v_bfe_u32 v13, v9, 1, 1
  v_lshl_add_u32 v12, v13, 3, v12
  v_and_b32 v13, 31, v0
  v_lshl_add_u32 v12, v13, 4, v12
  s_mov_b32 exec_hi, 0
  buffer_store_dwordx2 v[248:249], v12, s[4:7], s61 offen sc1
  s_mov_b64 exec, -1
  s_add_u32 s41, s41, 1
  s_add_u32 s42, s42, 1
  s_cmp_lt_u32 s42, 8
  s_cbranch_scc1 BA_item
  s_waitcnt vmcnt(0)
  s_barrier
  s_cmp_eq_u32 s32, 0
  s_cbranch_scc0 BA_done
  s_lshl_b32 s60, s40, 7
  s_add_u32 s60, s60, 1875968
  s_mov_b32 s61, 1
  v_mov_b32 v6, s61
  v_add_u32 v6, s3, v6
  v_mov_b32 v7, 0
  s_mov_b64 exec, 1
  buffer_store_dword v6, v7, s[4:7], s60 offen sc1
  s_mov_b64 exec, -1
BA_done:
  s_waitcnt vmcnt(0)
  s_barrier
  s_branch K_fin
K_big:
  s_sub_u32 s60, s33, 4
  s_cmp_lt_u32 s34, 24
  s_cbranch_scc0 K_c
  s_mul_i32 s97, s60, 24
  s_add_u32 s97, s97, s34
  s_lshr_b32 s98, s97, 1
  s_and_b32 s99, s97, 1
  s_sub_u32 s62, s97, 32
  s_cmp_lt_u32 s62, 32
  s_cbranch_scc0 K_a_go
  s_mov_b32 s59, 0
  v_mov_b32 v3, 144
  s_mov_b64 exec, 1
K_a_ww_w:
  buffer_load_dword v2, v3, s[24:27], 0 offen sc1
  s_waitcnt vmcnt(0)
  v_cmp_gt_u32 vcc, 64, v2
  s_cbranch_vccz K_a_ww_d
  s_sleep 8
  s_add_u32 s59, s59, 8
  s_cmp_lt_u32 s59, s56
  s_cbranch_scc1 K_a_ww_w
  s_mov_b32 s56, 0
K_a_ww_d:
  s_mov_b64 exec, -1
K_a_go:
  s_lshr_b32 s60, s98, 4
  s_and_b32 s61, s98, 15
  s_cmp_eq_u32 s60, 0
  s_cbranch_scc1 P1a_mv
  s_cmp_eq_u32 s60, 1
  s_cbranch_scc1 P1a_mq
  s_load_dwordx2 s[8:9], s[0:1], 24
  s_mov_b32 s10, 5242880
  s_mov_b32 s11, 0x20000
  s_mov_b32 s48, 2097152
  s_branch P1a_qk
P1a_mq:
  s_load_dwordx2 s[8:9], s[0:1], 16
  s_mov_b32 s10, 5242880
  s_mov_b32 s11, 0x20000
  s_mov_b32 s48, 35651584
P1a_qk:
  s_mov_b32 s45, 0
  s_mov_b32 s42, 16
  s_mov_b32 s43, 8
  s_mov_b32 s44, 4
  s_mov_b32 s50, 256
  s_mov_b32 s51, 64
  s_and_b32 s62, s32, 1
  s_lshl_b32 s62, s62, 7
  s_branch P1a_cm
P1a_mv:
  s_load_dwordx2 s[8:9], s[0:1], 32
  s_mov_b32 s10, 5242880
  s_mov_b32 s11, 0x20000
  s_mov_b32 s48, 18874368
  s_mov_b32 s45, 1
  s_mov_b32 s42, 8
  s_mov_b32 s43, 16
  s_mov_b32 s44, 4
  s_mov_b32 s50, 64
  s_mov_b32 s51, 2048
  s_and_b32 s62, s32, 1
  s_lshl_b32 s62, s62, 12
P1a_cm:
  s_load_dwordx2 s[12:13], s[0:1], 0
  s_mov_b32 s14, 2621440
  s_mov_b32 s15, 0x20000
  s_add_u32 s48, s48, s62
  s_lshl_b32 s62, s61, 1
  s_lshr_b32 s63, s32, 1
  s_add_u32 s62, s62, s63
  s_lshl_b32 s62, s62, 19
  s_add_u32 s48, s48, s62
  s_lshl_b32 s62, s99, 17
  s_add_u32 s48, s48, s62
  s_mov_b32 s49, 8192
  s_mov_b32 s40, 8192
  s_lshl_b32 s41, s61, 9
  s_mul_i32 s46, s99, 655360
  s_mov_b32 s47, 16
  s_mov_b32 s53, 4
  s_lshl_b32 s62, s98, 2
  s_add_u32 s62, s62, s99
  s_lshl_b32 s62, s62, 7
  s_add_u32 s52, s62, 1835008
  s_waitcnt lgkmcnt(0)
  s_mov_b32 s96, 2
  s_branch K_wsg
K_a_after_p1:
  s_cmp_lt_u32 s97, 64
  s_cbranch_scc0 K_a_rest
  s_add_u32 s60, s97, 32
  s_sub_u32 s61, s97, 16
  s_cmp_lt_u32 s97, 16
  s_cselect_b32 s70, s60, s61
  s_cselect_b32 s71, 2, 3
  s_lshr_b32 s60, s70, 4
  s_and_b32 s61, s70, 15
  s_cmp_eq_u32 s60, 0
  s_cbranch_scc1 P1b_mv
  s_cmp_eq_u32 s60, 1
  s_cbranch_scc1 P1b_mq
  s_load_dwordx2 s[8:9], s[0:1], 24
  s_mov_b32 s10, 5242880
  s_mov_b32 s11, 0x20000
  s_mov_b32 s48, 2097152
  s_branch P1b_qk
P1b_mq:
  s_load_dwordx2 s[8:9], s[0:1], 16
  s_mov_b32 s10, 5242880
  s_mov_b32 s11, 0x20000
  s_mov_b32 s48, 35651584
P1b_qk:
  s_mov_b32 s45, 0
  s_mov_b32 s42, 16
  s_mov_b32 s43, 8
  s_mov_b32 s44, 4
  s_mov_b32 s50, 256
  s_mov_b32 s51, 64
  s_and_b32 s62, s32, 1
  s_lshl_b32 s62, s62, 7
  s_branch P1b_cm
P1b_mv:
  s_load_dwordx2 s[8:9], s[0:1], 32
  s_mov_b32 s10, 5242880
  s_mov_b32 s11, 0x20000
  s_mov_b32 s48, 18874368
  s_mov_b32 s45, 1
  s_mov_b32 s42, 8
  s_mov_b32 s43, 16
  s_mov_b32 s44, 4
  s_mov_b32 s50, 64
  s_mov_b32 s51, 2048
  s_and_b32 s62, s32, 1
  s_lshl_b32 s62, s62, 12
P1b_cm:
  s_load_dwordx2 s[12:13], s[0:1], 0
  s_mov_b32 s14, 2621440
  s_mov_b32 s15, 0x20000
  s_add_u32 s48, s48, s62
  s_lshl_b32 s62, s61, 1
  s_lshr_b32 s63, s32, 1
  s_add_u32 s62, s62, s63
  s_lshl_b32 s62, s62, 19
  s_add_u32 s48, s48, s62
  s_lshl_b32 s62, s71, 17
  s_add_u32 s48, s48, s62
  s_mov_b32 s49, 8192
  s_mov_b32 s40, 8192
  s_lshl_b32 s41, s61, 9
  s_mul_i32 s46, s71, 655360
  s_mov_b32 s47, 16
  s_mov_b32 s53, 4
  s_lshl_b32 s62, s70, 2
  s_add_u32 s62, s62, s71
  s_lshl_b32 s62, s62, 7
  s_add_u32 s52, s62, 1835008
  s_waitcnt lgkmcnt(0)
  s_mov_b32 s96, 0
  s_branch K_wsg
K_a_rest:
  s_sub_u32 s98, s97, 64
  s_cmp_lt_u32 s98, 16
  s_cbranch_scc0 K_a_final
  s_load_dwordx2 s[8:9], s[0:1], 0
  s_mov_b32 s10, 2621440
  s_mov_b32 s11, 0x20000
  s_load_dwordx2 s[12:13], s[0:1], 80
  s_mov_b32 s14, 1280
  s_mov_b32 s15, 0x20000
  s_waitcnt lgkmcnt(0)
  s_lshl_b32 s60, s32, 6
  v_add_u32 v2, s60, v0
  v_lshrrev_b32 v3, 1, v2
  s_lshl_b32 s61, s98, 7
  v_add_u32 v3, s61, v3
  v_mul_u32_u24 v5, 1280, v3
  v_and_b32 v6, 1, v2
  v_mul_u32_u24 v6, 640, v6
  v_add_u32 v5, v5, v6
  v_mov_b32 v4, 0
  buffer_load_dwordx4 v[16:19], v5, s[8:11], 0 offen offset:0
  buffer_load_dwordx4 v[48:51], v6, s[12:15], 0 offen offset:0
  buffer_load_dwordx4 v[20:23], v5, s[8:11], 0 offen offset:16
  buffer_load_dwordx4 v[52:55], v6, s[12:15], 0 offen offset:16
  buffer_load_dwordx4 v[24:27], v5, s[8:11], 0 offen offset:32
  buffer_load_dwordx4 v[56:59], v6, s[12:15], 0 offen offset:32
  buffer_load_dwordx4 v[28:31], v5, s[8:11], 0 offen offset:48
  buffer_load_dwordx4 v[60:63], v6, s[12:15], 0 offen offset:48
  buffer_load_dwordx4 v[32:35], v5, s[8:11], 0 offen offset:64
  buffer_load_dwordx4 v[64:67], v6, s[12:15], 0 offen offset:64
  buffer_load_dwordx4 v[36:39], v5, s[8:11], 0 offen offset:80
  buffer_load_dwordx4 v[68:71], v6, s[12:15], 0 offen offset:80
  buffer_load_dwordx4 v[40:43], v5, s[8:11], 0 offen offset:96
  buffer_load_dwordx4 v[72:75], v6, s[12:15], 0 offen offset:96
  buffer_load_dwordx4 v[44:47], v5, s[8:11], 0 offen offset:112
  buffer_load_dwordx4 v[76:79], v6, s[12:15], 0 offen offset:112
  s_waitcnt vmcnt(0)
  v_lshlrev_b32 v8, 16, v16
  v_lshlrev_b32 v9, 16, v48
  v_fmac_f32 v4, v8, v9
  v_and_b32 v8, 0xffff0000, v16
  v_and_b32 v9, 0xffff0000, v48
  v_fmac_f32 v4, v8, v9
  v_lshlrev_b32 v8, 16, v17
  v_lshlrev_b32 v9, 16, v49
  v_fmac_f32 v4, v8, v9
  v_and_b32 v8, 0xffff0000, v17
  v_and_b32 v9, 0xffff0000, v49
  v_fmac_f32 v4, v8, v9
  v_lshlrev_b32 v8, 16, v18
  v_lshlrev_b32 v9, 16, v50
  v_fmac_f32 v4, v8, v9
  v_and_b32 v8, 0xffff0000, v18
  v_and_b32 v9, 0xffff0000, v50
  v_fmac_f32 v4, v8, v9
  v_lshlrev_b32 v8, 16, v19
  v_lshlrev_b32 v9, 16, v51
  v_fmac_f32 v4, v8, v9
  v_and_b32 v8, 0xffff0000, v19
  v_and_b32 v9, 0xffff0000, v51
  v_fmac_f32 v4, v8, v9
  v_lshlrev_b32 v8, 16, v20
  v_lshlrev_b32 v9, 16, v52
  v_fmac_f32 v4, v8, v9
  v_and_b32 v8, 0xffff0000, v20
  v_and_b32 v9, 0xffff0000, v52
  v_fmac_f32 v4, v8, v9
  v_lshlrev_b32 v8, 16, v21
  v_lshlrev_b32 v9, 16, v53
  v_fmac_f32 v4, v8, v9
  v_and_b32 v8, 0xffff0000, v21
  v_and_b32 v9, 0xffff0000, v53
  v_fmac_f32 v4, v8, v9
  v_lshlrev_b32 v8, 16, v22
  v_lshlrev_b32 v9, 16, v54
  v_fmac_f32 v4, v8, v9
  v_and_b32 v8, 0xffff0000, v22
  v_and_b32 v9, 0xffff0000, v54
  v_fmac_f32 v4, v8, v9
  v_lshlrev_b32 v8, 16, v23
  v_lshlrev_b32 v9, 16, v55
  v_fmac_f32 v4, v8, v9
  v_and_b32 v8, 0xffff0000, v23
  v_and_b32 v9, 0xffff0000, v55
  v_fmac_f32 v4, v8, v9
  v_lshlrev_b32 v8, 16, v24
  v_lshlrev_b32 v9, 16, v56
  v_fmac_f32 v4, v8, v9
  v_and_b32 v8, 0xffff0000, v24
  v_and_b32 v9, 0xffff0000, v56
  v_fmac_f32 v4, v8, v9
  v_lshlrev_b32 v8, 16, v25
  v_lshlrev_b32 v9, 16, v57
  v_fmac_f32 v4, v8, v9
  v_and_b32 v8, 0xffff0000, v25
  v_and_b32 v9, 0xffff0000, v57
  v_fmac_f32 v4, v8, v9
  v_lshlrev_b32 v8, 16, v26
  v_lshlrev_b32 v9, 16, v58
  v_fmac_f32 v4, v8, v9
  v_and_b32 v8, 0xffff0000, v26
  v_and_b32 v9, 0xffff0000, v58
  v_fmac_f32 v4, v8, v9
  v_lshlrev_b32 v8, 16, v27
  v_lshlrev_b32 v9, 16, v59
  v_fmac_f32 v4, v8, v9
  v_and_b32 v8, 0xffff0000, v27
  v_and_b32 v9, 0xffff0000, v59
  v_fmac_f32 v4, v8, v9
  v_lshlrev_b32 v8, 16, v28
  v_lshlrev_b32 v9, 16, v60
  v_fmac_f32 v4, v8, v9
  v_and_b32 v8, 0xffff0000, v28
  v_and_b32 v9, 0xffff0000, v60
  v_fmac_f32 v4, v8, v9
  v_lshlrev_b32 v8, 16, v29
  v_lshlrev_b32 v9, 16, v61
  v_fmac_f32 v4, v8, v9
  v_and_b32 v8, 0xffff0000, v29
  v_and_b32 v9, 0xffff0000, v61
  v_fmac_f32 v4, v8, v9
  v_lshlrev_b32 v8, 16, v30
  v_lshlrev_b32 v9, 16, v62
  v_fmac_f32 v4, v8, v9
  v_and_b32 v8, 0xffff0000, v30
  v_and_b32 v9, 0xffff0000, v62
  v_fmac_f32 v4, v8, v9
  v_lshlrev_b32 v8, 16, v31
  v_lshlrev_b32 v9, 16, v63
  v_fmac_f32 v4, v8, v9
  v_and_b32 v8, 0xffff0000, v31
  v_and_b32 v9, 0xffff0000, v63
  v_fmac_f32 v4, v8, v9
  v_lshlrev_b32 v8, 16, v32
  v_lshlrev_b32 v9, 16, v64
  v_fmac_f32 v4, v8, v9
  v_and_b32 v8, 0xffff0000, v32
  v_and_b32 v9, 0xffff0000, v64
  v_fmac_f32 v4, v8, v9
  v_lshlrev_b32 v8, 16, v33
  v_lshlrev_b32 v9, 16, v65
  v_fmac_f32 v4, v8, v9
  v_and_b32 v8, 0xffff0000, v33
  v_and_b32 v9, 0xffff0000, v65
  v_fmac_f32 v4, v8, v9
  v_lshlrev_b32 v8, 16, v34
  v_lshlrev_b32 v9, 16, v66
  v_fmac_f32 v4, v8, v9
  v_and_b32 v8, 0xffff0000, v34
  v_and_b32 v9, 0xffff0000, v66
  v_fmac_f32 v4, v8, v9
  v_lshlrev_b32 v8, 16, v35
  v_lshlrev_b32 v9, 16, v67
  v_fmac_f32 v4, v8, v9
  v_and_b32 v8, 0xffff0000, v35
  v_and_b32 v9, 0xffff0000, v67
  v_fmac_f32 v4, v8, v9
  v_lshlrev_b32 v8, 16, v36
  v_lshlrev_b32 v9, 16, v68
  v_fmac_f32 v4, v8, v9
  v_and_b32 v8, 0xffff0000, v36
  v_and_b32 v9, 0xffff0000, v68
  v_fmac_f32 v4, v8, v9
  v_lshlrev_b32 v8, 16, v37
  v_lshlrev_b32 v9, 16, v69
  v_fmac_f32 v4, v8, v9
  v_and_b32 v8, 0xffff0000, v37
  v_and_b32 v9, 0xffff0000, v69
  v_fmac_f32 v4, v8, v9
  v_lshlrev_b32 v8, 16, v38
  v_lshlrev_b32 v9, 16, v70
  v_fmac_f32 v4, v8, v9
  v_and_b32 v8, 0xffff0000, v38
  v_and_b32 v9, 0xffff0000, v70
  v_fmac_f32 v4, v8, v9
  v_lshlrev_b32 v8, 16, v39
  v_lshlrev_b32 v9, 16, v71
  v_fmac_f32 v4, v8, v9
  v_and_b32 v8, 0xffff0000, v39
  v_and_b32 v9, 0xffff0000, v71
  v_fmac_f32 v4, v8, v9
  v_lshlrev_b32 v8, 16, v40
  v_lshlrev_b32 v9, 16, v72
  v_fmac_f32 v4, v8, v9
  v_and_b32 v8, 0xffff0000, v40
  v_and_b32 v9, 0xffff0000, v72
  v_fmac_f32 v4, v8, v9
  v_lshlrev_b32 v8, 16, v41
  v_lshlrev_b32 v9, 16, v73
  v_fmac_f32 v4, v8, v9
  v_and_b32 v8, 0xffff0000, v41
  v_and_b32 v9, 0xffff0000, v73
  v_fmac_f32 v4, v8, v9
  v_lshlrev_b32 v8, 16, v42
  v_lshlrev_b32 v9, 16, v74
  v_fmac_f32 v4, v8, v9
  v_and_b32 v8, 0xffff0000, v42
  v_and_b32 v9, 0xffff0000, v74
  v_fmac_f32 v4, v8, v9
  v_lshlrev_b32 v8, 16, v43
  v_lshlrev_b32 v9, 16, v75
  v_fmac_f32 v4, v8, v9
  v_and_b32 v8, 0xffff0000, v43
  v_and_b32 v9, 0xffff0000, v75
  v_fmac_f32 v4, v8, v9
  v_lshlrev_b32 v8, 16, v44
  v_lshlrev_b32 v9, 16, v76
  v_fmac_f32 v4, v8, v9
  v_and_b32 v8, 0xffff0000, v44
  v_and_b32 v9, 0xffff0000, v76
  v_fmac_f32 v4, v8, v9
  v_lshlrev_b32 v8, 16, v45
  v_lshlrev_b32 v9, 16, v77
  v_fmac_f32 v4, v8, v9
  v_and_b32 v8, 0xffff0000, v45
  v_and_b32 v9, 0xffff0000, v77
  v_fmac_f32 v4, v8, v9
  v_lshlrev_b32 v8, 16, v46
  v_lshlrev_b32 v9, 16, v78
  v_fmac_f32 v4, v8, v9
  v_and_b32 v8, 0xffff0000, v46
  v_and_b32 v9, 0xffff0000, v78
  v_fmac_f32 v4, v8, v9
  v_lshlrev_b32 v8, 16, v47
  v_lshlrev_b32 v9, 16, v79
  v_fmac_f32 v4, v8, v9
  v_and_b32 v8, 0xffff0000, v47
  v_and_b32 v9, 0xffff0000, v79
  v_fmac_f32 v4, v8, v9
  buffer_load_dwordx4 v[16:19], v5, s[8:11], 0 offen offset:128
  buffer_load_dwordx4 v[48:51], v6, s[12:15], 0 offen offset:128
  buffer_load_dwordx4 v[20:23], v5, s[8:11], 0 offen offset:144
  buffer_load_dwordx4 v[52:55], v6, s[12:15], 0 offen offset:144
  buffer_load_dwordx4 v[24:27], v5, s[8:11], 0 offen offset:160
  buffer_load_dwordx4 v[56:59], v6, s[12:15], 0 offen offset:160
  buffer_load_dwordx4 v[28:31], v5, s[8:11], 0 offen offset:176
  buffer_load_dwordx4 v[60:63], v6, s[12:15], 0 offen offset:176
  buffer_load_dwordx4 v[32:35], v5, s[8:11], 0 offen offset:192
  buffer_load_dwordx4 v[64:67], v6, s[12:15], 0 offen offset:192
  buffer_load_dwordx4 v[36:39], v5, s[8:11], 0 offen offset:208
  buffer_load_dwordx4 v[68:71], v6, s[12:15], 0 offen offset:208
  buffer_load_dwordx4 v[40:43], v5, s[8:11], 0 offen offset:224
  buffer_load_dwordx4 v[72:75], v6, s[12:15], 0 offen offset:224
  buffer_load_dwordx4 v[44:47], v5, s[8:11], 0 offen offset:240
  buffer_load_dwordx4 v[76:79], v6, s[12:15], 0 offen offset:240
  s_waitcnt vmcnt(0)
  v_lshlrev_b32 v8, 16, v16
  v_lshlrev_b32 v9, 16, v48
  v_fmac_f32 v4, v8, v9
  v_and_b32 v8, 0xffff0000, v16
  v_and_b32 v9, 0xffff0000, v48
  v_fmac_f32 v4, v8, v9
  v_lshlrev_b32 v8, 16, v17
  v_lshlrev_b32 v9, 16, v49
  v_fmac_f32 v4, v8, v9
  v_and_b32 v8, 0xffff0000, v17
  v_and_b32 v9, 0xffff0000, v49
  v_fmac_f32 v4, v8, v9
  v_lshlrev_b32 v8, 16, v18
  v_lshlrev_b32 v9, 16, v50
  v_fmac_f32 v4, v8, v9
  v_and_b32 v8, 0xffff0000, v18
  v_and_b32 v9, 0xffff0000, v50
  v_fmac_f32 v4, v8, v9
  v_lshlrev_b32 v8, 16, v19
  v_lshlrev_b32 v9, 16, v51
  v_fmac_f32 v4, v8, v9
  v_and_b32 v8, 0xffff0000, v19
  v_and_b32 v9, 0xffff0000, v51
  v_fmac_f32 v4, v8, v9
  v_lshlrev_b32 v8, 16, v20
  v_lshlrev_b32 v9, 16, v52
  v_fmac_f32 v4, v8, v9
  v_and_b32 v8, 0xffff0000, v20
  v_and_b32 v9, 0xffff0000, v52
  v_fmac_f32 v4, v8, v9
  v_lshlrev_b32 v8, 16, v21
  v_lshlrev_b32 v9, 16, v53
  v_fmac_f32 v4, v8, v9
  v_and_b32 v8, 0xffff0000, v21
  v_and_b32 v9, 0xffff0000, v53
  v_fmac_f32 v4, v8, v9
  v_lshlrev_b32 v8, 16, v22
  v_lshlrev_b32 v9, 16, v54
  v_fmac_f32 v4, v8, v9
  v_and_b32 v8, 0xffff0000, v22
  v_and_b32 v9, 0xffff0000, v54
  v_fmac_f32 v4, v8, v9
  v_lshlrev_b32 v8, 16, v23
  v_lshlrev_b32 v9, 16, v55
  v_fmac_f32 v4, v8, v9
  v_and_b32 v8, 0xffff0000, v23
  v_and_b32 v9, 0xffff0000, v55
  v_fmac_f32 v4, v8, v9
  v_lshlrev_b32 v8, 16, v24
  v_lshlrev_b32 v9, 16, v56
  v_fmac_f32 v4, v8, v9
  v_and_b32 v8, 0xffff0000, v24
  v_and_b32 v9, 0xffff0000, v56
  v_fmac_f32 v4, v8, v9
  v_lshlrev_b32 v8, 16, v25
  v_lshlrev_b32 v9, 16, v57
  v_fmac_f32 v4, v8, v9
  v_and_b32 v8, 0xffff0000, v25
  v_and_b32 v9, 0xffff0000, v57
  v_fmac_f32 v4, v8, v9
  v_lshlrev_b32 v8, 16, v26
  v_lshlrev_b32 v9, 16, v58
  v_fmac_f32 v4, v8, v9
  v_and_b32 v8, 0xffff0000, v26
  v_and_b32 v9, 0xffff0000, v58
  v_fmac_f32 v4, v8, v9
  v_lshlrev_b32 v8, 16, v27
  v_lshlrev_b32 v9, 16, v59
  v_fmac_f32 v4, v8, v9
  v_and_b32 v8, 0xffff0000, v27
  v_and_b32 v9, 0xffff0000, v59
  v_fmac_f32 v4, v8, v9
  v_lshlrev_b32 v8, 16, v28
  v_lshlrev_b32 v9, 16, v60
  v_fmac_f32 v4, v8, v9
  v_and_b32 v8, 0xffff0000, v28
  v_and_b32 v9, 0xffff0000, v60
  v_fmac_f32 v4, v8, v9
  v_lshlrev_b32 v8, 16, v29
  v_lshlrev_b32 v9, 16, v61
  v_fmac_f32 v4, v8, v9
  v_and_b32 v8, 0xffff0000, v29
  v_and_b32 v9, 0xffff0000, v61
  v_fmac_f32 v4, v8, v9
  v_lshlrev_b32 v8, 16, v30
  v_lshlrev_b32 v9, 16, v62
  v_fmac_f32 v4, v8, v9
  v_and_b32 v8, 0xffff0000, v30
  v_and_b32 v9, 0xffff0000, v62
  v_fmac_f32 v4, v8, v9
  v_lshlrev_b32 v8, 16, v31
  v_lshlrev_b32 v9, 16, v63
  v_fmac_f32 v4, v8, v9
  v_and_b32 v8, 0xffff0000, v31
  v_and_b32 v9, 0xffff0000, v63
  v_fmac_f32 v4, v8, v9
  v_lshlrev_b32 v8, 16, v32
  v_lshlrev_b32 v9, 16, v64
  v_fmac_f32 v4, v8, v9
  v_and_b32 v8, 0xffff0000, v32
  v_and_b32 v9, 0xffff0000, v64
  v_fmac_f32 v4, v8, v9
  v_lshlrev_b32 v8, 16, v33
  v_lshlrev_b32 v9, 16, v65
  v_fmac_f32 v4, v8, v9
  v_and_b32 v8, 0xffff0000, v33
  v_and_b32 v9, 0xffff0000, v65
  v_fmac_f32 v4, v8, v9
  v_lshlrev_b32 v8, 16, v34
  v_lshlrev_b32 v9, 16, v66
  v_fmac_f32 v4, v8, v9
  v_and_b32 v8, 0xffff0000, v34
  v_and_b32 v9, 0xffff0000, v66
  v_fmac_f32 v4, v8, v9
  v_lshlrev_b32 v8, 16, v35
  v_lshlrev_b32 v9, 16, v67
  v_fmac_f32 v4, v8, v9
  v_and_b32 v8, 0xffff0000, v35
  v_and_b32 v9, 0xffff0000, v67
  v_fmac_f32 v4, v8, v9
  v_lshlrev_b32 v8, 16, v36
  v_lshlrev_b32 v9, 16, v68
  v_fmac_f32 v4, v8, v9
  v_and_b32 v8, 0xffff0000, v36
  v_and_b32 v9, 0xffff0000, v68
  v_fmac_f32 v4, v8, v9
  v_lshlrev_b32 v8, 16, v37
  v_lshlrev_b32 v9, 16, v69
  v_fmac_f32 v4, v8, v9
  v_and_b32 v8, 0xffff0000, v37
  v_and_b32 v9, 0xffff0000, v69
  v_fmac_f32 v4, v8, v9
  v_lshlrev_b32 v8, 16, v38
  v_lshlrev_b32 v9, 16, v70
  v_fmac_f32 v4, v8, v9
  v_and_b32 v8, 0xffff0000, v38
  v_and_b32 v9, 0xffff0000, v70
  v_fmac_f32 v4, v8, v9
  v_lshlrev_b32 v8, 16, v39
  v_lshlrev_b32 v9, 16, v71
  v_fmac_f32 v4, v8, v9
  v_and_b32 v8, 0xffff0000, v39
  v_and_b32 v9, 0xffff0000, v71
  v_fmac_f32 v4, v8, v9
  v_lshlrev_b32 v8, 16, v40
  v_lshlrev_b32 v9, 16, v72
  v_fmac_f32 v4, v8, v9
  v_and_b32 v8, 0xffff0000, v40
  v_and_b32 v9, 0xffff0000, v72
  v_fmac_f32 v4, v8, v9
  v_lshlrev_b32 v8, 16, v41
  v_lshlrev_b32 v9, 16, v73
  v_fmac_f32 v4, v8, v9
  v_and_b32 v8, 0xffff0000, v41
  v_and_b32 v9, 0xffff0000, v73
  v_fmac_f32 v4, v8, v9
  v_lshlrev_b32 v8, 16, v42
  v_lshlrev_b32 v9, 16, v74
  v_fmac_f32 v4, v8, v9
  v_and_b32 v8, 0xffff0000, v42
  v_and_b32 v9, 0xffff0000, v74
  v_fmac_f32 v4, v8, v9
  v_lshlrev_b32 v8, 16, v43
  v_lshlrev_b32 v9, 16, v75
  v_fmac_f32 v4, v8, v9
  v_and_b32 v8, 0xffff0000, v43
  v_and_b32 v9, 0xffff0000, v75
  v_fmac_f32 v4, v8, v9
  v_lshlrev_b32 v8, 16, v44
  v_lshlrev_b32 v9, 16, v76
  v_fmac_f32 v4, v8, v9
  v_and_b32 v8, 0xffff0000, v44
  v_and_b32 v9, 0xffff0000, v76
  v_fmac_f32 v4, v8, v9
  v_lshlrev_b32 v8, 16, v45
  v_lshlrev_b32 v9, 16, v77
  v_fmac_f32 v4, v8, v9
  v_and_b32 v8, 0xffff0000, v45
  v_and_b32 v9, 0xffff0000, v77
  v_fmac_f32 v4, v8, v9
  v_lshlrev_b32 v8, 16, v46
  v_lshlrev_b32 v9, 16, v78
  v_fmac_f32 v4, v8, v9
  v_and_b32 v8, 0xffff0000, v46
  v_and_b32 v9, 0xffff0000, v78
  v_fmac_f32 v4, v8, v9
  v_lshlrev_b32 v8, 16, v47
  v_lshlrev_b32 v9, 16, v79
  v_fmac_f32 v4, v8, v9
  v_and_b32 v8, 0xffff0000, v47
  v_and_b32 v9, 0xffff0000, v79
  v_fmac_f32 v4, v8, v9
  buffer_load_dwordx4 v[16:19], v5, s[8:11], 0 offen offset:256
  buffer_load_dwordx4 v[48:51], v6, s[12:15], 0 offen offset:256
  buffer_load_dwordx4 v[20:23], v5, s[8:11], 0 offen offset:272
  buffer_load_dwordx4 v[52:55], v6, s[12:15], 0 offen offset:272
  buffer_load_dwordx4 v[24:27], v5, s[8:11], 0 offen offset:288
  buffer_load_dwordx4 v[56:59], v6, s[12:15], 0 offen offset:288
  buffer_load_dwordx4 v[28:31], v5, s[8:11], 0 offen offset:304
  buffer_load_dwordx4 v[60:63], v6, s[12:15], 0 offen offset:304
  buffer_load_dwordx4 v[32:35], v5, s[8:11], 0 offen offset:320
  buffer_load_dwordx4 v[64:67], v6, s[12:15], 0 offen offset:320
  buffer_load_dwordx4 v[36:39], v5, s[8:11], 0 offen offset:336
  buffer_load_dwordx4 v[68:71], v6, s[12:15], 0 offen offset:336
  buffer_load_dwordx4 v[40:43], v5, s[8:11], 0 offen offset:352
  buffer_load_dwordx4 v[72:75], v6, s[12:15], 0 offen offset:352
  buffer_load_dwordx4 v[44:47], v5, s[8:11], 0 offen offset:368
  buffer_load_dwordx4 v[76:79], v6, s[12:15], 0 offen offset:368
  s_waitcnt vmcnt(0)
  v_lshlrev_b32 v8, 16, v16
  v_lshlrev_b32 v9, 16, v48
  v_fmac_f32 v4, v8, v9
  v_and_b32 v8, 0xffff0000, v16
  v_and_b32 v9, 0xffff0000, v48
  v_fmac_f32 v4, v8, v9
  v_lshlrev_b32 v8, 16, v17
  v_lshlrev_b32 v9, 16, v49
  v_fmac_f32 v4, v8, v9
  v_and_b32 v8, 0xffff0000, v17
  v_and_b32 v9, 0xffff0000, v49
  v_fmac_f32 v4, v8, v9
  v_lshlrev_b32 v8, 16, v18
  v_lshlrev_b32 v9, 16, v50
  v_fmac_f32 v4, v8, v9
  v_and_b32 v8, 0xffff0000, v18
  v_and_b32 v9, 0xffff0000, v50
  v_fmac_f32 v4, v8, v9
  v_lshlrev_b32 v8, 16, v19
  v_lshlrev_b32 v9, 16, v51
  v_fmac_f32 v4, v8, v9
  v_and_b32 v8, 0xffff0000, v19
  v_and_b32 v9, 0xffff0000, v51
  v_fmac_f32 v4, v8, v9
  v_lshlrev_b32 v8, 16, v20
  v_lshlrev_b32 v9, 16, v52
  v_fmac_f32 v4, v8, v9
  v_and_b32 v8, 0xffff0000, v20
  v_and_b32 v9, 0xffff0000, v52
  v_fmac_f32 v4, v8, v9
  v_lshlrev_b32 v8, 16, v21
  v_lshlrev_b32 v9, 16, v53
  v_fmac_f32 v4, v8, v9
  v_and_b32 v8, 0xffff0000, v21
  v_and_b32 v9, 0xffff0000, v53
  v_fmac_f32 v4, v8, v9
  v_lshlrev_b32 v8, 16, v22
  v_lshlrev_b32 v9, 16, v54
  v_fmac_f32 v4, v8, v9
  v_and_b32 v8, 0xffff0000, v22
  v_and_b32 v9, 0xffff0000, v54
  v_fmac_f32 v4, v8, v9
  v_lshlrev_b32 v8, 16, v23
  v_lshlrev_b32 v9, 16, v55
  v_fmac_f32 v4, v8, v9
  v_and_b32 v8, 0xffff0000, v23
  v_and_b32 v9, 0xffff0000, v55
  v_fmac_f32 v4, v8, v9
  v_lshlrev_b32 v8, 16, v24
  v_lshlrev_b32 v9, 16, v56
  v_fmac_f32 v4, v8, v9
  v_and_b32 v8, 0xffff0000, v24
  v_and_b32 v9, 0xffff0000, v56
  v_fmac_f32 v4, v8, v9
  v_lshlrev_b32 v8, 16, v25
  v_lshlrev_b32 v9, 16, v57
  v_fmac_f32 v4, v8, v9
  v_and_b32 v8, 0xffff0000, v25
  v_and_b32 v9, 0xffff0000, v57
  v_fmac_f32 v4, v8, v9
  v_lshlrev_b32 v8, 16, v26
  v_lshlrev_b32 v9, 16, v58
  v_fmac_f32 v4, v8, v9
  v_and_b32 v8, 0xffff0000, v26
  v_and_b32 v9, 0xffff0000, v58
  v_fmac_f32 v4, v8, v9
  v_lshlrev_b32 v8, 16, v27
  v_lshlrev_b32 v9, 16, v59
  v_fmac_f32 v4, v8, v9
  v_and_b32 v8, 0xffff0000, v27
  v_and_b32 v9, 0xffff0000, v59
  v_fmac_f32 v4, v8, v9
  v_lshlrev_b32 v8, 16, v28
  v_lshlrev_b32 v9, 16, v60
  v_fmac_f32 v4, v8, v9
  v_and_b32 v8, 0xffff0000, v28
  v_and_b32 v9, 0xffff0000, v60
  v_fmac_f32 v4, v8, v9
  v_lshlrev_b32 v8, 16, v29
  v_lshlrev_b32 v9, 16, v61
  v_fmac_f32 v4, v8, v9
  v_and_b32 v8, 0xffff0000, v29
  v_and_b32 v9, 0xffff0000, v61
  v_fmac_f32 v4, v8, v9
  v_lshlrev_b32 v8, 16, v30
  v_lshlrev_b32 v9, 16, v62
  v_fmac_f32 v4, v8, v9
  v_and_b32 v8, 0xffff0000, v30
  v_and_b32 v9, 0xffff0000, v62
  v_fmac_f32 v4, v8, v9
  v_lshlrev_b32 v8, 16, v31
  v_lshlrev_b32 v9, 16, v63
  v_fmac_f32 v4, v8, v9
  v_and_b32 v8, 0xffff0000, v31
  v_and_b32 v9, 0xffff0000, v63
  v_fmac_f32 v4, v8, v9
  v_lshlrev_b32 v8, 16, v32
  v_lshlrev_b32 v9, 16, v64
  v_fmac_f32 v4, v8, v9
  v_and_b32 v8, 0xffff0000, v32
  v_and_b32 v9, 0xffff0000, v64
  v_fmac_f32 v4, v8, v9
  v_lshlrev_b32 v8, 16, v33
  v_lshlrev_b32 v9, 16, v65
  v_fmac_f32 v4, v8, v9
  v_and_b32 v8, 0xffff0000, v33
  v_and_b32 v9, 0xffff0000, v65
  v_fmac_f32 v4, v8, v9
  v_lshlrev_b32 v8, 16, v34
  v_lshlrev_b32 v9, 16, v66
  v_fmac_f32 v4, v8, v9
  v_and_b32 v8, 0xffff0000, v34
  v_and_b32 v9, 0xffff0000, v66
  v_fmac_f32 v4, v8, v9
  v_lshlrev_b32 v8, 16, v35
  v_lshlrev_b32 v9, 16, v67
  v_fmac_f32 v4, v8, v9
  v_and_b32 v8, 0xffff0000, v35
  v_and_b32 v9, 0xffff0000, v67
  v_fmac_f32 v4, v8, v9
  v_lshlrev_b32 v8, 16, v36
  v_lshlrev_b32 v9, 16, v68
  v_fmac_f32 v4, v8, v9
  v_and_b32 v8, 0xffff0000, v36
  v_and_b32 v9, 0xffff0000, v68
  v_fmac_f32 v4, v8, v9
  v_lshlrev_b32 v8, 16, v37
  v_lshlrev_b32 v9, 16, v69
  v_fmac_f32 v4, v8, v9
  v_and_b32 v8, 0xffff0000, v37
  v_and_b32 v9, 0xffff0000, v69
  v_fmac_f32 v4, v8, v9
  v_lshlrev_b32 v8, 16, v38
  v_lshlrev_b32 v9, 16, v70
  v_fmac_f32 v4, v8, v9
  v_and_b32 v8, 0xffff0000, v38
  v_and_b32 v9, 0xffff0000, v70
  v_fmac_f32 v4, v8, v9
  v_lshlrev_b32 v8, 16, v39
  v_lshlrev_b32 v9, 16, v71
  v_fmac_f32 v4, v8, v9
  v_and_b32 v8, 0xffff0000, v39
  v_and_b32 v9, 0xffff0000, v71
  v_fmac_f32 v4, v8, v9
  v_lshlrev_b32 v8, 16, v40
  v_lshlrev_b32 v9, 16, v72
  v_fmac_f32 v4, v8, v9
  v_and_b32 v8, 0xffff0000, v40
  v_and_b32 v9, 0xffff0000, v72
  v_fmac_f32 v4, v8, v9
  v_lshlrev_b32 v8, 16, v41
  v_lshlrev_b32 v9, 16, v73
  v_fmac_f32 v4, v8, v9
  v_and_b32 v8, 0xffff0000, v41
  v_and_b32 v9, 0xffff0000, v73
  v_fmac_f32 v4, v8, v9
  v_lshlrev_b32 v8, 16, v42
  v_lshlrev_b32 v9, 16, v74
  v_fmac_f32 v4, v8, v9
  v_and_b32 v8, 0xffff0000, v42
  v_and_b32 v9, 0xffff0000, v74
  v_fmac_f32 v4, v8, v9
  v_lshlrev_b32 v8, 16, v43
  v_lshlrev_b32 v9, 16, v75
  v_fmac_f32 v4, v8, v9
  v_and_b32 v8, 0xffff0000, v43
  v_and_b32 v9, 0xffff0000, v75
  v_fmac_f32 v4, v8, v9
  v_lshlrev_b32 v8, 16, v44
  v_lshlrev_b32 v9, 16, v76
  v_fmac_f32 v4, v8, v9
  v_and_b32 v8, 0xffff0000, v44
  v_and_b32 v9, 0xffff0000, v76
  v_fmac_f32 v4, v8, v9
  v_lshlrev_b32 v8, 16, v45
  v_lshlrev_b32 v9, 16, v77
  v_fmac_f32 v4, v8, v9
  v_and_b32 v8, 0xffff0000, v45
  v_and_b32 v9, 0xffff0000, v77
  v_fmac_f32 v4, v8, v9
  v_lshlrev_b32 v8, 16, v46
  v_lshlrev_b32 v9, 16, v78
  v_fmac_f32 v4, v8, v9
  v_and_b32 v8, 0xffff0000, v46
  v_and_b32 v9, 0xffff0000, v78
  v_fmac_f32 v4, v8, v9
  v_lshlrev_b32 v8, 16, v47
  v_lshlrev_b32 v9, 16, v79
  v_fmac_f32 v4, v8, v9
  v_and_b32 v8, 0xffff0000, v47
  v_and_b32 v9, 0xffff0000, v79
  v_fmac_f32 v4, v8, v9
  buffer_load_dwordx4 v[16:19], v5, s[8:11], 0 offen offset:384
  buffer_load_dwordx4 v[48:51], v6, s[12:15], 0 offen offset:384
  buffer_load_dwordx4 v[20:23], v5, s[8:11], 0 offen offset:400
  buffer_load_dwordx4 v[52:55], v6, s[12:15], 0 offen offset:400
  buffer_load_dwordx4 v[24:27], v5, s[8:11], 0 offen offset:416
  buffer_load_dwordx4 v[56:59], v6, s[12:15], 0 offen offset:416
  buffer_load_dwordx4 v[28:31], v5, s[8:11], 0 offen offset:432
  buffer_load_dwordx4 v[60:63], v6, s[12:15], 0 offen offset:432
  buffer_load_dwordx4 v[32:35], v5, s[8:11], 0 offen offset:448
  buffer_load_dwordx4 v[64:67], v6, s[12:15], 0 offen offset:448
  buffer_load_dwordx4 v[36:39], v5, s[8:11], 0 offen offset:464
  buffer_load_dwordx4 v[68:71], v6, s[12:15], 0 offen offset:464
  buffer_load_dwordx4 v[40:43], v5, s[8:11], 0 offen offset:480
  buffer_load_dwordx4 v[72:75], v6, s[12:15], 0 offen offset:480
  buffer_load_dwordx4 v[44:47], v5, s[8:11], 0 offen offset:496
  buffer_load_dwordx4 v[76:79], v6, s[12:15], 0 offen offset:496
  s_waitcnt vmcnt(0)
  v_lshlrev_b32 v8, 16, v16
  v_lshlrev_b32 v9, 16, v48
  v_fmac_f32 v4, v8, v9
  v_and_b32 v8, 0xffff0000, v16
  v_and_b32 v9, 0xffff0000, v48
  v_fmac_f32 v4, v8, v9
  v_lshlrev_b32 v8, 16, v17
  v_lshlrev_b32 v9, 16, v49
  v_fmac_f32 v4, v8, v9
  v_and_b32 v8, 0xffff0000, v17
  v_and_b32 v9, 0xffff0000, v49
  v_fmac_f32 v4, v8, v9
  v_lshlrev_b32 v8, 16, v18
  v_lshlrev_b32 v9, 16, v50
  v_fmac_f32 v4, v8, v9
  v_and_b32 v8, 0xffff0000, v18
  v_and_b32 v9, 0xffff0000, v50
  v_fmac_f32 v4, v8, v9
  v_lshlrev_b32 v8, 16, v19
  v_lshlrev_b32 v9, 16, v51
  v_fmac_f32 v4, v8, v9
  v_and_b32 v8, 0xffff0000, v19
  v_and_b32 v9, 0xffff0000, v51
  v_fmac_f32 v4, v8, v9
  v_lshlrev_b32 v8, 16, v20
  v_lshlrev_b32 v9, 16, v52
  v_fmac_f32 v4, v8, v9
  v_and_b32 v8, 0xffff0000, v20
  v_and_b32 v9, 0xffff0000, v52
  v_fmac_f32 v4, v8, v9
  v_lshlrev_b32 v8, 16, v21
  v_lshlrev_b32 v9, 16, v53
  v_fmac_f32 v4, v8, v9
  v_and_b32 v8, 0xffff0000, v21
  v_and_b32 v9, 0xffff0000, v53
  v_fmac_f32 v4, v8, v9
  v_lshlrev_b32 v8, 16, v22
  v_lshlrev_b32 v9, 16, v54
  v_fmac_f32 v4, v8, v9
  v_and_b32 v8, 0xffff0000, v22
  v_and_b32 v9, 0xffff0000, v54
  v_fmac_f32 v4, v8, v9
  v_lshlrev_b32 v8, 16, v23
  v_lshlrev_b32 v9, 16, v55
  v_fmac_f32 v4, v8, v9
  v_and_b32 v8, 0xffff0000, v23
  v_and_b32 v9, 0xffff0000, v55
  v_fmac_f32 v4, v8, v9
  v_lshlrev_b32 v8, 16, v24
  v_lshlrev_b32 v9, 16, v56
  v_fmac_f32 v4, v8, v9
  v_and_b32 v8, 0xffff0000, v24
  v_and_b32 v9, 0xffff0000, v56
  v_fmac_f32 v4, v8, v9
  v_lshlrev_b32 v8, 16, v25
  v_lshlrev_b32 v9, 16, v57
  v_fmac_f32 v4, v8, v9
  v_and_b32 v8, 0xffff0000, v25
  v_and_b32 v9, 0xffff0000, v57
  v_fmac_f32 v4, v8, v9
  v_lshlrev_b32 v8, 16, v26
  v_lshlrev_b32 v9, 16, v58
  v_fmac_f32 v4, v8, v9
  v_and_b32 v8, 0xffff0000, v26
  v_and_b32 v9, 0xffff0000, v58
  v_fmac_f32 v4, v8, v9
  v_lshlrev_b32 v8, 16, v27
  v_lshlrev_b32 v9, 16, v59
  v_fmac_f32 v4, v8, v9
  v_and_b32 v8, 0xffff0000, v27
  v_and_b32 v9, 0xffff0000, v59
  v_fmac_f32 v4, v8, v9
  v_lshlrev_b32 v8, 16, v28
  v_lshlrev_b32 v9, 16, v60
  v_fmac_f32 v4, v8, v9
  v_and_b32 v8, 0xffff0000, v28
  v_and_b32 v9, 0xffff0000, v60
  v_fmac_f32 v4, v8, v9
  v_lshlrev_b32 v8, 16, v29
  v_lshlrev_b32 v9, 16, v61
  v_fmac_f32 v4, v8, v9
  v_and_b32 v8, 0xffff0000, v29
  v_and_b32 v9, 0xffff0000, v61
  v_fmac_f32 v4, v8, v9
  v_lshlrev_b32 v8, 16, v30
  v_lshlrev_b32 v9, 16, v62
  v_fmac_f32 v4, v8, v9
  v_and_b32 v8, 0xffff0000, v30
  v_and_b32 v9, 0xffff0000, v62
  v_fmac_f32 v4, v8, v9
  v_lshlrev_b32 v8, 16, v31
  v_lshlrev_b32 v9, 16, v63
  v_fmac_f32 v4, v8, v9
  v_and_b32 v8, 0xffff0000, v31
  v_and_b32 v9, 0xffff0000, v63
  v_fmac_f32 v4, v8, v9
  v_lshlrev_b32 v8, 16, v32
  v_lshlrev_b32 v9, 16, v64
  v_fmac_f32 v4, v8, v9
  v_and_b32 v8, 0xffff0000, v32
  v_and_b32 v9, 0xffff0000, v64
  v_fmac_f32 v4, v8, v9
  v_lshlrev_b32 v8, 16, v33
  v_lshlrev_b32 v9, 16, v65
  v_fmac_f32 v4, v8, v9
  v_and_b32 v8, 0xffff0000, v33
  v_and_b32 v9, 0xffff0000, v65
  v_fmac_f32 v4, v8, v9
  v_lshlrev_b32 v8, 16, v34
  v_lshlrev_b32 v9, 16, v66
  v_fmac_f32 v4, v8, v9
  v_and_b32 v8, 0xffff0000, v34
  v_and_b32 v9, 0xffff0000, v66
  v_fmac_f32 v4, v8, v9
  v_lshlrev_b32 v8, 16, v35
  v_lshlrev_b32 v9, 16, v67
  v_fmac_f32 v4, v8, v9
  v_and_b32 v8, 0xffff0000, v35
  v_and_b32 v9, 0xffff0000, v67
  v_fmac_f32 v4, v8, v9
  v_lshlrev_b32 v8, 16, v36
  v_lshlrev_b32 v9, 16, v68
  v_fmac_f32 v4, v8, v9
  v_and_b32 v8, 0xffff0000, v36
  v_and_b32 v9, 0xffff0000, v68
  v_fmac_f32 v4, v8, v9
  v_lshlrev_b32 v8, 16, v37
  v_lshlrev_b32 v9, 16, v69
  v_fmac_f32 v4, v8, v9
  v_and_b32 v8, 0xffff0000, v37
  v_and_b32 v9, 0xffff0000, v69
  v_fmac_f32 v4, v8, v9
  v_lshlrev_b32 v8, 16, v38
  v_lshlrev_b32 v9, 16, v70
  v_fmac_f32 v4, v8, v9
  v_and_b32 v8, 0xffff0000, v38
  v_and_b32 v9, 0xffff0000, v70
  v_fmac_f32 v4, v8, v9
  v_lshlrev_b32 v8, 16, v39
  v_lshlrev_b32 v9, 16, v71
  v_fmac_f32 v4, v8, v9
  v_and_b32 v8, 0xffff0000, v39
  v_and_b32 v9, 0xffff0000, v71
  v_fmac_f32 v4, v8, v9
  v_lshlrev_b32 v8, 16, v40
  v_lshlrev_b32 v9, 16, v72
  v_fmac_f32 v4, v8, v9
  v_and_b32 v8, 0xffff0000, v40
  v_and_b32 v9, 0xffff0000, v72
  v_fmac_f32 v4, v8, v9
  v_lshlrev_b32 v8, 16, v41
  v_lshlrev_b32 v9, 16, v73
  v_fmac_f32 v4, v8, v9
  v_and_b32 v8, 0xffff0000, v41
  v_and_b32 v9, 0xffff0000, v73
  v_fmac_f32 v4, v8, v9
  v_lshlrev_b32 v8, 16, v42
  v_lshlrev_b32 v9, 16, v74
  v_fmac_f32 v4, v8, v9
  v_and_b32 v8, 0xffff0000, v42
  v_and_b32 v9, 0xffff0000, v74
  v_fmac_f32 v4, v8, v9
  v_lshlrev_b32 v8, 16, v43
  v_lshlrev_b32 v9, 16, v75
  v_fmac_f32 v4, v8, v9
  v_and_b32 v8, 0xffff0000, v43
  v_and_b32 v9, 0xffff0000, v75
  v_fmac_f32 v4, v8, v9
  v_lshlrev_b32 v8, 16, v44
  v_lshlrev_b32 v9, 16, v76
  v_fmac_f32 v4, v8, v9
  v_and_b32 v8, 0xffff0000, v44
  v_and_b32 v9, 0xffff0000, v76
  v_fmac_f32 v4, v8, v9
  v_lshlrev_b32 v8, 16, v45
  v_lshlrev_b32 v9, 16, v77
  v_fmac_f32 v4, v8, v9
  v_and_b32 v8, 0xffff0000, v45
  v_and_b32 v9, 0xffff0000, v77
  v_fmac_f32 v4, v8, v9
  v_lshlrev_b32 v8, 16, v46
  v_lshlrev_b32 v9, 16, v78
  v_fmac_f32 v4, v8, v9
  v_and_b32 v8, 0xffff0000, v46
  v_and_b32 v9, 0xffff0000, v78
  v_fmac_f32 v4, v8, v9
  v_lshlrev_b32 v8, 16, v47
  v_lshlrev_b32 v9, 16, v79
  v_fmac_f32 v4, v8, v9
  v_and_b32 v8, 0xffff0000, v47
  v_and_b32 v9, 0xffff0000, v79
  v_fmac_f32 v4, v8, v9
  buffer_load_dwordx4 v[16:19], v5, s[8:11], 0 offen offset:512
  buffer_load_dwordx4 v[48:51], v6, s[12:15], 0 offen offset:512
  buffer_load_dwordx4 v[20:23], v5, s[8:11], 0 offen offset:528
  buffer_load_dwordx4 v[52:55], v6, s[12:15], 0 offen offset:528
  buffer_load_dwordx4 v[24:27], v5, s[8:11], 0 offen offset:544
  buffer_load_dwordx4 v[56:59], v6, s[12:15], 0 offen offset:544
  buffer_load_dwordx4 v[28:31], v5, s[8:11], 0 offen offset:560
  buffer_load_dwordx4 v[60:63], v6, s[12:15], 0 offen offset:560
  buffer_load_dwordx4 v[32:35], v5, s[8:11], 0 offen offset:576
  buffer_load_dwordx4 v[64:67], v6, s[12:15], 0 offen offset:576
  buffer_load_dwordx4 v[36:39], v5, s[8:11], 0 offen offset:592
  buffer_load_dwordx4 v[68:71], v6, s[12:15], 0 offen offset:592
  buffer_load_dwordx4 v[40:43], v5, s[8:11], 0 offen offset:608
  buffer_load_dwordx4 v[72:75], v6, s[12:15], 0 offen offset:608
  buffer_load_dwordx4 v[44:47], v5, s[8:11], 0 offen offset:624
  buffer_load_dwordx4 v[76:79], v6, s[12:15], 0 offen offset:624
  s_waitcnt vmcnt(0)
  v_lshlrev_b32 v8, 16, v16
  v_lshlrev_b32 v9, 16, v48
  v_fmac_f32 v4, v8, v9
  v_and_b32 v8, 0xffff0000, v16
  v_and_b32 v9, 0xffff0000, v48
  v_fmac_f32 v4, v8, v9
  v_lshlrev_b32 v8, 16, v17
  v_lshlrev_b32 v9, 16, v49
  v_fmac_f32 v4, v8, v9
  v_and_b32 v8, 0xffff0000, v17
  v_and_b32 v9, 0xffff0000, v49
  v_fmac_f32 v4, v8, v9
  v_lshlrev_b32 v8, 16, v18
  v_lshlrev_b32 v9, 16, v50
  v_fmac_f32 v4, v8, v9
  v_and_b32 v8, 0xffff0000, v18
  v_and_b32 v9, 0xffff0000, v50
  v_fmac_f32 v4, v8, v9
  v_lshlrev_b32 v8, 16, v19
  v_lshlrev_b32 v9, 16, v51
  v_fmac_f32 v4, v8, v9
  v_and_b32 v8, 0xffff0000, v19
  v_and_b32 v9, 0xffff0000, v51
  v_fmac_f32 v4, v8, v9
  v_lshlrev_b32 v8, 16, v20
  v_lshlrev_b32 v9, 16, v52
  v_fmac_f32 v4, v8, v9
  v_and_b32 v8, 0xffff0000, v20
  v_and_b32 v9, 0xffff0000, v52
  v_fmac_f32 v4, v8, v9
  v_lshlrev_b32 v8, 16, v21
  v_lshlrev_b32 v9, 16, v53
  v_fmac_f32 v4, v8, v9
  v_and_b32 v8, 0xffff0000, v21
  v_and_b32 v9, 0xffff0000, v53
  v_fmac_f32 v4, v8, v9
  v_lshlrev_b32 v8, 16, v22
  v_lshlrev_b32 v9, 16, v54
  v_fmac_f32 v4, v8, v9
  v_and_b32 v8, 0xffff0000, v22
  v_and_b32 v9, 0xffff0000, v54
  v_fmac_f32 v4, v8, v9
  v_lshlrev_b32 v8, 16, v23
  v_lshlrev_b32 v9, 16, v55
  v_fmac_f32 v4, v8, v9
  v_and_b32 v8, 0xffff0000, v23
  v_and_b32 v9, 0xffff0000, v55
  v_fmac_f32 v4, v8, v9
  v_lshlrev_b32 v8, 16, v24
  v_lshlrev_b32 v9, 16, v56
  v_fmac_f32 v4, v8, v9
  v_and_b32 v8, 0xffff0000, v24
  v_and_b32 v9, 0xffff0000, v56
  v_fmac_f32 v4, v8, v9
  v_lshlrev_b32 v8, 16, v25
  v_lshlrev_b32 v9, 16, v57
  v_fmac_f32 v4, v8, v9
  v_and_b32 v8, 0xffff0000, v25
  v_and_b32 v9, 0xffff0000, v57
  v_fmac_f32 v4, v8, v9
  v_lshlrev_b32 v8, 16, v26
  v_lshlrev_b32 v9, 16, v58
  v_fmac_f32 v4, v8, v9
  v_and_b32 v8, 0xffff0000, v26
  v_and_b32 v9, 0xffff0000, v58
  v_fmac_f32 v4, v8, v9
  v_lshlrev_b32 v8, 16, v27
  v_lshlrev_b32 v9, 16, v59
  v_fmac_f32 v4, v8, v9
  v_and_b32 v8, 0xffff0000, v27
  v_and_b32 v9, 0xffff0000, v59
  v_fmac_f32 v4, v8, v9
  v_lshlrev_b32 v8, 16, v28
  v_lshlrev_b32 v9, 16, v60
  v_fmac_f32 v4, v8, v9
  v_and_b32 v8, 0xffff0000, v28
  v_and_b32 v9, 0xffff0000, v60
  v_fmac_f32 v4, v8, v9
  v_lshlrev_b32 v8, 16, v29
  v_lshlrev_b32 v9, 16, v61
  v_fmac_f32 v4, v8, v9
  v_and_b32 v8, 0xffff0000, v29
  v_and_b32 v9, 0xffff0000, v61
  v_fmac_f32 v4, v8, v9
  v_lshlrev_b32 v8, 16, v30
  v_lshlrev_b32 v9, 16, v62
  v_fmac_f32 v4, v8, v9
  v_and_b32 v8, 0xffff0000, v30
  v_and_b32 v9, 0xffff0000, v62
  v_fmac_f32 v4, v8, v9
  v_lshlrev_b32 v8, 16, v31
  v_lshlrev_b32 v9, 16, v63
  v_fmac_f32 v4, v8, v9
  v_and_b32 v8, 0xffff0000, v31
  v_and_b32 v9, 0xffff0000, v63
  v_fmac_f32 v4, v8, v9
  v_lshlrev_b32 v8, 16, v32
  v_lshlrev_b32 v9, 16, v64
  v_fmac_f32 v4, v8, v9
  v_and_b32 v8, 0xffff0000, v32
  v_and_b32 v9, 0xffff0000, v64
  v_fmac_f32 v4, v8, v9
  v_lshlrev_b32 v8, 16, v33
  v_lshlrev_b32 v9, 16, v65
  v_fmac_f32 v4, v8, v9
  v_and_b32 v8, 0xffff0000, v33
  v_and_b32 v9, 0xffff0000, v65
  v_fmac_f32 v4, v8, v9
  v_lshlrev_b32 v8, 16, v34
  v_lshlrev_b32 v9, 16, v66
  v_fmac_f32 v4, v8, v9
  v_and_b32 v8, 0xffff0000, v34
  v_and_b32 v9, 0xffff0000, v66
  v_fmac_f32 v4, v8, v9
  v_lshlrev_b32 v8, 16, v35
  v_lshlrev_b32 v9, 16, v67
  v_fmac_f32 v4, v8, v9
  v_and_b32 v8, 0xffff0000, v35
  v_and_b32 v9, 0xffff0000, v67
  v_fmac_f32 v4, v8, v9
  v_lshlrev_b32 v8, 16, v36
  v_lshlrev_b32 v9, 16, v68
  v_fmac_f32 v4, v8, v9
  v_and_b32 v8, 0xffff0000, v36
  v_and_b32 v9, 0xffff0000, v68
  v_fmac_f32 v4, v8, v9
  v_lshlrev_b32 v8, 16, v37
  v_lshlrev_b32 v9, 16, v69
  v_fmac_f32 v4, v8, v9
  v_and_b32 v8, 0xffff0000, v37
  v_and_b32 v9, 0xffff0000, v69
  v_fmac_f32 v4, v8, v9
  v_lshlrev_b32 v8, 16, v38
  v_lshlrev_b32 v9, 16, v70
  v_fmac_f32 v4, v8, v9
  v_and_b32 v8, 0xffff0000, v38
  v_and_b32 v9, 0xffff0000, v70
  v_fmac_f32 v4, v8, v9
  v_lshlrev_b32 v8, 16, v39
  v_lshlrev_b32 v9, 16, v71
  v_fmac_f32 v4, v8, v9
  v_and_b32 v8, 0xffff0000, v39
  v_and_b32 v9, 0xffff0000, v71
  v_fmac_f32 v4, v8, v9
  v_lshlrev_b32 v8, 16, v40
  v_lshlrev_b32 v9, 16, v72
  v_fmac_f32 v4, v8, v9
  v_and_b32 v8, 0xffff0000, v40
  v_and_b32 v9, 0xffff0000, v72
  v_fmac_f32 v4, v8, v9
  v_lshlrev_b32 v8, 16, v41
  v_lshlrev_b32 v9, 16, v73
  v_fmac_f32 v4, v8, v9
  v_and_b32 v8, 0xffff0000, v41
  v_and_b32 v9, 0xffff0000, v73
  v_fmac_f32 v4, v8, v9
  v_lshlrev_b32 v8, 16, v42
  v_lshlrev_b32 v9, 16, v74
  v_fmac_f32 v4, v8, v9
  v_and_b32 v8, 0xffff0000, v42
  v_and_b32 v9, 0xffff0000, v74
  v_fmac_f32 v4, v8, v9
  v_lshlrev_b32 v8, 16, v43
  v_lshlrev_b32 v9, 16, v75
  v_fmac_f32 v4, v8, v9
  v_and_b32 v8, 0xffff0000, v43
  v_and_b32 v9, 0xffff0000, v75
  v_fmac_f32 v4, v8, v9
  v_lshlrev_b32 v8, 16, v44
  v_lshlrev_b32 v9, 16, v76
  v_fmac_f32 v4, v8, v9
  v_and_b32 v8, 0xffff0000, v44
  v_and_b32 v9, 0xffff0000, v76
  v_fmac_f32 v4, v8, v9
  v_lshlrev_b32 v8, 16, v45
  v_lshlrev_b32 v9, 16, v77
  v_fmac_f32 v4, v8, v9
  v_and_b32 v8, 0xffff0000, v45
  v_and_b32 v9, 0xffff0000, v77
  v_fmac_f32 v4, v8, v9
  v_lshlrev_b32 v8, 16, v46
  v_lshlrev_b32 v9, 16, v78
  v_fmac_f32 v4, v8, v9
  v_and_b32 v8, 0xffff0000, v46
  v_and_b32 v9, 0xffff0000, v78
  v_fmac_f32 v4, v8, v9
  v_lshlrev_b32 v8, 16, v47
  v_lshlrev_b32 v9, 16, v79
  v_fmac_f32 v4, v8, v9
  v_and_b32 v8, 0xffff0000, v47
  v_and_b32 v9, 0xffff0000, v79
  v_fmac_f32 v4, v8, v9
  s_nop 1
  v_mov_b32_dpp v8, v4 quad_perm:[1,0,3,2] row_mask:0xf bank_mask:0xf
  v_add_f32 v4, v4, v8
  v_mul_f32 v8, 0xbfb8aa3b, v4
  v_exp_f32 v8, v8
  s_nop 0
  v_add_f32 v8, 1.0, v8
  v_rcp_f32 v8, v8
  v_lshlrev_b32 v9, 2, v3
  s_mov_b32 s62, 98566144
  buffer_store_dword v8, v9, s[4:7], s62 offen sc1
  s_waitcnt vmcnt(0)
  s_barrier
  s_cmp_eq_u32 s32, 0
  s_cbranch_scc0 GA_done
  s_lshl_b32 s60, s98, 7
  s_add_u32 s60, s60, 1900544
  s_mov_b32 s61, 1
  v_mov_b32 v8, s61
  v_add_u32 v8, s3, v8
  v_mov_b32 v9, 0
  s_mov_b64 exec, 1
  buffer_store_dword v8, v9, s[4:7], s60 offen sc1
  s_mov_b64 exec, -1
GA_done:
  s_waitcnt vmcnt(0)
  s_barrier
K_a_final:
  s_cmp_lt_u32 s34, 15
  s_cbranch_scc0 K_fin
  s_sub_u32 s60, s33, 4
  s_mul_i32 s97, s60, 15
  s_add_u32 s97, s97, s34
  s_mul_i32 s40, s97, 21846
  s_lshr_b32 s40, s40, 16
  s_mul_i32 s41, s40, 3
  s_sub_u32 s41, s97, s41
  v_lshrrev_b32 v104, 2, v0
  v_mul_u32_u24 v108, 1280, v104
  v_and_b32 v105, 3, v0
  v_lshl_add_u32 v108, v105, 4, v108
  v_lshrrev_b32 v104, 5, v0
  v_bfe_u32 v105, v0, 2, 2
  v_lshl_add_u32 v104, v104, 2, v105
  v_lshlrev_b32 v109, 6, v104
  v_bfe_u32 v105, v0, 4, 1
  v_lshl_add_u32 v109, v105, 5, v109
  v_and_b32 v105, 3, v0
  v_lshl_add_u32 v109, v105, 3, v109
  s_lshl_b32 s63, s32, 13
  v_add_u32 v109, s63, v109
  s_load_dwordx2 s[12:13], s[0:1], 40
  s_mov_b32 s14, 5242880
  s_mov_b32 s15, 0x20000
  s_waitcnt lgkmcnt(0)
  s_mul_i32 s60, s32, 1310720
  s_lshl_b32 s61, s40, 6
  s_add_u32 s60, s60, s61
  s_add_u32 m0, s63, 0
  s_nop 0
  buffer_load_dwordx4 v108, s[12:15], s60 offen lds
  s_add_u32 s60, s60, 20480
  s_add_u32 m0, s63, 1024
  s_nop 0
  buffer_load_dwordx4 v108, s[12:15], s60 offen lds
  s_add_u32 s60, s60, 20480
  s_add_u32 m0, s63, 2048
  s_nop 0
  buffer_load_dwordx4 v108, s[12:15], s60 offen lds
  s_add_u32 s60, s60, 20480
  s_add_u32 m0, s63, 3072
  s_nop 0
  buffer_load_dwordx4 v108, s[12:15], s60 offen lds
  s_add_u32 s60, s60, 20480
  s_add_u32 m0, s63, 4096
  s_nop 0
  buffer_load_dwordx4 v108, s[12:15], s60 offen lds
  s_add_u32 s60, s60, 20480
  s_add_u32 m0, s63, 5120
  s_nop 0
  buffer_load_dwordx4 v108, s[12:15], s60 offen lds
  s_add_u32 s60, s60, 20480
  s_add_u32 m0, s63, 6144
  s_nop 0
  buffer_load_dwordx4 v108, s[12:15], s60 offen lds
  s_add_u32 s60, s60, 20480
  s_add_u32 m0, s63, 7168
  s_nop 0
  buffer_load_dwordx4 v108, s[12:15], s60 offen lds
  s_add_u32 s60, s60, 20480
  s_waitcnt vmcnt(0)
  ds_read_b64_tr_b16 a[0:1], v109 offset:0
  ds_read_b64_tr_b16 a[2:3], v109 offset:512
  ds_read_b64_tr_b16 a[4:5], v109 offset:1024
  ds_read_b64_tr_b16 a[6:7], v109 offset:1536
  ds_read_b64_tr_b16 a[8:9], v109 offset:2048
  ds_read_b64_tr_b16 a[10:11], v109 offset:2560
  ds_read_b64_tr_b16 a[12:13], v109 offset:3072
  ds_read_b64_tr_b16 a[14:15], v109 offset:3584
  s_waitcnt lgkmcnt(0)
  ds_read_b64_tr_b16 a[16:17], v109 offset:4096
  ds_read_b64_tr_b16 a[18:19], v109 offset:4608
  ds_read_b64_tr_b16 a[20:21], v109 offset:5120
  ds_read_b64_tr_b16 a[22:23], v109 offset:5632
  ds_read_b64_tr_b16 a[24:25], v109 offset:6144
  ds_read_b64_tr_b16 a[26:27], v109 offset:6656
  ds_read_b64_tr_b16 a[28:29], v109 offset:7168
  ds_read_b64_tr_b16 a[30:31], v109 offset:7680
  s_waitcnt lgkmcnt(0)
  s_waitcnt lgkmcnt(0)
  s_add_u32 m0, s63, 0
  s_nop 0
  buffer_load_dwordx4 v108, s[12:15], s60 offen lds
  s_add_u32 s60, s60, 20480
  s_add_u32 m0, s63, 1024
  s_nop 0
  buffer_load_dwordx4 v108, s[12:15], s60 offen lds
  s_add_u32 s60, s60, 20480
  s_add_u32 m0, s63, 2048
  s_nop 0
  buffer_load_dwordx4 v108, s[12:15], s60 offen lds
  s_add_u32 s60, s60, 20480
  s_add_u32 m0, s63, 3072
  s_nop 0
  buffer_load_dwordx4 v108, s[12:15], s60 offen lds
  s_add_u32 s60, s60, 20480
  s_add_u32 m0, s63, 4096
  s_nop 0
  buffer_load_dwordx4 v108, s[12:15], s60 offen lds
  s_add_u32 s60, s60, 20480
  s_add_u32 m0, s63, 5120
  s_nop 0
  buffer_load_dwordx4 v108, s[12:15], s60 offen lds
  s_add_u32 s60, s60, 20480
  s_add_u32 m0, s63, 6144
  s_nop 0
  buffer_load_dwordx4 v108, s[12:15], s60 offen lds
  s_add_u32 s60, s60, 20480
  s_add_u32 m0, s63, 7168
  s_nop 0
  buffer_load_dwordx4 v108, s[12:15], s60 offen lds
  s_add_u32 s60, s60, 20480
  s_waitcnt vmcnt(0)
  ds_read_b64_tr_b16 a[32:33], v109 offset:0
  ds_read_b64_tr_b16 a[34:35], v109 offset:512
  ds_read_b64_tr_b16 a[36:37], v109 offset:1024
  ds_read_b64_tr_b16 a[38:39], v109 offset:1536
  ds_read_b64_tr_b16 a[40:41], v109 offset:2048
  ds_read_b64_tr_b16 a[42:43], v109 offset:2560
  ds_read_b64_tr_b16 a[44:45], v109 offset:3072
  ds_read_b64_tr_b16 a[46:47], v109 offset:3584
  s_waitcnt lgkmcnt(0)
  ds_read_b64_tr_b16 a[48:49], v109 offset:4096
  ds_read_b64_tr_b16 a[50:51], v109 offset:4608
  ds_read_b64_tr_b16 a[52:53], v109 offset:5120
  ds_read_b64_tr_b16 a[54:55], v109 offset:5632
  ds_read_b64_tr_b16 a[56:57], v109 offset:6144
  ds_read_b64_tr_b16 a[58:59], v109 offset:6656
  ds_read_b64_tr_b16 a[60:61], v109 offset:7168
  ds_read_b64_tr_b16 a[62:63], v109 offset:7680
  s_waitcnt lgkmcnt(0)
  s_waitcnt lgkmcnt(0)
  s_add_u32 m0, s63, 0
  s_nop 0
  buffer_load_dwordx4 v108, s[12:15], s60 offen lds
  s_add_u32 s60, s60, 20480
  s_add_u32 m0, s63, 1024
  s_nop 0
  buffer_load_dwordx4 v108, s[12:15], s60 offen lds
  s_add_u32 s60, s60, 20480
  s_add_u32 m0, s63, 2048
  s_nop 0
  buffer_load_dwordx4 v108, s[12:15], s60 offen lds
  s_add_u32 s60, s60, 20480
  s_add_u32 m0, s63, 3072
  s_nop 0
  buffer_load_dwordx4 v108, s[12:15], s60 offen lds
  s_add_u32 s60, s60, 20480
  s_add_u32 m0, s63, 4096
  s_nop 0
  buffer_load_dwordx4 v108, s[12:15], s60 offen lds
  s_add_u32 s60, s60, 20480
  s_add_u32 m0, s63, 5120
  s_nop 0
  buffer_load_dwordx4 v108, s[12:15], s60 offen lds
  s_add_u32 s60, s60, 20480
  s_add_u32 m0, s63, 6144
  s_nop 0
  buffer_load_dwordx4 v108, s[12:15], s60 offen lds
  s_add_u32 s60, s60, 20480
  s_add_u32 m0, s63, 7168
  s_nop 0
  buffer_load_dwordx4 v108, s[12:15], s60 offen lds
  s_add_u32 s60, s60, 20480
  s_waitcnt vmcnt(0)
  ds_read_b64_tr_b16 a[64:65], v109 offset:0
  ds_read_b64_tr_b16 a[66:67], v109 offset:512
  ds_read_b64_tr_b16 a[68:69], v109 offset:1024
  ds_read_b64_tr_b16 a[70:71], v109 offset:1536
  ds_read_b64_tr_b16 a[72:73], v109 offset:2048
  ds_read_b64_tr_b16 a[74:75], v109 offset:2560
  ds_read_b64_tr_b16 a[76:77], v109 offset:3072
  ds_read_b64_tr_b16 a[78:79], v109 offset:3584
  s_waitcnt lgkmcnt(0)
  ds_read_b64_tr_b16 a[80:81], v109 offset:4096
  ds_read_b64_tr_b16 a[82:83], v109 offset:4608
  ds_read_b64_tr_b16 a[84:85], v109 offset:5120
  ds_read_b64_tr_b16 a[86:87], v109 offset:5632
  ds_read_b64_tr_b16 a[88:89], v109 offset:6144
  ds_read_b64_tr_b16 a[90:91], v109 offset:6656
  ds_read_b64_tr_b16 a[92:93], v109 offset:7168
  ds_read_b64_tr_b16 a[94:95], v109 offset:7680
  s_waitcnt lgkmcnt(0)
  s_waitcnt lgkmcnt(0)
  s_add_u32 m0, s63, 0
  s_nop 0
  buffer_load_dwordx4 v108, s[12:15], s60 offen lds
  s_add_u32 s60, s60, 20480
  s_add_u32 m0, s63, 1024
  s_nop 0
  buffer_load_dwordx4 v108, s[12:15], s60 offen lds
  s_add_u32 s60, s60, 20480
  s_add_u32 m0, s63, 2048
  s_nop 0
  buffer_load_dwordx4 v108, s[12:15], s60 offen lds
  s_add_u32 s60, s60, 20480
  s_add_u32 m0, s63, 3072
  s_nop 0
  buffer_load_dwordx4 v108, s[12:15], s60 offen lds
  s_add_u32 s60, s60, 20480
  s_add_u32 m0, s63, 4096
  s_nop 0
  buffer_load_dwordx4 v108, s[12:15], s60 offen lds
  s_add_u32 s60, s60, 20480
  s_add_u32 m0, s63, 5120
  s_nop 0
  buffer_load_dwordx4 v108, s[12:15], s60 offen lds
  s_add_u32 s60, s60, 20480
  s_add_u32 m0, s63, 6144
  s_nop 0
  buffer_load_dwordx4 v108, s[12:15], s60 offen lds
  s_add_u32 s60, s60, 20480
  s_add_u32 m0, s63, 7168
  s_nop 0
  buffer_load_dwordx4 v108, s[12:15], s60 offen lds
  s_add_u32 s60, s60, 20480
  s_waitcnt vmcnt(0)
  ds_read_b64_tr_b16 a[96:97], v109 offset:0
  ds_read_b64_tr_b16 a[98:99], v109 offset:512
  ds_read_b64_tr_b16 a[100:101], v109 offset:1024
  ds_read_b64_tr_b16 a[102:103], v109 offset:1536
  ds_read_b64_tr_b16 a[104:105], v109 offset:2048
  ds_read_b64_tr_b16 a[106:107], v109 offset:2560
  ds_read_b64_tr_b16 a[108:109], v109 offset:3072
  ds_read_b64_tr_b16 a[110:111], v109 offset:3584
  s_waitcnt lgkmcnt(0)
  ds_read_b64_tr_b16 a[112:113], v109 offset:4096
  ds_read_b64_tr_b16 a[114:115], v109 offset:4608
  ds_read_b64_tr_b16 a[116:117], v109 offset:5120
  ds_read_b64_tr_b16 a[118:119], v109 offset:5632
  ds_read_b64_tr_b16 a[120:121], v109 offset:6144
  ds_read_b64_tr_b16 a[122:123], v109 offset:6656
  ds_read_b64_tr_b16 a[124:125], v109 offset:7168
  ds_read_b64_tr_b16 a[126:127], v109 offset:7680
  s_waitcnt lgkmcnt(0)
  s_waitcnt lgkmcnt(0)
  s_add_u32 m0, s63, 0
  s_nop 0
  buffer_load_dwordx4 v108, s[12:15], s60 offen lds
  s_add_u32 s60, s60, 20480
  s_add_u32 m0, s63, 1024
  s_nop 0
  buffer_load_dwordx4 v108, s[12:15], s60 offen lds
  s_add_u32 s60, s60, 20480
  s_add_u32 m0, s63, 2048
  s_nop 0
  buffer_load_dwordx4 v108, s[12:15], s60 offen lds
  s_add_u32 s60, s60, 20480
  s_add_u32 m0, s63, 3072
  s_nop 0
  buffer_load_dwordx4 v108, s[12:15], s60 offen lds
  s_add_u32 s60, s60, 20480
  s_add_u32 m0, s63, 4096
  s_nop 0
  buffer_load_dwordx4 v108, s[12:15], s60 offen lds
  s_add_u32 s60, s60, 20480
  s_add_u32 m0, s63, 5120
  s_nop 0
  buffer_load_dwordx4 v108, s[12:15], s60 offen lds
  s_add_u32 s60, s60, 20480
  s_add_u32 m0, s63, 6144
  s_nop 0
  buffer_load_dwordx4 v108, s[12:15], s60 offen lds
  s_add_u32 s60, s60, 20480
  s_add_u32 m0, s63, 7168
  s_nop 0
  buffer_load_dwordx4 v108, s[12:15], s60 offen lds
  s_add_u32 s60, s60, 20480
  s_waitcnt vmcnt(0)
  ds_read_b64_tr_b16 a[128:129], v109 offset:0
  ds_read_b64_tr_b16 a[130:131], v109 offset:512
  ds_read_b64_tr_b16 a[132:133], v109 offset:1024
  ds_read_b64_tr_b16 a[134:135], v109 offset:1536
  ds_read_b64_tr_b16 a[136:137], v109 offset:2048
  ds_read_b64_tr_b16 a[138:139], v109 offset:2560
  ds_read_b64_tr_b16 a[140:141], v109 offset:3072
  ds_read_b64_tr_b16 a[142:143], v109 offset:3584
  s_waitcnt lgkmcnt(0)
  ds_read_b64_tr_b16 a[144:145], v109 offset:4096
  ds_read_b64_tr_b16 a[146:147], v109 offset:4608
  ds_read_b64_tr_b16 a[148:149], v109 offset:5120
  ds_read_b64_tr_b16 a[150:151], v109 offset:5632
  ds_read_b64_tr_b16 a[152:153], v109 offset:6144
  ds_read_b64_tr_b16 a[154:155], v109 offset:6656
  ds_read_b64_tr_b16 a[156:157], v109 offset:7168
  ds_read_b64_tr_b16 a[158:159], v109 offset:7680
  s_waitcnt lgkmcnt(0)
  s_waitcnt lgkmcnt(0)
  s_add_u32 m0, s63, 0
  s_nop 0
  buffer_load_dwordx4 v108, s[12:15], s60 offen lds
  s_add_u32 s60, s60, 20480
  s_add_u32 m0, s63, 1024
  s_nop 0
  buffer_load_dwordx4 v108, s[12:15], s60 offen lds
  s_add_u32 s60, s60, 20480
  s_add_u32 m0, s63, 2048
  s_nop 0
  buffer_load_dwordx4 v108, s[12:15], s60 offen lds
  s_add_u32 s60, s60, 20480
  s_add_u32 m0, s63, 3072
  s_nop 0
  buffer_load_dwordx4 v108, s[12:15], s60 offen lds
  s_add_u32 s60, s60, 20480
  s_add_u32 m0, s63, 4096
  s_nop 0
  buffer_load_dwordx4 v108, s[12:15], s60 offen lds
  s_add_u32 s60, s60, 20480
  s_add_u32 m0, s63, 5120
  s_nop 0
  buffer_load_dwordx4 v108, s[12:15], s60 offen lds
  s_add_u32 s60, s60, 20480
  s_add_u32 m0, s63, 6144
  s_nop 0
  buffer_load_dwordx4 v108, s[12:15], s60 offen lds
  s_add_u32 s60, s60, 20480
  s_add_u32 m0, s63, 7168
  s_nop 0
  buffer_load_dwordx4 v108, s[12:15], s60 offen lds
  s_add_u32 s60, s60, 20480
  s_waitcnt vmcnt(0)
  ds_read_b64_tr_b16 a[160:161], v109 offset:0
  ds_read_b64_tr_b16 a[162:163], v109 offset:512
  ds_read_b64_tr_b16 a[164:165], v109 offset:1024
  ds_read_b64_tr_b16 a[166:167], v109 offset:1536
  ds_read_b64_tr_b16 a[168:169], v109 offset:2048
  ds_read_b64_tr_b16 a[170:171], v109 offset:2560
  ds_read_b64_tr_b16 a[172:173], v109 offset:3072
  ds_read_b64_tr_b16 a[174:175], v109 offset:3584
  s_waitcnt lgkmcnt(0)
  ds_read_b64_tr_b16 a[176:177], v109 offset:4096
  ds_read_b64_tr_b16 a[178:179], v109 offset:4608
  ds_read_b64_tr_b16 a[180:181], v109 offset:5120
  ds_read_b64_tr_b16 a[182:183], v109 offset:5632
  ds_read_b64_tr_b16 a[184:185], v109 offset:6144
  ds_read_b64_tr_b16 a[186:187], v109 offset:6656
  ds_read_b64_tr_b16 a[188:189], v109 offset:7168
  ds_read_b64_tr_b16 a[190:191], v109 offset:7680
  s_waitcnt lgkmcnt(0)
  s_waitcnt lgkmcnt(0)
  s_add_u32 m0, s63, 0
  s_nop 0
  buffer_load_dwordx4 v108, s[12:15], s60 offen lds
  s_add_u32 s60, s60, 20480
  s_add_u32 m0, s63, 1024
  s_nop 0
  buffer_load_dwordx4 v108, s[12:15], s60 offen lds
  s_add_u32 s60, s60, 20480
  s_add_u32 m0, s63, 2048
  s_nop 0
  buffer_load_dwordx4 v108, s[12:15], s60 offen lds
  s_add_u32 s60, s60, 20480
  s_add_u32 m0, s63, 3072
  s_nop 0
  buffer_load_dwordx4 v108, s[12:15], s60 offen lds
  s_add_u32 s60, s60, 20480
  s_add_u32 m0, s63, 4096
  s_nop 0
  buffer_load_dwordx4 v108, s[12:15], s60 offen lds
  s_add_u32 s60, s60, 20480
  s_add_u32 m0, s63, 5120
  s_nop 0
  buffer_load_dwordx4 v108, s[12:15], s60 offen lds
  s_add_u32 s60, s60, 20480
  s_add_u32 m0, s63, 6144
  s_nop 0
  buffer_load_dwordx4 v108, s[12:15], s60 offen lds
  s_add_u32 s60, s60, 20480
  s_add_u32 m0, s63, 7168
  s_nop 0
  buffer_load_dwordx4 v108, s[12:15], s60 offen lds
  s_add_u32 s60, s60, 20480
  s_waitcnt vmcnt(0)
  ds_read_b64_tr_b16 a[192:193], v109 offset:0
  ds_read_b64_tr_b16 a[194:195], v109 offset:512
  ds_read_b64_tr_b16 a[196:197], v109 offset:1024
  ds_read_b64_tr_b16 a[198:199], v109 offset:1536
  ds_read_b64_tr_b16 a[200:201], v109 offset:2048
  ds_read_b64_tr_b16 a[202:203], v109 offset:2560
  ds_read_b64_tr_b16 a[204:205], v109 offset:3072
  ds_read_b64_tr_b16 a[206:207], v109 offset:3584
  s_waitcnt lgkmcnt(0)
  ds_read_b64_tr_b16 a[208:209], v109 offset:4096
  ds_read_b64_tr_b16 a[210:211], v109 offset:4608
  ds_read_b64_tr_b16 a[212:213], v109 offset:5120
  ds_read_b64_tr_b16 a[214:215], v109 offset:5632
  ds_read_b64_tr_b16 a[216:217], v109 offset:6144
  ds_read_b64_tr_b16 a[218:219], v109 offset:6656
  ds_read_b64_tr_b16 a[220:221], v109 offset:7168
  ds_read_b64_tr_b16 a[222:223], v109 offset:7680
  s_waitcnt lgkmcnt(0)
  s_waitcnt lgkmcnt(0)
  s_add_u32 m0, s63, 0
  s_nop 0
  buffer_load_dwordx4 v108, s[12:15], s60 offen lds
  s_add_u32 s60, s60, 20480
  s_add_u32 m0, s63, 1024
  s_nop 0
  buffer_load_dwordx4 v108, s[12:15], s60 offen lds
  s_add_u32 s60, s60, 20480
  s_add_u32 m0, s63, 2048
  s_nop 0
  buffer_load_dwordx4 v108, s[12:15], s60 offen lds
  s_add_u32 s60, s60, 20480
  s_add_u32 m0, s63, 3072
  s_nop 0
  buffer_load_dwordx4 v108, s[12:15], s60 offen lds
  s_add_u32 s60, s60, 20480
  s_add_u32 m0, s63, 4096
  s_nop 0
  buffer_load_dwordx4 v108, s[12:15], s60 offen lds
  s_add_u32 s60, s60, 20480
  s_add_u32 m0, s63, 5120
  s_nop 0
  buffer_load_dwordx4 v108, s[12:15], s60 offen lds
  s_add_u32 s60, s60, 20480
  s_add_u32 m0, s63, 6144
  s_nop 0
  buffer_load_dwordx4 v108, s[12:15], s60 offen lds
  s_add_u32 s60, s60, 20480
  s_add_u32 m0, s63, 7168
  s_nop 0
  buffer_load_dwordx4 v108, s[12:15], s60 offen lds
  s_add_u32 s60, s60, 20480
  s_waitcnt vmcnt(0)
  ds_read_b64_tr_b16 a[224:225], v109 offset:0
  ds_read_b64_tr_b16 a[226:227], v109 offset:512
  ds_read_b64_tr_b16 a[228:229], v109 offset:1024
  ds_read_b64_tr_b16 a[230:231], v109 offset:1536
  ds_read_b64_tr_b16 a[232:233], v109 offset:2048
  ds_read_b64_tr_b16 a[234:235], v109 offset:2560
  ds_read_b64_tr_b16 a[236:237], v109 offset:3072
  ds_read_b64_tr_b16 a[238:239], v109 offset:3584
  s_waitcnt lgkmcnt(0)
  ds_read_b64_tr_b16 a[240:241], v109 offset:4096
  ds_read_b64_tr_b16 a[242:243], v109 offset:4608
  ds_read_b64_tr_b16 a[244:245], v109 offset:5120
  ds_read_b64_tr_b16 a[246:247], v109 offset:5632
  ds_read_b64_tr_b16 a[248:249], v109 offset:6144
  ds_read_b64_tr_b16 a[250:251], v109 offset:6656
  ds_read_b64_tr_b16 a[252:253], v109 offset:7168
  ds_read_b64_tr_b16 a[254:255], v109 offset:7680
  s_waitcnt lgkmcnt(0)
  s_waitcnt lgkmcnt(0)
  s_load_dwordx2 s[12:13], s[0:1], 72
  s_mov_b32 s14, 819200
  s_mov_b32 s15, 0x20000
  s_waitcnt lgkmcnt(0)
  s_mul_i32 s60, s32, 204800
  s_add_u32 s60, s60, s61
  s_add_u32 m0, s63, 0
  s_nop 0
  buffer_load_dwordx4 v108, s[12:15], s60 offen lds
  s_add_u32 s60, s60, 20480
  s_add_u32 m0, s63, 1024
  s_nop 0
  buffer_load_dwordx4 v108, s[12:15], s60 offen lds
  s_add_u32 s60, s60, 20480
  s_add_u32 m0, s63, 2048
  s_nop 0
  buffer_load_dwordx4 v108, s[12:15], s60 offen lds
  s_add_u32 s60, s60, 20480
  s_add_u32 m0, s63, 3072
  s_nop 0
  buffer_load_dwordx4 v108, s[12:15], s60 offen lds
  s_add_u32 s60, s60, 20480
  s_add_u32 m0, s63, 4096
  s_nop 0
  buffer_load_dwordx4 v108, s[12:15], s60 offen lds
  s_add_u32 s60, s60, 20480
  s_add_u32 m0, s63, 5120
  s_nop 0
  buffer_load_dwordx4 v108, s[12:15], s60 offen lds
  s_add_u32 s60, s60, 20480
  s_add_u32 m0, s63, 6144
  s_nop 0
  buffer_load_dwordx4 v108, s[12:15], s60 offen lds
  s_add_u32 s60, s60, 20480
  s_add_u32 m0, s63, 7168
  s_nop 0
  buffer_load_dwordx4 v108, s[12:15], s60 offen lds
  s_add_u32 s60, s60, 20480
  s_waitcnt vmcnt(0)
  ds_read_b64_tr_b16 v[200:201], v109 offset:0
  ds_read_b64_tr_b16 v[202:203], v109 offset:512
  ds_read_b64_tr_b16 v[204:205], v109 offset:1024
  ds_read_b64_tr_b16 v[206:207], v109 offset:1536
  ds_read_b64_tr_b16 v[208:209], v109 offset:2048
  ds_read_b64_tr_b16 v[210:211], v109 offset:2560
  ds_read_b64_tr_b16 v[212:213], v109 offset:3072
  ds_read_b64_tr_b16 v[214:215], v109 offset:3584
  s_waitcnt lgkmcnt(0)
  ds_read_b64_tr_b16 v[216:217], v109 offset:4096
  ds_read_b64_tr_b16 v[218:219], v109 offset:4608
  ds_read_b64_tr_b16 v[220:221], v109 offset:5120
  ds_read_b64_tr_b16 v[222:223], v109 offset:5632
  ds_read_b64_tr_b16 v[224:225], v109 offset:6144
  ds_read_b64_tr_b16 v[226:227], v109 offset:6656
  ds_read_b64_tr_b16 v[228:229], v109 offset:7168
  ds_read_b64_tr_b16 v[230:231], v109 offset:7680
  s_waitcnt lgkmcnt(0)
  s_waitcnt lgkmcnt(0)
  s_add_u32 m0, s63, 0
  s_nop 0
  buffer_load_dwordx4 v108, s[12:15], s60 offen lds
  s_add_u32 s60, s60, 20480
  s_add_u32 m0, s63, 1024
  s_nop 0
  buffer_load_dwordx4 v108, s[12:15], s60 offen lds
  s_add_u32 s60, s60, 20480
  s_waitcnt vmcnt(0)
  ds_read_b64_tr_b16 v[232:233], v109 offset:0
  ds_read_b64_tr_b16 v[234:235], v109 offset:512
  ds_read_b64_tr_b16 v[236:237], v109 offset:1024
  ds_read_b64_tr_b16 v[238:239], v109 offset:1536
  s_waitcnt lgkmcnt(0)
  s_load_dwordx2 s[8:9], s[0:1], 88
  s_mov_b32 s10, 2621440
  s_mov_b32 s11, 0x20000
  v_lshlrev_b32 v2, 4, v0
  s_lshl_b32 s60, s32, 12
  s_add_u32 s60, s60, 32768
  v_add_u32 v5, s60, v2
  s_lshl_b32 s60, s32, 10
  s_add_u32 s60, s60, 32768
  v_add_u32 v4, s60, v2
  v_and_b32 v104, 31, v0
  v_mul_u32_u24 v6, 1280, v104
  v_lshrrev_b32 v105, 5, v0
  v_lshl_add_u32 v6, v105, 3, v6
  s_lshl_b32 s60, s40, 6
  s_lshl_b32 s61, s32, 4
  s_add_u32 s60, s60, s61
  v_add_u32 v6, s60, v6
  s_waitcnt lgkmcnt(0)
  v_lshlrev_b32 v104, 7, v0
  v_add_u32 v104, 1900544, v104
  s_mov_b32 s62, 1
  s_add_u32 s62, s62, s3
  s_mov_b32 s59, 0
  s_mov_b64 exec, 0xffff
FI_g_w:
  buffer_load_dword v105, v104, s[4:7], 0 offen sc1
  s_waitcnt vmcnt(0)
  v_subrev_u32 v105, s62, v105
  v_cmp_lt_u32 vcc, 0x7f, v105
  s_cbranch_vccz FI_g_d
  s_sleep 2
  s_add_u32 s59, s59, 4
  s_cmp_lt_u32 s59, s56
  s_cbranch_scc1 FI_g_w
  s_mov_b32 s56, 0
FI_g_d:
  s_mov_b64 exec, -1
  s_mov_b32 s42, s41
FI_seg:
  s_lshl_b32 s60, s42, 7
  s_add_u32 s60, s60, 1875968
  v_mov_b32 v104, s60
  s_mov_b32 s62, 1
  s_add_u32 s62, s62, s3
  s_mov_b32 s59, 0
  s_mov_b64 exec, 1
FI_b_w:
  buffer_load_dword v105, v104, s[4:7], 0 offen sc1
  s_waitcnt vmcnt(0)
  v_subrev_u32 v105, s62, v105
  v_cmp_lt_u32 vcc, 0x7f, v105
  s_cbranch_vccz FI_b_d
  s_sleep 2
  s_add_u32 s59, s59, 4
  s_cmp_lt_u32 s59, s56
  s_cbranch_scc1 FI_b_w
  s_mov_b32 s56, 0
FI_b_d:
  s_mov_b64 exec, -1
  s_mul_i32 s44, s42, 40960
  s_mul_i32 s60, s32, 10240
  s_add_u32 s44, s44, s60
  s_add_u32 s44, s44, 94371840
  buffer_load_dwordx4 v[40:43], v2, s[4:7], s44 offen offset:0 sc1
  buffer_load_dwordx4 v[44:47], v2, s[4:7], s44 offen offset:1024 sc1
  buffer_load_dwordx4 v[48:51], v2, s[4:7], s44 offen offset:2048 sc1
  buffer_load_dwordx4 v[52:55], v2, s[4:7], s44 offen offset:3072 sc1
  s_add_u32 s44, s44, 4096
  buffer_load_dwordx4 v[56:59], v2, s[4:7], s44 offen offset:0 sc1
  buffer_load_dwordx4 v[60:63], v2, s[4:7], s44 offen offset:1024 sc1
  buffer_load_dwordx4 v[64:67], v2, s[4:7], s44 offen offset:2048 sc1
  buffer_load_dwordx4 v[68:71], v2, s[4:7], s44 offen offset:3072 sc1
  s_add_u32 s44, s44, 4096
  buffer_load_dwordx4 v[72:75], v2, s[4:7], s44 offen offset:0 sc1
  buffer_load_dwordx4 v[76:79], v2, s[4:7], s44 offen offset:1024 sc1
  s_lshl_b32 s60, s42, 7
  s_add_u32 s60, s60, 98566144
  v_and_b32 v104, 31, v0
  v_lshlrev_b32 v104, 2, v104
  buffer_load_dword v3, v104, s[4:7], s60 offen sc1
  s_waitcnt vmcnt(10)
  v_mfma_f32_32x32x16_bf16 v[24:39], v[200:203], v[40:43], 0
  s_waitcnt vmcnt(9)
  v_mfma_f32_32x32x16_bf16 v[24:39], v[204:207], v[44:47], v[24:39]
  s_waitcnt vmcnt(8)
  v_mfma_f32_32x32x16_bf16 v[24:39], v[208:211], v[48:51], v[24:39]
  s_waitcnt vmcnt(7)
  v_mfma_f32_32x32x16_bf16 v[24:39], v[212:215], v[52:55], v[24:39]
  s_waitcnt vmcnt(6)
  v_mfma_f32_32x32x16_bf16 v[24:39], v[216:219], v[56:59], v[24:39]
  s_waitcnt vmcnt(5)
  v_mfma_f32_32x32x16_bf16 v[24:39], v[220:223], v[60:63], v[24:39]
  s_waitcnt vmcnt(4)
  v_mfma_f32_32x32x16_bf16 v[24:39], v[224:227], v[64:67], v[24:39]
  s_waitcnt vmcnt(3)
  v_mfma_f32_32x32x16_bf16 v[24:39], v[228:231], v[68:71], v[24:39]
  s_waitcnt vmcnt(2)
  v_mfma_f32_32x32x16_bf16 v[24:39], v[232:235], v[72:75], v[24:39]
  s_waitcnt vmcnt(1)
  v_mfma_f32_32x32x16_bf16 v[24:39], v[236:239], v[76:79], v[24:39]
  s_waitcnt vmcnt(0)
  s_and_b32 s60, s42, 3
  s_lshl_b32 s60, s60, 7
  s_lshl_b32 s61, s32, 12
  s_add_u32 s60, s60, s61
  s_add_u32 s60, s60, 1884160
  v_lshlrev_b32 v104, 9, v0
  v_add_u32 v104, s60, v104
  s_lshr_b32 s62, s42, 2
  s_add_u32 s62, s62, 1
  s_add_u32 s62, s62, s3
  s_mov_b32 s59, 0
  s_mov_b64 exec, 0xff
FI_x_w:
  buffer_load_dword v105, v104, s[4:7], 0 offen sc1
  s_waitcnt vmcnt(0)
  v_subrev_u32 v105, s62, v105
  v_cmp_lt_u32 vcc, 0x7f, v105
  s_cbranch_vccz FI_x_d
  s_sleep 1
  s_add_u32 s59, s59, 4
  s_cmp_lt_u32 s59, s56
  s_cbranch_scc1 FI_x_w
  s_mov_b32 s56, 0
FI_x_d:
  s_mov_b64 exec, -1
  s_lshl_b32 s43, s42, 18
  s_lshl_b32 s60, s32, 16
  s_add_u32 s43, s43, s60
  s_add_u32 s43, s43, 60817408
  buffer_load_dwordx4 v[40:43], v2, s[4:7], s43 offen offset:0 sc1
  buffer_load_dwordx4 v[44:47], v2, s[4:7], s43 offen offset:1024 sc1
  buffer_load_dwordx4 v[48:51], v2, s[4:7], s43 offen offset:2048 sc1
  buffer_load_dwordx4 v[52:55], v2, s[4:7], s43 offen offset:3072 sc1
  s_add_u32 s43, s43, 4096
  buffer_load_dwordx4 v[56:59], v2, s[4:7], s43 offen offset:0 sc1
  buffer_load_dwordx4 v[60:63], v2, s[4:7], s43 offen offset:1024 sc1
  buffer_load_dwordx4 v[64:67], v2, s[4:7], s43 offen offset:2048 sc1
  buffer_load_dwordx4 v[68:71], v2, s[4:7], s43 offen offset:3072 sc1
  s_add_u32 s43, s43, 4096
  buffer_load_dwordx4 v[72:75], v2, s[4:7], s43 offen offset:0 sc1
  buffer_load_dwordx4 v[76:79], v2, s[4:7], s43 offen offset:1024 sc1
  buffer_load_dwordx4 v[80:83], v2, s[4:7], s43 offen offset:2048 sc1
  buffer_load_dwordx4 v[84:87], v2, s[4:7], s43 offen offset:3072 sc1
  s_add_u32 s43, s43, 4096
  buffer_load_dwordx4 v[88:91], v2, s[4:7], s43 offen offset:0 sc1
  buffer_load_dwordx4 v[92:95], v2, s[4:7], s43 offen offset:1024 sc1
  buffer_load_dwordx4 v[96:99], v2, s[4:7], s43 offen offset:2048 sc1
  buffer_load_dwordx4 v[100:103], v2, s[4:7], s43 offen offset:3072 sc1
  s_waitcnt vmcnt(15)
  v_mfma_f32_32x32x16_bf16 v[8:23], a[0:3], v[40:43], 0
  s_add_u32 s43, s43, 4096
  buffer_load_dwordx4 v[40:43], v2, s[4:7], s43 offen offset:0 sc1
  s_waitcnt vmcnt(15)
  v_mfma_f32_32x32x16_bf16 v[8:23], a[4:7], v[44:47], v[8:23]
  buffer_load_dwordx4 v[44:47], v2, s[4:7], s43 offen offset:1024 sc1
  s_waitcnt vmcnt(15)
  v_mfma_f32_32x32x16_bf16 v[8:23], a[8:11], v[48:51], v[8:23]
  buffer_load_dwordx4 v[48:51], v2, s[4:7], s43 offen offset:2048 sc1
  s_waitcnt vmcnt(15)
  v_mfma_f32_32x32x16_bf16 v[8:23], a[12:15], v[52:55], v[8:23]
  buffer_load_dwordx4 v[52:55], v2, s[4:7], s43 offen offset:3072 sc1
  s_waitcnt vmcnt(15)
  v_mfma_f32_32x32x16_bf16 v[8:23], a[16:19], v[56:59], v[8:23]
  s_add_u32 s43, s43, 4096
  buffer_load_dwordx4 v[56:59], v2, s[4:7], s43 offen offset:0 sc1
  s_waitcnt vmcnt(15)
  v_mfma_f32_32x32x16_bf16 v[8:23], a[20:23], v[60:63], v[8:23]
  buffer_load_dwordx4 v[60:63], v2, s[4:7], s43 offen offset:1024 sc1
  s_waitcnt vmcnt(15)
  v_mfma_f32_32x32x16_bf16 v[8:23], a[24:27], v[64:67], v[8:23]
  buffer_load_dwordx4 v[64:67], v2, s[4:7], s43 offen offset:2048 sc1
  s_waitcnt vmcnt(15)
  v_mfma_f32_32x32x16_bf16 v[8:23], a[28:31], v[68:71], v[8:23]
  buffer_load_dwordx4 v[68:71], v2, s[4:7], s43 offen offset:3072 sc1
  s_waitcnt vmcnt(15)
  v_mfma_f32_32x32x16_bf16 v[8:23], a[32:35], v[72:75], v[8:23]
  s_add_u32 s43, s43, 4096
  buffer_load_dwordx4 v[72:75], v2, s[4:7], s43 offen offset:0 sc1
  s_waitcnt vmcnt(15)
  v_mfma_f32_32x32x16_bf16 v[8:23], a[36:39], v[76:79], v[8:23]
  buffer_load_dwordx4 v[76:79], v2, s[4:7], s43 offen offset:1024 sc1
  s_waitcnt vmcnt(15)
  v_mfma_f32_32x32x16_bf16 v[8:23], a[40:43], v[80:83], v[8:23]
  buffer_load_dwordx4 v[80:83], v2, s[4:7], s43 offen offset:2048 sc1
  s_waitcnt vmcnt(15)
  v_mfma_f32_32x32x16_bf16 v[8:23], a[44:47], v[84:87], v[8:23]
  buffer_load_dwordx4 v[84:87], v2, s[4:7], s43 offen offset:3072 sc1
  s_waitcnt vmcnt(15)
  v_mfma_f32_32x32x16_bf16 v[8:23], a[48:51], v[88:91], v[8:23]
  s_add_u32 s43, s43, 4096
  buffer_load_dwordx4 v[88:91], v2, s[4:7], s43 offen offset:0 sc1
  s_waitcnt vmcnt(15)
  v_mfma_f32_32x32x16_bf16 v[8:23], a[52:55], v[92:95], v[8:23]
  buffer_load_dwordx4 v[92:95], v2, s[4:7], s43 offen offset:1024 sc1
  s_waitcnt vmcnt(15)
  v_mfma_f32_32x32x16_bf16 v[8:23], a[56:59], v[96:99], v[8:23]
  buffer_load_dwordx4 v[96:99], v2, s[4:7], s43 offen offset:2048 sc1
  s_waitcnt vmcnt(15)
  v_mfma_f32_32x32x16_bf16 v[8:23], a[60:63], v[100:103], v[8:23]
  buffer_load_dwordx4 v[100:103], v2, s[4:7], s43 offen offset:3072 sc1
  s_waitcnt vmcnt(15)
  v_mfma_f32_32x32x16_bf16 v[8:23], a[64:67], v[40:43], v[8:23]
  s_add_u32 s43, s43, 4096
  buffer_load_dwordx4 v[40:43], v2, s[4:7], s43 offen offset:0 sc1
  s_waitcnt vmcnt(15)
  v_mfma_f32_32x32x16_bf16 v[8:23], a[68:71], v[44:47], v[8:23]
  buffer_load_dwordx4 v[44:47], v2, s[4:7], s43 offen offset:1024 sc1
  s_waitcnt vmcnt(15)
  v_mfma_f32_32x32x16_bf16 v[8:23], a[72:75], v[48:51], v[8:23]
  buffer_load_dwordx4 v[48:51], v2, s[4:7], s43 offen offset:2048 sc1
  s_waitcnt vmcnt(15)
  v_mfma_f32_32x32x16_bf16 v[8:23], a[76:79], v[52:55], v[8:23]
  buffer_load_dwordx4 v[52:55], v2, s[4:7], s43 offen offset:3072 sc1
  s_waitcnt vmcnt(15)
  v_mfma_f32_32x32x16_bf16 v[8:23], a[80:83], v[56:59], v[8:23]
  s_add_u32 s43, s43, 4096
  buffer_load_dwordx4 v[56:59], v2, s[4:7], s43 offen offset:0 sc1
  s_waitcnt vmcnt(15)
  v_mfma_f32_32x32x16_bf16 v[8:23], a[84:87], v[60:63], v[8:23]
  buffer_load_dwordx4 v[60:63], v2, s[4:7], s43 offen offset:1024 sc1
  s_waitcnt vmcnt(15)
  v_mfma_f32_32x32x16_bf16 v[8:23], a[88:91], v[64:67], v[8:23]
  buffer_load_dwordx4 v[64:67], v2, s[4:7], s43 offen offset:2048 sc1
  s_waitcnt vmcnt(15)
  v_mfma_f32_32x32x16_bf16 v[8:23], a[92:95], v[68:71], v[8:23]
  buffer_load_dwordx4 v[68:71], v2, s[4:7], s43 offen offset:3072 sc1
  s_waitcnt vmcnt(15)
  v_mfma_f32_32x32x16_bf16 v[8:23], a[96:99], v[72:75], v[8:23]
  s_add_u32 s43, s43, 4096
  buffer_load_dwordx4 v[72:75], v2, s[4:7], s43 offen offset:0 sc1
  s_waitcnt vmcnt(15)
  v_mfma_f32_32x32x16_bf16 v[8:23], a[100:103], v[76:79], v[8:23]
  buffer_load_dwordx4 v[76:79], v2, s[4:7], s43 offen offset:1024 sc1
  s_waitcnt vmcnt(15)
  v_mfma_f32_32x32x16_bf16 v[8:23], a[104:107], v[80:83], v[8:23]
  buffer_load_dwordx4 v[80:83], v2, s[4:7], s43 offen offset:2048 sc1
  s_waitcnt vmcnt(15)
  v_mfma_f32_32x32x16_bf16 v[8:23], a[108:111], v[84:87], v[8:23]
  buffer_load_dwordx4 v[84:87], v2, s[4:7], s43 offen offset:3072 sc1
  s_waitcnt vmcnt(15)
  v_mfma_f32_32x32x16_bf16 v[8:23], a[112:115], v[88:91], v[8:23]
  s_add_u32 s43, s43, 4096
  buffer_load_dwordx4 v[88:91], v2, s[4:7], s43 offen offset:0 sc1
  s_waitcnt vmcnt(15)
  v_mfma_f32_32x32x16_bf16 v[8:23], a[116:119], v[92:95], v[8:23]
  buffer_load_dwordx4 v[92:95], v2, s[4:7], s43 offen offset:1024 sc1
  s_waitcnt vmcnt(15)
  v_mfma_f32_32x32x16_bf16 v[8:23], a[120:123], v[96:99], v[8:23]
  buffer_load_dwordx4 v[96:99], v2, s[4:7], s43 offen offset:2048 sc1
  s_waitcnt vmcnt(15)
  v_mfma_f32_32x32x16_bf16 v[8:23], a[124:127], v[100:103], v[8:23]
  buffer_load_dwordx4 v[100:103], v2, s[4:7], s43 offen offset:3072 sc1
  s_waitcnt vmcnt(15)
  v_mfma_f32_32x32x16_bf16 v[8:23], a[128:131], v[40:43], v[8:23]
  s_add_u32 s43, s43, 4096
  buffer_load_dwordx4 v[40:43], v2, s[4:7], s43 offen offset:0 sc1
  s_waitcnt vmcnt(15)
  v_mfma_f32_32x32x16_bf16 v[8:23], a[132:135], v[44:47], v[8:23]
  buffer_load_dwordx4 v[44:47], v2, s[4:7], s43 offen offset:1024 sc1
  s_waitcnt vmcnt(15)
  v_mfma_f32_32x32x16_bf16 v[8:23], a[136:139], v[48:51], v[8:23]
  buffer_load_dwordx4 v[48:51], v2, s[4:7], s43 offen offset:2048 sc1
  s_waitcnt vmcnt(15)
  v_mfma_f32_32x32x16_bf16 v[8:23], a[140:143], v[52:55], v[8:23]
  buffer_load_dwordx4 v[52:55], v2, s[4:7], s43 offen offset:3072 sc1
  s_waitcnt vmcnt(15)
  v_mfma_f32_32x32x16_bf16 v[8:23], a[144:147], v[56:59], v[8:23]
  s_add_u32 s43, s43, 4096
  buffer_load_dwordx4 v[56:59], v2, s[4:7], s43 offen offset:0 sc1
  s_waitcnt vmcnt(15)
  v_mfma_f32_32x32x16_bf16 v[8:23], a[148:151], v[60:63], v[8:23]
  buffer_load_dwordx4 v[60:63], v2, s[4:7], s43 offen offset:1024 sc1
  s_waitcnt vmcnt(15)
  v_mfma_f32_32x32x16_bf16 v[8:23], a[152:155], v[64:67], v[8:23]
  buffer_load_dwordx4 v[64:67], v2, s[4:7], s43 offen offset:2048 sc1
  s_waitcnt vmcnt(15)
  v_mfma_f32_32x32x16_bf16 v[8:23], a[156:159], v[68:71], v[8:23]
  buffer_load_dwordx4 v[68:71], v2, s[4:7], s43 offen offset:3072 sc1
  s_waitcnt vmcnt(15)
  v_mfma_f32_32x32x16_bf16 v[8:23], a[160:163], v[72:75], v[8:23]
  s_add_u32 s43, s43, 4096
  buffer_load_dwordx4 v[72:75], v2, s[4:7], s43 offen offset:0 sc1
  s_waitcnt vmcnt(15)
  v_mfma_f32_32x32x16_bf16 v[8:23], a[164:167], v[76:79], v[8:23]
  buffer_load_dwordx4 v[76:79], v2, s[4:7], s43 offen offset:1024 sc1
  s_waitcnt vmcnt(15)
  v_mfma_f32_32x32x16_bf16 v[8:23], a[168:171], v[80:83], v[8:23]
  buffer_load_dwordx4 v[80:83], v2, s[4:7], s43 offen offset:2048 sc1
  s_waitcnt vmcnt(15)
  v_mfma_f32_32x32x16_bf16 v[8:23], a[172:175], v[84:87], v[8:23]
  buffer_load_dwordx4 v[84:87], v2, s[4:7], s43 offen offset:3072 sc1
  s_waitcnt vmcnt(15)
  v_mfma_f32_32x32x16_bf16 v[8:23], a[176:179], v[88:91], v[8:23]
  s_add_u32 s43, s43, 4096
  buffer_load_dwordx4 v[88:91], v2, s[4:7], s43 offen offset:0 sc1
  s_waitcnt vmcnt(15)
  v_mfma_f32_32x32x16_bf16 v[8:23], a[180:183], v[92:95], v[8:23]
  buffer_load_dwordx4 v[92:95], v2, s[4:7], s43 offen offset:1024 sc1
  s_waitcnt vmcnt(15)
  v_mfma_f32_32x32x16_bf16 v[8:23], a[184:187], v[96:99], v[8:23]
  buffer_load_dwordx4 v[96:99], v2, s[4:7], s43 offen offset:2048 sc1
  s_waitcnt vmcnt(15)
  v_mfma_f32_32x32x16_bf16 v[8:23], a[188:191], v[100:103], v[8:23]
  buffer_load_dwordx4 v[100:103], v2, s[4:7], s43 offen offset:3072 sc1
  s_waitcnt vmcnt(15)
  v_mfma_f32_32x32x16_bf16 v[8:23], a[192:195], v[40:43], v[8:23]
  s_waitcnt vmcnt(14)
  v_mfma_f32_32x32x16_bf16 v[8:23], a[196:199], v[44:47], v[8:23]
  s_waitcnt vmcnt(13)
  v_mfma_f32_32x32x16_bf16 v[8:23], a[200:203], v[48:51], v[8:23]
  s_waitcnt vmcnt(12)
  v_mfma_f32_32x32x16_bf16 v[8:23], a[204:207], v[52:55], v[8:23]
  s_waitcnt vmcnt(11)
  v_mfma_f32_32x32x16_bf16 v[8:23], a[208:211], v[56:59], v[8:23]
  s_waitcnt vmcnt(10)
  v_mfma_f32_32x32x16_bf16 v[8:23], a[212:215], v[60:63], v[8:23]
  s_waitcnt vmcnt(9)
  v_mfma_f32_32x32x16_bf16 v[8:23], a[216:219], v[64:67], v[8:23]
  s_waitcnt vmcnt(8)
  v_mfma_f32_32x32x16_bf16 v[8:23], a[220:223], v[68:71], v[8:23]
  s_waitcnt vmcnt(7)
  v_mfma_f32_32x32x16_bf16 v[8:23], a[224:227], v[72:75], v[8:23]
  s_waitcnt vmcnt(6)
  v_mfma_f32_32x32x16_bf16 v[8:23], a[228:231], v[76:79], v[8:23]
  s_waitcnt vmcnt(5)
  v_mfma_f32_32x32x16_bf16 v[8:23], a[232:235], v[80:83], v[8:23]
  s_waitcnt vmcnt(4)
  v_mfma_f32_32x32x16_bf16 v[8:23], a[236:239], v[84:87], v[8:23]
  s_waitcnt vmcnt(3)
  v_mfma_f32_32x32x16_bf16 v[8:23], a[240:243], v[88:91], v[8:23]
  s_waitcnt vmcnt(2)
  v_mfma_f32_32x32x16_bf16 v[8:23], a[244:247], v[92:95], v[8:23]
  s_waitcnt vmcnt(1)
  v_mfma_f32_32x32x16_bf16 v[8:23], a[248:251], v[96:99], v[8:23]
  s_waitcnt vmcnt(0)
  v_mfma_f32_32x32x16_bf16 v[8:23], a[252:255], v[100:103], v[8:23]
  s_nop 11
  v_sub_f32 v104, 1.0, v3
  v_mul_f32 v8, v8, v3
  v_fmac_f32 v8, v24, v104
  v_mul_f32 v9, v9, v3
  v_fmac_f32 v9, v25, v104
  v_mul_f32 v10, v10, v3
  v_fmac_f32 v10, v26, v104
  v_mul_f32 v11, v11, v3
  v_fmac_f32 v11, v27, v104
  v_mul_f32 v12, v12, v3
  v_fmac_f32 v12, v28, v104
  v_mul_f32 v13, v13, v3
  v_fmac_f32 v13, v29, v104
  v_mul_f32 v14, v14, v3
  v_fmac_f32 v14, v30, v104
  v_mul_f32 v15, v15, v3
  v_fmac_f32 v15, v31, v104
  v_mul_f32 v16, v16, v3
  v_fmac_f32 v16, v32, v104
  v_mul_f32 v17, v17, v3
  v_fmac_f32 v17, v33, v104
  v_mul_f32 v18, v18, v3
  v_fmac_f32 v18, v34, v104
  v_mul_f32 v19, v19, v3
  v_fmac_f32 v19, v35, v104
  v_mul_f32 v20, v20, v3
  v_fmac_f32 v20, v36, v104
  v_mul_f32 v21, v21, v3
  v_fmac_f32 v21, v37, v104
  v_mul_f32 v22, v22, v3
  v_fmac_f32 v22, v38, v104
  v_mul_f32 v23, v23, v3
  v_fmac_f32 v23, v39, v104
  s_barrier
  ds_write_b128 v5, v[8:11] offset:0
  ds_write_b128 v5, v[12:15] offset:1024
  ds_write_b128 v5, v[16:19] offset:2048
  ds_write_b128 v5, v[20:23] offset:3072
  s_waitcnt lgkmcnt(0)
  s_barrier
  ds_read_b128 v[108:111], v4 offset:0
  ds_read_b128 v[112:115], v4 offset:4096
  ds_read_b128 v[116:119], v4 offset:8192
  ds_read_b128 v[120:123], v4 offset:12288
  s_waitcnt lgkmcnt(0)
  v_pk_add_f32 v[108:109], v[108:109], v[112:113]
  v_pk_add_f32 v[110:111], v[110:111], v[114:115]
  v_pk_add_f32 v[108:109], v[108:109], v[116:117]
  v_pk_add_f32 v[110:111], v[110:111], v[118:119]
  v_pk_add_f32 v[108:109], v[108:109], v[120:121]
  v_pk_add_f32 v[110:111], v[110:111], v[122:123]
  v_cvt_pk_bf16_f32 v108, v108, v109
  v_cvt_pk_bf16_f32 v109, v110, v111
  s_mul_i32 s45, s42, 40960
  buffer_store_dwordx2 v[108:109], v6, s[8:11], s45 offen
  s_add_u32 s42, s42, 3
  s_cmp_lt_u32 s42, 64
  s_cbranch_scc1 FI_seg
  s_waitcnt vmcnt(0)
  s_branch K_fin
K_c:
  s_lshl_b32 s97, s60, 3
  s_add_u32 s97, s97, s34
  s_sub_u32 s97, s97, 24
  s_mov_b32 s98, s97
  s_mov_b32 s99, 2
  s_mov_b32 s59, 0
  v_mov_b32 v3, 144
  s_mov_b64 exec, 1
K_c_ww_w:
  buffer_load_dword v2, v3, s[24:27], 0 offen sc1
  s_waitcnt vmcnt(0)
  v_cmp_gt_u32 vcc, 64, v2
  s_cbranch_vccz K_c_ww_d
  s_sleep 8
  s_add_u32 s59, s59, 8
  s_cmp_lt_u32 s59, s56
  s_cbranch_scc1 K_c_ww_w
  s_mov_b32 s56, 0
K_c_ww_d:
  s_mov_b64 exec, -1
  s_lshr_b32 s60, s98, 4
  s_and_b32 s61, s98, 15
  s_cmp_eq_u32 s60, 0
  s_cbranch_scc1 P1c_mv
  s_cmp_eq_u32 s60, 1
  s_cbranch_scc1 P1c_mq
  s_load_dwordx2 s[8:9], s[0:1], 24
  s_mov_b32 s10, 5242880
  s_mov_b32 s11, 0x20000
  s_mov_b32 s48, 2097152
  s_branch P1c_qk
P1c_mq:
  s_load_dwordx2 s[8:9], s[0:1], 16
  s_mov_b32 s10, 5242880
  s_mov_b32 s11, 0x20000
  s_mov_b32 s48, 35651584
P1c_qk:
  s_mov_b32 s45, 0
  s_mov_b32 s42, 16
  s_mov_b32 s43, 8
  s_mov_b32 s44, 4
  s_mov_b32 s50, 256
  s_mov_b32 s51, 64
  s_and_b32 s62, s32, 1
  s_lshl_b32 s62, s62, 7
  s_branch P1c_cm
P1c_mv:
  s_load_dwordx2 s[8:9], s[0:1], 32
  s_mov_b32 s10, 5242880
  s_mov_b32 s11, 0x20000
  s_mov_b32 s48, 18874368
  s_mov_b32 s45, 1
  s_mov_b32 s42, 8
  s_mov_b32 s43, 16
  s_mov_b32 s44, 4
  s_mov_b32 s50, 64
  s_mov_b32 s51, 2048
  s_and_b32 s62, s32, 1
  s_lshl_b32 s62, s62, 12
P1c_cm:
  s_load_dwordx2 s[12:13], s[0:1], 0
  s_mov_b32 s14, 2621440
  s_mov_b32 s15, 0x20000
  s_add_u32 s48, s48, s62
  s_lshl_b32 s62, s61, 1
  s_lshr_b32 s63, s32, 1
  s_add_u32 s62, s62, s63
  s_lshl_b32 s62, s62, 19
  s_add_u32 s48, s48, s62
  s_lshl_b32 s62, s99, 17
  s_add_u32 s48, s48, s62
  s_mov_b32 s49, 8192
  s_mov_b32 s40, 8192
  s_lshl_b32 s41, s61, 9
  s_mul_i32 s46, s99, 655360
  s_mov_b32 s47, 16
  s_mov_b32 s53, 4
  s_lshl_b32 s62, s98, 2
  s_add_u32 s62, s62, s99
  s_lshl_b32 s62, s62, 7
  s_add_u32 s52, s62, 1835008
  s_waitcnt lgkmcnt(0)
  s_mov_b32 s96, 3
  s_branch K_wsg
K_c_after_p1:
  s_mov_b32 s40, s97
  s_mul_i32 s43, s32, 28672
  s_mov_b32 s52, 0x3e0293ee
  v_mov_b32 v190, 0xf149f2ca
  v_lshrrev_b32 v174, 4, v0
  v_and_b32 v175, 15, v0
  v_xor_b32 v175, v175, v174
  v_lshlrev_b32 v175, 4, v175
  v_lshl_add_u32 v169, v174, 8, v175
  v_and_b32 v175, 3, v0
  v_xor_b32 v175, v175, v174
  v_lshlrev_b32 v175, 4, v175
  v_lshrrev_b32 v176, 2, v0
  v_lshl_add_u32 v170, v176, 6, v175
  v_lshlrev_b32 v171, 4, v0
  v_and_b32 v174, 31, v0
  v_lshrrev_b32 v175, 5, v0
  v_and_b32 v177, 15, v174
  v_xor_b32 v177, v177, v175
  v_lshlrev_b32 v177, 4, v177
  v_lshl_add_u32 v164, v174, 8, v177
  v_add_u32 v164, s43, v164
  v_bfe_u32 v177, v174, 4, 1
  v_lshlrev_b32 v176, 4, v177
  v_bfe_u32 v177, v174, 2, 1
  v_lshl_add_u32 v176, v177, 3, v176
  v_bfe_u32 v177, v174, 3, 1
  v_lshl_add_u32 v176, v177, 2, v176
  v_and_b32 v177, 3, v174
  v_add_u32 v176, v176, v177
  v_and_b32 v177, 15, v176
  v_xor_b32 v177, v177, v175
  v_lshlrev_b32 v177, 4, v177
  v_lshl_add_u32 v165, v176, 8, v177
  v_add_u32 v165, s43, v165
  v_and_b32 v176, 3, v174
  v_lshrrev_b32 v177, 1, v174
  v_and_b32 v177, 4, v177
  v_or_b32 v176, v176, v177
  v_and_b32 v177, 15, v176
  v_xor_b32 v177, v177, v175
  v_lshlrev_b32 v177, 4, v177
  v_lshl_add_u32 v166, v176, 8, v177
  v_add_u32 v166, s43, v166
  v_bfe_u32 v176, v174, 2, 2
  v_xor_b32 v176, v176, v175
  v_lshlrev_b32 v176, 4, v176
  v_lshl_add_u32 v167, v174, 6, v176
  v_add_u32 v167, s43, v167
  v_lshlrev_b32 v168, 4, v174
  v_add_u32 v168, s43, v168
  v_lshlrev_b32 v176, 3, v175
  v_sub_u32 v176, v174, v176
  v_cmp_le_i32 s[64:65], 0, v176
  v_cmp_le_i32 s[66:67], 1, v176
  v_cmp_le_i32 s[68:69], 2, v176
  v_cmp_le_i32 s[70:71], 3, v176
  v_cmp_le_i32 s[72:73], 4, v176
  v_cmp_le_i32 s[74:75], 5, v176
  v_cmp_le_i32 s[76:77], 6, v176
  v_cmp_le_i32 s[78:79], 7, v176
  v_cmp_le_i32 s[80:81], 16, v176
  v_cmp_le_i32 s[82:83], 17, v176
  v_cmp_le_i32 s[84:85], 18, v176
  v_cmp_le_i32 s[86:87], 19, v176
  v_cmp_le_i32 s[88:89], 20, v176
  v_cmp_le_i32 s[90:91], 21, v176
  v_cmp_le_i32 s[92:93], 22, v176
  v_cmp_le_i32 s[94:95], 23, v176
  s_lshr_b32 s60, s40, 1
  v_lshlrev_b32 v176, 4, v0
  v_add_u32 v176, s60, v176
  v_lshlrev_b32 v176, 9, v176
  v_add_u32 v176, 1835008, v176
  s_lshl_b32 s60, s40, 8
  s_add_u32 s60, s60, 1867392
  v_lshlrev_b32 v177, 7, v0
  v_add_u32 v177, s60, v177
  v_cmp_gt_u32 vcc, 3, v0
  s_nop 1
  v_cndmask_b32 v172, v177, v176, vcc
  s_lshl_b32 s50, s40, 2
  s_add_u32 s50, s50, s32
  s_lshl_b32 s50, s50, 7
  s_add_u32 s50, s50, 1884160
  s_mov_b32 s41, s32
  s_mov_b32 s42, 0
XA_item:
  s_lshr_b32 s60, s41, 4
  s_lshl_b32 s60, s60, 7
  s_and_b32 s61, s41, 15
  s_add_u32 s61, s61, 1
  s_add_u32 s62, s41, 1
  v_cmp_gt_u32 vcc, 3, v0
  v_mov_b32 v176, s60
  s_nop 0
  v_cndmask_b32 v176, 0, v176, vcc
  v_add_u32 v176, v176, v172
  v_mov_b32 v173, s62
  v_mov_b32 v177, s61
  v_cndmask_b32 v173, v173, v177, vcc
  v_add_u32 v173, s3, v173
  s_mov_b32 s59, 0
  s_mov_b64 exec, 0x1f
XA_w:
  buffer_load_dword v177, v176, s[4:7], 0 offen sc1
  s_waitcnt vmcnt(0)
  v_sub_u32 v177, v177, v173
  v_cmp_lt_u32 vcc, 0x7f, v177
  s_cbranch_vccz XA_go
  s_sleep 4
  s_add_u32 s59, s59, 4
  s_cmp_lt_u32 s59, s56
  s_cbranch_scc1 XA_w
  s_mov_b32 s56, 0
XA_go:
  s_mov_b64 exec, -1
  s_lshl_b32 s60, s40, 19
  s_lshl_b32 s61, s41, 13
  s_add_u32 s60, s60, s61
  s_add_u32 s44, s60, 35651584
  s_add_u32 s45, s60, 2097152
  s_add_u32 s46, s60, 18874368
  s_lshl_b32 s60, s41, 16
  s_lshl_b32 s61, s40, 11
  s_add_u32 s60, s60, s61
  s_add_u32 s47, s60, 52428800
  s_add_u32 s48, s60, 56623104
  s_lshl_b32 s60, s41, 18
  s_lshl_b32 s61, s40, 13
  s_add_u32 s60, s60, s61
  s_add_u32 s49, s60, 60817408
  v_xor_b32 v174, 0, v169
  v_xor_b32 v175, 64, v169
  v_xor_b32 v176, 128, v169
  v_xor_b32 v177, 192, v169
  s_add_u32 m0, s43, 0
  s_add_u32 s60, s44, 0
  buffer_load_dwordx4 v174, s[4:7], s60 offen sc1 lds
  s_add_u32 m0, s43, 1024
  s_add_u32 s60, s44, 1024
  buffer_load_dwordx4 v175, s[4:7], s60 offen sc1 lds
  s_add_u32 m0, s43, 2048
  s_add_u32 s60, s44, 2048
  buffer_load_dwordx4 v176, s[4:7], s60 offen sc1 lds
  s_add_u32 m0, s43, 3072
  s_add_u32 s60, s44, 3072
  buffer_load_dwordx4 v177, s[4:7], s60 offen sc1 lds
  s_add_u32 m0, s43, 4096
  s_add_u32 s60, s44, 4096
  buffer_load_dwordx4 v174, s[4:7], s60 offen sc1 lds
  s_add_u32 m0, s43, 5120
  s_add_u32 s60, s44, 5120
  buffer_load_dwordx4 v175, s[4:7], s60 offen sc1 lds
  s_add_u32 m0, s43, 6144
  s_add_u32 s60, s44, 6144
  buffer_load_dwordx4 v176, s[4:7], s60 offen sc1 lds
  s_add_u32 m0, s43, 7168
  s_add_u32 s60, s44, 7168
  buffer_load_dwordx4 v177, s[4:7], s60 offen sc1 lds
  s_add_u32 m0, s43, 8192
  s_add_u32 s60, s45, 0
  buffer_load_dwordx4 v174, s[4:7], s60 offen sc1 lds
  s_add_u32 m0, s43, 9216
  s_add_u32 s60, s45, 1024
  buffer_load_dwordx4 v175, s[4:7], s60 offen sc1 lds
  s_add_u32 m0, s43, 10240
  s_add_u32 s60, s45, 2048
  buffer_load_dwordx4 v176, s[4:7], s60 offen sc1 lds
  s_add_u32 m0, s43, 11264
  s_add_u32 s60, s45, 3072
  buffer_load_dwordx4 v177, s[4:7], s60 offen sc1 lds
  s_add_u32 m0, s43, 12288
  s_add_u32 s60, s45, 4096
  buffer_load_dwordx4 v174, s[4:7], s60 offen sc1 lds
  s_add_u32 m0, s43, 13312
  s_add_u32 s60, s45, 5120
  buffer_load_dwordx4 v175, s[4:7], s60 offen sc1 lds
  s_add_u32 m0, s43, 14336
  s_add_u32 s60, s45, 6144
  buffer_load_dwordx4 v176, s[4:7], s60 offen sc1 lds
  s_add_u32 m0, s43, 15360
  s_add_u32 s60, s45, 7168
  buffer_load_dwordx4 v177, s[4:7], s60 offen sc1 lds
  s_add_u32 m0, s43, 24576
  s_add_u32 s60, s47, 0
  buffer_load_dwordx4 v174, s[4:7], s60 offen sc1 lds
  s_add_u32 m0, s43, 25600
  s_add_u32 s60, s47, 1024
  buffer_load_dwordx4 v175, s[4:7], s60 offen sc1 lds
  s_add_u32 m0, s43, 16384
  s_add_u32 s60, s46, 0
  buffer_load_dwordx4 v170, s[4:7], s60 offen sc1 lds
  s_add_u32 m0, s43, 17408
  s_add_u32 s60, s46, 1024
  buffer_load_dwordx4 v170, s[4:7], s60 offen sc1 lds
  s_add_u32 m0, s43, 18432
  s_add_u32 s60, s46, 2048
  buffer_load_dwordx4 v170, s[4:7], s60 offen sc1 lds
  s_add_u32 m0, s43, 19456
  s_add_u32 s60, s46, 3072
  buffer_load_dwordx4 v170, s[4:7], s60 offen sc1 lds
  s_add_u32 m0, s43, 20480
  s_add_u32 s60, s46, 4096
  buffer_load_dwordx4 v170, s[4:7], s60 offen sc1 lds
  s_add_u32 m0, s43, 21504
  s_add_u32 s60, s46, 5120
  buffer_load_dwordx4 v170, s[4:7], s60 offen sc1 lds
  s_add_u32 m0, s43, 22528
  s_add_u32 s60, s46, 6144
  buffer_load_dwordx4 v170, s[4:7], s60 offen sc1 lds
  s_add_u32 m0, s43, 23552
  s_add_u32 s60, s46, 7168
  buffer_load_dwordx4 v170, s[4:7], s60 offen sc1 lds
  s_add_u32 m0, s43, 26624
  s_add_u32 s60, s48, 0
  buffer_load_dwordx4 v171, s[4:7], s60 offen sc1 lds
  s_add_u32 m0, s43, 27648
  s_add_u32 s60, s48, 1024
  buffer_load_dwordx4 v171, s[4:7], s60 offen sc1 lds
  s_waitcnt vmcnt(10)
  v_xor_b32 v174, 0, v164
  ds_read_b128 v[8:11], v174 offset:0
  v_xor_b32 v174, 32, v164
  ds_read_b128 v[12:15], v174 offset:0
  v_xor_b32 v174, 64, v164
  ds_read_b128 v[16:19], v174 offset:0
  v_xor_b32 v174, 96, v164
  ds_read_b128 v[20:23], v174 offset:0
  v_xor_b32 v174, 128, v164
  ds_read_b128 v[24:27], v174 offset:0
  v_xor_b32 v174, 160, v164
  ds_read_b128 v[28:31], v174 offset:0
  v_xor_b32 v174, 192, v164
  ds_read_b128 v[32:35], v174 offset:0
  v_xor_b32 v174, 224, v164
  ds_read_b128 v[36:39], v174 offset:0
  s_waitcnt lgkmcnt(0)
  v_xor_b32 v174, 0, v165
  ds_read_b128 v[136:139], v174 offset:8192
  v_xor_b32 v175, 32, v165
  ds_read_b128 v[140:143], v175 offset:8192
  v_xor_b32 v176, 64, v165
  ds_read_b128 v[144:147], v176 offset:8192
  v_xor_b32 v177, 96, v165
  ds_read_b128 v[148:151], v177 offset:8192
  s_waitcnt lgkmcnt(3)
  v_mfma_f32_32x32x16_bf16 v[40:55], v[136:139], v[8:11], 0
  v_xor_b32 v174, 128, v165
  ds_read_b128 v[136:139], v174 offset:8192
  s_waitcnt lgkmcnt(3)
  v_mfma_f32_32x32x16_bf16 v[40:55], v[140:143], v[12:15], v[40:55]
  v_xor_b32 v175, 160, v165
  ds_read_b128 v[140:143], v175 offset:8192
  s_waitcnt lgkmcnt(3)
  v_mfma_f32_32x32x16_bf16 v[40:55], v[144:147], v[16:19], v[40:55]
  v_xor_b32 v176, 192, v165
  ds_read_b128 v[144:147], v176 offset:8192
  s_waitcnt lgkmcnt(3)
  v_mfma_f32_32x32x16_bf16 v[40:55], v[148:151], v[20:23], v[40:55]
  v_xor_b32 v177, 224, v165
  ds_read_b128 v[148:151], v177 offset:8192
  s_waitcnt lgkmcnt(3)
  v_mfma_f32_32x32x16_bf16 v[40:55], v[136:139], v[24:27], v[40:55]
  s_waitcnt lgkmcnt(2)
  v_mfma_f32_32x32x16_bf16 v[40:55], v[140:143], v[28:31], v[40:55]
  s_waitcnt lgkmcnt(1)
  v_mfma_f32_32x32x16_bf16 v[40:55], v[144:147], v[32:35], v[40:55]
  s_waitcnt lgkmcnt(0)
  v_mfma_f32_32x32x16_bf16 v[40:55], v[148:151], v[36:39], v[40:55]
  v_xor_b32 v174, 0, v166
  ds_read_b128 v[136:139], v174 offset:24576
  v_xor_b32 v175, 32, v166
  ds_read_b128 v[140:143], v175 offset:24576
  v_xor_b32 v176, 64, v166
  ds_read_b128 v[144:147], v176 offset:24576
  v_xor_b32 v177, 96, v166
  ds_read_b128 v[148:151], v177 offset:24576
  s_waitcnt lgkmcnt(3)
  v_mfma_f32_32x32x16_bf16 v[56:71], v[136:139], v[8:11], 0
  v_xor_b32 v174, 128, v166
  ds_read_b128 v[136:139], v174 offset:24576
  s_waitcnt lgkmcnt(3)
  v_mfma_f32_32x32x16_bf16 v[56:71], v[140:143], v[12:15], v[56:71]
  v_xor_b32 v175, 160, v166
  ds_read_b128 v[140:143], v175 offset:24576
  s_waitcnt lgkmcnt(3)
  v_mfma_f32_32x32x16_bf16 v[56:71], v[144:147], v[16:19], v[56:71]
  v_xor_b32 v176, 192, v166
  ds_read_b128 v[144:147], v176 offset:24576
  s_waitcnt lgkmcnt(3)
  v_mfma_f32_32x32x16_bf16 v[56:71], v[148:151], v[20:23], v[56:71]
  v_xor_b32 v177, 224, v166
  ds_read_b128 v[148:151], v177 offset:24576
  s_waitcnt lgkmcnt(3)
  v_mfma_f32_32x32x16_bf16 v[56:71], v[136:139], v[24:27], v[56:71]
  s_waitcnt lgkmcnt(2)
  v_mfma_f32_32x32x16_bf16 v[56:71], v[140:143], v[28:31], v[56:71]
  s_waitcnt lgkmcnt(1)
  v_mfma_f32_32x32x16_bf16 v[56:71], v[144:147], v[32:35], v[56:71]
  s_waitcnt lgkmcnt(0)
  v_mfma_f32_32x32x16_bf16 v[56:71], v[148:151], v[36:39], v[56:71]
  v_cndmask_b32 v40, v190, v40, s[64:65]
  v_cndmask_b32 v41, v190, v41, s[66:67]
  v_cndmask_b32 v42, v190, v42, s[68:69]
  v_cndmask_b32 v43, v190, v43, s[70:71]
  v_cndmask_b32 v44, v190, v44, s[72:73]
  v_cndmask_b32 v45, v190, v45, s[74:75]
  v_cndmask_b32 v46, v190, v46, s[76:77]
  v_cndmask_b32 v47, v190, v47, s[78:79]
  v_cndmask_b32 v48, v190, v48, s[80:81]
  v_cndmask_b32 v49, v190, v49, s[82:83]
  v_cndmask_b32 v50, v190, v50, s[84:85]
  v_cndmask_b32 v51, v190, v51, s[86:87]
  v_cndmask_b32 v52, v190, v52, s[88:89]
  v_cndmask_b32 v53, v190, v53, s[90:91]
  v_cndmask_b32 v54, v190, v54, s[92:93]
  v_cndmask_b32 v55, v190, v55, s[94:95]
  s_mov_b32 s60, -1
  s_mov_b32 s61, 0
  v_cndmask_b32 v56, v190, v56, s[60:61]
  v_cndmask_b32 v57, v190, v57, s[60:61]
  v_cndmask_b32 v58, v190, v58, s[60:61]
  v_cndmask_b32 v59, v190, v59, s[60:61]
  v_cndmask_b32 v60, v190, v60, s[60:61]
  v_cndmask_b32 v61, v190, v61, s[60:61]
  v_cndmask_b32 v62, v190, v62, s[60:61]
  v_cndmask_b32 v63, v190, v63, s[60:61]
  v_max3_f32 v174, v40, v41, v42
  v_max3_f32 v174, v174, v43, v44
  v_max3_f32 v174, v174, v45, v46
  v_max3_f32 v174, v174, v47, v48
  v_max3_f32 v174, v174, v49, v50
  v_max3_f32 v174, v174, v51, v52
  v_max3_f32 v174, v174, v53, v54
  v_max3_f32 v174, v174, v55, v56
  v_max3_f32 v174, v174, v57, v58
  v_max3_f32 v174, v174, v59, v60
  v_max3_f32 v174, v174, v61, v62
  v_max_f32 v174, v174, v63
  v_mov_b32 v175, v174
  s_nop 1
  v_permlane32_swap_b32 v174, v175
  v_max_f32 v174, v174, v175
  v_mul_f32 v174, s52, v174
  v_sub_f32 v174, 0, v174
  v_fma_f32 v40, v40, s52, v174
  v_fma_f32 v41, v41, s52, v174
  v_fma_f32 v42, v42, s52, v174
  v_fma_f32 v43, v43, s52, v174
  v_fma_f32 v44, v44, s52, v174
  v_fma_f32 v45, v45, s52, v174
  v_fma_f32 v46, v46, s52, v174
  v_fma_f32 v47, v47, s52, v174
  v_fma_f32 v48, v48, s52, v174
  v_fma_f32 v49, v49, s52, v174
  v_fma_f32 v50, v50, s52, v174
  v_fma_f32 v51, v51, s52, v174
  v_fma_f32 v52, v52, s52, v174
  v_fma_f32 v53, v53, s52, v174
  v_fma_f32 v54, v54, s52, v174
  v_fma_f32 v55, v55, s52, v174
  v_exp_f32 v40, v40
  v_exp_f32 v41, v41
  v_exp_f32 v42, v42
  v_exp_f32 v43, v43
  v_exp_f32 v44, v44
  v_exp_f32 v45, v45
  v_exp_f32 v46, v46
  v_exp_f32 v47, v47
  v_exp_f32 v48, v48
  v_exp_f32 v49, v49
  v_exp_f32 v50, v50
  v_exp_f32 v51, v51
  v_exp_f32 v52, v52
  v_exp_f32 v53, v53
  v_exp_f32 v54, v54
  v_exp_f32 v55, v55
  v_fma_f32 v56, v56, s52, v174
  v_fma_f32 v57, v57, s52, v174
  v_fma_f32 v58, v58, s52, v174
  v_fma_f32 v59, v59, s52, v174
  v_fma_f32 v60, v60, s52, v174
  v_fma_f32 v61, v61, s52, v174
  v_fma_f32 v62, v62, s52, v174
  v_fma_f32 v63, v63, s52, v174
  v_exp_f32 v56, v56
  v_exp_f32 v57, v57
  v_exp_f32 v58, v58
  v_exp_f32 v59, v59
  v_exp_f32 v60, v60
  v_exp_f32 v61, v61
  v_exp_f32 v62, v62
  v_exp_f32 v63, v63
  v_cvt_pk_bf16_f32 v152, v40, v41
  v_cvt_pk_bf16_f32 v153, v42, v43
  v_cvt_pk_bf16_f32 v154, v44, v45
  v_cvt_pk_bf16_f32 v155, v46, v47
  v_cvt_pk_bf16_f32 v156, v48, v49
  v_cvt_pk_bf16_f32 v157, v50, v51
  v_cvt_pk_bf16_f32 v158, v52, v53
  v_cvt_pk_bf16_f32 v159, v54, v55
  v_cvt_pk_bf16_f32 v160, v56, v57
  v_cvt_pk_bf16_f32 v161, v58, v59
  v_cvt_pk_bf16_f32 v162, v60, v61
  v_cvt_pk_bf16_f32 v163, v62, v63
  v_mov_b32 v175, 0
  v_lshlrev_b32 v176, 16, v152
  v_and_b32 v177, 0xffff0000, v152
  v_add_f32 v175, v175, v176
  v_add_f32 v175, v175, v177
  v_lshlrev_b32 v176, 16, v153
  v_and_b32 v177, 0xffff0000, v153
  v_add_f32 v175, v175, v176
  v_add_f32 v175, v175, v177
  v_lshlrev_b32 v176, 16, v154
  v_and_b32 v177, 0xffff0000, v154
  v_add_f32 v175, v175, v176
  v_add_f32 v175, v175, v177
  v_lshlrev_b32 v176, 16, v155
  v_and_b32 v177, 0xffff0000, v155
  v_add_f32 v175, v175, v176
  v_add_f32 v175, v175, v177
  v_lshlrev_b32 v176, 16, v156
  v_and_b32 v177, 0xffff0000, v156
  v_add_f32 v175, v175, v176
  v_add_f32 v175, v175, v177
  v_lshlrev_b32 v176, 16, v157
  v_and_b32 v177, 0xffff0000, v157
  v_add_f32 v175, v175, v176
  v_add_f32 v175, v175, v177
  v_lshlrev_b32 v176, 16, v158
  v_and_b32 v177, 0xffff0000, v158
  v_add_f32 v175, v175, v176
  v_add_f32 v175, v175, v177
  v_lshlrev_b32 v176, 16, v159
  v_and_b32 v177, 0xffff0000, v159
  v_add_f32 v175, v175, v176
  v_add_f32 v175, v175, v177
  v_lshlrev_b32 v176, 16, v160
  v_and_b32 v177, 0xffff0000, v160
  v_add_f32 v175, v175, v176
  v_add_f32 v175, v175, v177
  v_lshlrev_b32 v176, 16, v161
  v_and_b32 v177, 0xffff0000, v161
  v_add_f32 v175, v175, v176
  v_add_f32 v175, v175, v177
  v_lshlrev_b32 v176, 16, v162
  v_and_b32 v177, 0xffff0000, v162
  v_add_f32 v175, v175, v176
  v_add_f32 v175, v175, v177
  v_lshlrev_b32 v176, 16, v163
  v_and_b32 v177, 0xffff0000, v163
  v_add_f32 v175, v175, v176
  v_add_f32 v175, v175, v177
  v_mov_b32 v176, v175
  s_nop 1
  v_permlane32_swap_b32 v175, v176
  v_add_f32 v175, v175, v176
  v_rcp_f32 v175, v175
  s_waitcnt vmcnt(0)
  v_xor_b32 v176, 32, v167
  ds_read_b128 v[136:139], v167 offset:16384
  ds_read_b128 v[140:143], v176 offset:16384
  ds_read_b128 v[144:147], v168 offset:26624
  s_waitcnt lgkmcnt(2)
  v_mfma_f32_32x32x16_bf16 v[72:87], v[136:139], v[152:155], 0
  s_waitcnt lgkmcnt(1)
  v_mfma_f32_32x32x16_bf16 v[72:87], v[140:143], v[156:159], v[72:87]
  s_waitcnt lgkmcnt(0)
  v_mfma_f32_32x32x16_bf16 v[72:87], v[144:147], v[160:163], v[72:87]
  s_nop 3
  ds_read_b128 v[136:139], v167 offset:18432
  ds_read_b128 v[140:143], v176 offset:18432
  ds_read_b128 v[144:147], v168 offset:27136
  s_waitcnt lgkmcnt(2)
  v_mfma_f32_32x32x16_bf16 v[88:103], v[136:139], v[152:155], 0
  s_waitcnt lgkmcnt(1)
  v_mfma_f32_32x32x16_bf16 v[88:103], v[140:143], v[156:159], v[88:103]
  s_waitcnt lgkmcnt(0)
  v_mfma_f32_32x32x16_bf16 v[88:103], v[144:147], v[160:163], v[88:103]
  s_nop 3
  ds_read_b128 v[136:139], v167 offset:20480
  ds_read_b128 v[140:143], v176 offset:20480
  ds_read_b128 v[144:147], v168 offset:27648
  s_waitcnt lgkmcnt(2)
  v_mfma_f32_32x32x16_bf16 v[104:119], v[136:139], v[152:155], 0
  s_waitcnt lgkmcnt(1)
  v_mfma_f32_32x32x16_bf16 v[104:119], v[140:143], v[156:159], v[104:119]
  s_waitcnt lgkmcnt(0)
  v_mfma_f32_32x32x16_bf16 v[104:119], v[144:147], v[160:163], v[104:119]
  s_nop 3
  ds_read_b128 v[136:139], v167 offset:22528
  ds_read_b128 v[140:143], v176 offset:22528
  ds_read_b128 v[144:147], v168 offset:28160
  s_waitcnt lgkmcnt(2)
  v_mfma_f32_32x32x16_bf16 v[120:135], v[136:139], v[152:155], 0
  s_waitcnt lgkmcnt(1)
  v_mfma_f32_32x32x16_bf16 v[120:135], v[140:143], v[156:159], v[120:135]
  s_waitcnt lgkmcnt(0)
  v_mfma_f32_32x32x16_bf16 v[120:135], v[144:147], v[160:163], v[120:135]
  s_nop 3
  s_nop 11
  v_mul_f32 v72, v72, v175
  v_mul_f32 v73, v73, v175
  v_mul_f32 v74, v74, v175
  v_mul_f32 v75, v75, v175
  v_mul_f32 v76, v76, v175
  v_mul_f32 v77, v77, v175
  v_mul_f32 v78, v78, v175
  v_mul_f32 v79, v79, v175
  v_cvt_pk_bf16_f32 v8, v72, v73
  v_cvt_pk_bf16_f32 v9, v74, v75
  v_cvt_pk_bf16_f32 v10, v76, v77
  v_cvt_pk_bf16_f32 v11, v78, v79
  buffer_store_dwordx4 v[8:11], v171, s[4:7], s49 offen offset:0 sc1
  v_mul_f32 v80, v80, v175
  v_mul_f32 v81, v81, v175
  v_mul_f32 v82, v82, v175
  v_mul_f32 v83, v83, v175
  v_mul_f32 v84, v84, v175
  v_mul_f32 v85, v85, v175
  v_mul_f32 v86, v86, v175
  v_mul_f32 v87, v87, v175
  v_cvt_pk_bf16_f32 v12, v80, v81
  v_cvt_pk_bf16_f32 v13, v82, v83
  v_cvt_pk_bf16_f32 v14, v84, v85
  v_cvt_pk_bf16_f32 v15, v86, v87
  buffer_store_dwordx4 v[12:15], v171, s[4:7], s49 offen offset:1024 sc1
  v_mul_f32 v88, v88, v175
  v_mul_f32 v89, v89, v175
  v_mul_f32 v90, v90, v175
  v_mul_f32 v91, v91, v175
  v_mul_f32 v92, v92, v175
  v_mul_f32 v93, v93, v175
  v_mul_f32 v94, v94, v175
  v_mul_f32 v95, v95, v175
  v_cvt_pk_bf16_f32 v16, v88, v89
  v_cvt_pk_bf16_f32 v17, v90, v91
  v_cvt_pk_bf16_f32 v18, v92, v93
  v_cvt_pk_bf16_f32 v19, v94, v95
  buffer_store_dwordx4 v[16:19], v171, s[4:7], s49 offen offset:2048 sc1
  v_mul_f32 v96, v96, v175
  v_mul_f32 v97, v97, v175
  v_mul_f32 v98, v98, v175
  v_mul_f32 v99, v99, v175
  v_mul_f32 v100, v100, v175
  v_mul_f32 v101, v101, v175
  v_mul_f32 v102, v102, v175
  v_mul_f32 v103, v103, v175
  v_cvt_pk_bf16_f32 v20, v96, v97
  v_cvt_pk_bf16_f32 v21, v98, v99
  v_cvt_pk_bf16_f32 v22, v100, v101
  v_cvt_pk_bf16_f32 v23, v102, v103
  buffer_store_dwordx4 v[20:23], v171, s[4:7], s49 offen offset:3072 sc1
  v_mul_f32 v104, v104, v175
  v_mul_f32 v105, v105, v175
  v_mul_f32 v106, v106, v175
  v_mul_f32 v107, v107, v175
  v_mul_f32 v108, v108, v175
  v_mul_f32 v109, v109, v175
  v_mul_f32 v110, v110, v175
  v_mul_f32 v111, v111, v175
  v_cvt_pk_bf16_f32 v24, v104, v105
  v_cvt_pk_bf16_f32 v25, v106, v107
  v_cvt_pk_bf16_f32 v26, v108, v109
  v_cvt_pk_bf16_f32 v27, v110, v111
  s_add_u32 s49, s49, 4096
  buffer_store_dwordx4 v[24:27], v171, s[4:7], s49 offen offset:0 sc1
  v_mul_f32 v112, v112, v175
  v_mul_f32 v113, v113, v175
  v_mul_f32 v114, v114, v175
  v_mul_f32 v115, v115, v175
  v_mul_f32 v116, v116, v175
  v_mul_f32 v117, v117, v175
  v_mul_f32 v118, v118, v175
  v_mul_f32 v119, v119, v175
  v_cvt_pk_bf16_f32 v28, v112, v113
  v_cvt_pk_bf16_f32 v29, v114, v115
  v_cvt_pk_bf16_f32 v30, v116, v117
  v_cvt_pk_bf16_f32 v31, v118, v119
  buffer_store_dwordx4 v[28:31], v171, s[4:7], s49 offen offset:1024 sc1
  v_mul_f32 v120, v120, v175
  v_mul_f32 v121, v121, v175
  v_mul_f32 v122, v122, v175
  v_mul_f32 v123, v123, v175
  v_mul_f32 v124, v124, v175
  v_mul_f32 v125, v125, v175
  v_mul_f32 v126, v126, v175
  v_mul_f32 v127, v127, v175
  v_cvt_pk_bf16_f32 v32, v120, v121
  v_cvt_pk_bf16_f32 v33, v122, v123
  v_cvt_pk_bf16_f32 v34, v124, v125
  v_cvt_pk_bf16_f32 v35, v126, v127
  buffer_store_dwordx4 v[32:35], v171, s[4:7], s49 offen offset:2048 sc1
  v_mul_f32 v128, v128, v175
  v_mul_f32 v129, v129, v175
  v_mul_f32 v130, v130, v175
  v_mul_f32 v131, v131, v175
  v_mul_f32 v132, v132, v175
  v_mul_f32 v133, v133, v175
  v_mul_f32 v134, v134, v175
  v_mul_f32 v135, v135, v175
  v_cvt_pk_bf16_f32 v36, v128, v129
  v_cvt_pk_bf16_f32 v37, v130, v131
  v_cvt_pk_bf16_f32 v38, v132, v133
  v_cvt_pk_bf16_f32 v39, v134, v135
  buffer_store_dwordx4 v[36:39], v171, s[4:7], s49 offen offset:3072 sc1
  s_waitcnt vmcnt(0)
  s_add_u32 s42, s42, 1
  v_mov_b32 v176, s42
  v_add_u32 v176, s3, v176
  v_mov_b32 v177, 0
  s_mov_b64 exec, 1
  buffer_store_dword v176, v177, s[4:7], s50 offen sc1
  s_mov_b64 exec, -1
  s_add_u32 s41, s41, 4
  s_cmp_lt_u32 s41, 64
  s_cbranch_scc1 XA_item
  s_branch K_fin
K_wsg:
  v_lshrrev_b32 v98, 5, v0
  v_mul_lo_u32 v99, s40, v98
  v_bfe_u32 v100, v0, 2, 3
  v_and_b32 v101, 3, v0
  v_or_b32 v102, 0, v98
  v_xor_b32 v102, v102, v100
  v_lshlrev_b32 v102, 6, v102
  v_lshl_add_u32 v102, v101, 4, v102
  v_add_u32 v104, v102, v99
  v_or_b32 v102, 2, v98
  v_xor_b32 v102, v102, v100
  v_lshlrev_b32 v102, 6, v102
  v_lshl_add_u32 v102, v101, 4, v102
  v_add_u32 v105, v102, v99
  v_lshrrev_b32 v98, 5, v0
  v_bfe_u32 v99, v0, 2, 2
  v_lshl_add_u32 v100, v98, 3, v99
  v_lshlrev_b32 v100, 9, v100
  v_bfe_u32 v101, v0, 1, 1
  v_mul_lo_u32 v101, s42, v101
  v_bfe_u32 v102, v0, 4, 1
  v_mul_lo_u32 v102, s43, v102
  v_add_u32 v101, v101, v102
  v_and_b32 v102, 1, v0
  v_mul_lo_u32 v102, s44, v102
  v_add_u32 v101, v101, v102
  v_lshl_add_u32 v100, v101, 1, v100
  s_lshl_b32 s60, s32, 1
  s_add_u32 s60, s60, 0
  v_xor_b32 v102, s60, v99
  v_lshl_add_u32 v108, v102, 6, v100
  s_lshl_b32 s60, s32, 1
  s_add_u32 s60, s60, 1
  v_xor_b32 v102, s60, v99
  v_lshl_add_u32 v109, v102, 6, v100
  s_lshl_b32 s60, s32, 4
  s_add_u32 s60, s60, 0
  s_mul_i32 s60, s60, s40
  s_add_u32 s60, s60, s41
  s_lshl_b32 s61, s32, 13
  s_lshl_b32 s62, s40, 1
  s_add_u32 m0, s61, 0
  s_nop 0
  buffer_load_dwordx4 v104, s[8:11], s60 offen lds
  s_add_u32 s60, s60, s62
  s_add_u32 m0, s61, 1024
  s_nop 0
  buffer_load_dwordx4 v105, s[8:11], s60 offen lds
  s_add_u32 s60, s60, s62
  s_add_u32 m0, s61, 2048
  s_nop 0
  buffer_load_dwordx4 v104, s[8:11], s60 offen lds
  s_add_u32 s60, s60, s62
  s_add_u32 m0, s61, 3072
  s_nop 0
  buffer_load_dwordx4 v105, s[8:11], s60 offen lds
  s_add_u32 s60, s60, s62
  s_add_u32 m0, s61, 4096
  s_nop 0
  buffer_load_dwordx4 v104, s[8:11], s60 offen lds
  s_add_u32 s60, s60, s62
  s_add_u32 m0, s61, 5120
  s_nop 0
  buffer_load_dwordx4 v105, s[8:11], s60 offen lds
  s_add_u32 s60, s60, s62
  s_add_u32 m0, s61, 6144
  s_nop 0
  buffer_load_dwordx4 v104, s[8:11], s60 offen lds
  s_add_u32 s60, s60, s62
  s_add_u32 m0, s61, 7168
  s_nop 0
  buffer_load_dwordx4 v105, s[8:11], s60 offen lds
  s_lshl_b32 s60, s32, 4
  s_add_u32 s60, s60, 64
  s_mul_i32 s60, s60, s40
  s_add_u32 s60, s60, s41
  s_lshl_b32 s61, s32, 13
  s_lshl_b32 s62, s40, 1
  s_add_u32 m0, s61, 32768
  s_nop 0
  buffer_load_dwordx4 v104, s[8:11], s60 offen lds
  s_add_u32 s60, s60, s62
  s_add_u32 m0, s61, 33792
  s_nop 0
  buffer_load_dwordx4 v105, s[8:11], s60 offen lds
  s_add_u32 s60, s60, s62
  s_add_u32 m0, s61, 34816
  s_nop 0
  buffer_load_dwordx4 v104, s[8:11], s60 offen lds
  s_add_u32 s60, s60, s62
  s_add_u32 m0, s61, 35840
  s_nop 0
  buffer_load_dwordx4 v105, s[8:11], s60 offen lds
  s_add_u32 s60, s60, s62
  s_add_u32 m0, s61, 36864
  s_nop 0
  buffer_load_dwordx4 v104, s[8:11], s60 offen lds
  s_add_u32 s60, s60, s62
  s_add_u32 m0, s61, 37888
  s_nop 0
  buffer_load_dwordx4 v105, s[8:11], s60 offen lds
  s_add_u32 s60, s60, s62
  s_add_u32 m0, s61, 38912
  s_nop 0
  buffer_load_dwordx4 v104, s[8:11], s60 offen lds
  s_add_u32 s60, s60, s62
  s_add_u32 m0, s61, 39936
  s_nop 0
  buffer_load_dwordx4 v105, s[8:11], s60 offen lds
  s_waitcnt vmcnt(8)
  s_barrier
  s_lshl_b32 s60, s32, 4
  s_add_u32 s60, s60, 128
  s_mul_i32 s60, s60, s40
  s_add_u32 s60, s60, s41
  s_lshl_b32 s61, s32, 13
  s_lshl_b32 s62, s40, 1
  s_add_u32 m0, s61, 65536
  s_nop 0
  buffer_load_dwordx4 v104, s[8:11], s60 offen lds
  s_add_u32 s60, s60, s62
  s_add_u32 m0, s61, 66560
  s_nop 0
  buffer_load_dwordx4 v105, s[8:11], s60 offen lds
  s_add_u32 s60, s60, s62
  s_add_u32 m0, s61, 67584
  s_nop 0
  buffer_load_dwordx4 v104, s[8:11], s60 offen lds
  s_add_u32 s60, s60, s62
  s_add_u32 m0, s61, 68608
  s_nop 0
  buffer_load_dwordx4 v105, s[8:11], s60 offen lds
  s_add_u32 s60, s60, s62
  s_add_u32 m0, s61, 69632
  s_nop 0
  buffer_load_dwordx4 v104, s[8:11], s60 offen lds
  s_add_u32 s60, s60, s62
  s_add_u32 m0, s61, 70656
  s_nop 0
  buffer_load_dwordx4 v105, s[8:11], s60 offen lds
  s_add_u32 s60, s60, s62
  s_add_u32 m0, s61, 71680
  s_nop 0
  buffer_load_dwordx4 v104, s[8:11], s60 offen lds
  s_add_u32 s60, s60, s62
  s_add_u32 m0, s61, 72704
  s_nop 0
  buffer_load_dwordx4 v105, s[8:11], s60 offen lds
  v_add_u32 v106, 0, v108
  v_add_u32 v107, 0, v109
  ds_read_b64_tr_b16 a[0:1], v106 offset:0
  ds_read_b64_tr_b16 a[2:3], v106 offset:2048
  ds_read_b64_tr_b16 a[160:161], v107 offset:0
  ds_read_b64_tr_b16 a[162:163], v107 offset:2048
  ds_read_b64_tr_b16 a[4:5], v106 offset:8192
  ds_read_b64_tr_b16 a[6:7], v106 offset:10240
  ds_read_b64_tr_b16 a[164:165], v107 offset:8192
  ds_read_b64_tr_b16 a[166:167], v107 offset:10240
  s_waitcnt lgkmcnt(0)
  ds_read_b64_tr_b16 a[8:9], v106 offset:16384
  ds_read_b64_tr_b16 a[10:11], v106 offset:18432
  ds_read_b64_tr_b16 a[168:169], v107 offset:16384
  ds_read_b64_tr_b16 a[170:171], v107 offset:18432
  ds_read_b64_tr_b16 a[12:13], v106 offset:24576
  ds_read_b64_tr_b16 a[14:15], v106 offset:26624
  ds_read_b64_tr_b16 a[172:173], v107 offset:24576
  ds_read_b64_tr_b16 a[174:175], v107 offset:26624
  s_waitcnt lgkmcnt(0)
  s_waitcnt vmcnt(8)
  s_barrier
  s_lshl_b32 s60, s32, 4
  s_add_u32 s60, s60, 192
  s_mul_i32 s60, s60, s40
  s_add_u32 s60, s60, s41
  s_lshl_b32 s61, s32, 13
  s_lshl_b32 s62, s40, 1
  s_add_u32 m0, s61, 0
  s_nop 0
  buffer_load_dwordx4 v104, s[8:11], s60 offen lds
  s_add_u32 s60, s60, s62
  s_add_u32 m0, s61, 1024
  s_nop 0
  buffer_load_dwordx4 v105, s[8:11], s60 offen lds
  s_add_u32 s60, s60, s62
  s_add_u32 m0, s61, 2048
  s_nop 0
  buffer_load_dwordx4 v104, s[8:11], s60 offen lds
  s_add_u32 s60, s60, s62
  s_add_u32 m0, s61, 3072
  s_nop 0
  buffer_load_dwordx4 v105, s[8:11], s60 offen lds
  s_add_u32 s60, s60, s62
  s_add_u32 m0, s61, 4096
  s_nop 0
  buffer_load_dwordx4 v104, s[8:11], s60 offen lds
  s_add_u32 s60, s60, s62
  s_add_u32 m0, s61, 5120
  s_nop 0
  buffer_load_dwordx4 v105, s[8:11], s60 offen lds
  s_add_u32 s60, s60, s62
  s_add_u32 m0, s61, 6144
  s_nop 0
  buffer_load_dwordx4 v104, s[8:11], s60 offen lds
  s_add_u32 s60, s60, s62
  s_add_u32 m0, s61, 7168
  s_nop 0
  buffer_load_dwordx4 v105, s[8:11], s60 offen lds
  v_add_u32 v106, 32768, v108
  v_add_u32 v107, 32768, v109
  ds_read_b64_tr_b16 a[16:17], v106 offset:0
  ds_read_b64_tr_b16 a[18:19], v106 offset:2048
  ds_read_b64_tr_b16 a[176:177], v107 offset:0
  ds_read_b64_tr_b16 a[178:179], v107 offset:2048
  ds_read_b64_tr_b16 a[20:21], v106 offset:8192
  ds_read_b64_tr_b16 a[22:23], v106 offset:10240
  ds_read_b64_tr_b16 a[180:181], v107 offset:8192
  ds_read_b64_tr_b16 a[182:183], v107 offset:10240
  s_waitcnt lgkmcnt(0)
  ds_read_b64_tr_b16 a[24:25], v106 offset:16384
  ds_read_b64_tr_b16 a[26:27], v106 offset:18432
  ds_read_b64_tr_b16 a[184:185], v107 offset:16384
  ds_read_b64_tr_b16 a[186:187], v107 offset:18432
  ds_read_b64_tr_b16 a[28:29], v106 offset:24576
  ds_read_b64_tr_b16 a[30:31], v106 offset:26624
  ds_read_b64_tr_b16 a[188:189], v107 offset:24576
  ds_read_b64_tr_b16 a[190:191], v107 offset:26624
  s_waitcnt lgkmcnt(0)
  s_waitcnt vmcnt(8)
  s_barrier
  s_lshl_b32 s60, s32, 4
  s_add_u32 s60, s60, 256
  s_mul_i32 s60, s60, s40
  s_add_u32 s60, s60, s41
  s_lshl_b32 s61, s32, 13
  s_lshl_b32 s62, s40, 1
  s_add_u32 m0, s61, 32768
  s_nop 0
  buffer_load_dwordx4 v104, s[8:11], s60 offen lds
  s_add_u32 s60, s60, s62
  s_add_u32 m0, s61, 33792
  s_nop 0
  buffer_load_dwordx4 v105, s[8:11], s60 offen lds
  s_add_u32 s60, s60, s62
  s_add_u32 m0, s61, 34816
  s_nop 0
  buffer_load_dwordx4 v104, s[8:11], s60 offen lds
  s_add_u32 s60, s60, s62
  s_add_u32 m0, s61, 35840
  s_nop 0
  buffer_load_dwordx4 v105, s[8:11], s60 offen lds
  s_add_u32 s60, s60, s62
  s_add_u32 m0, s61, 36864
  s_nop 0
  buffer_load_dwordx4 v104, s[8:11], s60 offen lds
  s_add_u32 s60, s60, s62
  s_add_u32 m0, s61, 37888
  s_nop 0
  buffer_load_dwordx4 v105, s[8:11], s60 offen lds
  s_add_u32 s60, s60, s62
  s_add_u32 m0, s61, 38912
  s_nop 0
  buffer_load_dwordx4 v104, s[8:11], s60 offen lds
  s_add_u32 s60, s60, s62
  s_add_u32 m0, s61, 39936
  s_nop 0
  buffer_load_dwordx4 v105, s[8:11], s60 offen lds
  v_add_u32 v106, 65536, v108
  v_add_u32 v107, 65536, v109
  ds_read_b64_tr_b16 a[32:33], v106 offset:0
  ds_read_b64_tr_b16 a[34:35], v106 offset:2048
  ds_read_b64_tr_b16 a[192:193], v107 offset:0
  ds_read_b64_tr_b16 a[194:195], v107 offset:2048
  ds_read_b64_tr_b16 a[36:37], v106 offset:8192
  ds_read_b64_tr_b16 a[38:39], v106 offset:10240
  ds_read_b64_tr_b16 a[196:197], v107 offset:8192
  ds_read_b64_tr_b16 a[198:199], v107 offset:10240
  s_waitcnt lgkmcnt(0)
  ds_read_b64_tr_b16 a[40:41], v106 offset:16384
  ds_read_b64_tr_b16 a[42:43], v106 offset:18432
  ds_read_b64_tr_b16 a[200:201], v107 offset:16384
  ds_read_b64_tr_b16 a[202:203], v107 offset:18432
  ds_read_b64_tr_b16 a[44:45], v106 offset:24576
  ds_read_b64_tr_b16 a[46:47], v106 offset:26624
  ds_read_b64_tr_b16 a[204:205], v107 offset:24576
  ds_read_b64_tr_b16 a[206:207], v107 offset:26624
  s_waitcnt lgkmcnt(0)
  s_waitcnt vmcnt(8)
  s_barrier
  s_lshl_b32 s60, s32, 4
  s_add_u32 s60, s60, 320
  s_mul_i32 s60, s60, s40
  s_add_u32 s60, s60, s41
  s_lshl_b32 s61, s32, 13
  s_lshl_b32 s62, s40, 1
  s_add_u32 m0, s61, 65536
  s_nop 0
  buffer_load_dwordx4 v104, s[8:11], s60 offen lds
  s_add_u32 s60, s60, s62
  s_add_u32 m0, s61, 66560
  s_nop 0
  buffer_load_dwordx4 v105, s[8:11], s60 offen lds
  s_add_u32 s60, s60, s62
  s_add_u32 m0, s61, 67584
  s_nop 0
  buffer_load_dwordx4 v104, s[8:11], s60 offen lds
  s_add_u32 s60, s60, s62
  s_add_u32 m0, s61, 68608
  s_nop 0
  buffer_load_dwordx4 v105, s[8:11], s60 offen lds
  s_add_u32 s60, s60, s62
  s_add_u32 m0, s61, 69632
  s_nop 0
  buffer_load_dwordx4 v104, s[8:11], s60 offen lds
  s_add_u32 s60, s60, s62
  s_add_u32 m0, s61, 70656
  s_nop 0
  buffer_load_dwordx4 v105, s[8:11], s60 offen lds
  s_add_u32 s60, s60, s62
  s_add_u32 m0, s61, 71680
  s_nop 0
  buffer_load_dwordx4 v104, s[8:11], s60 offen lds
  s_add_u32 s60, s60, s62
  s_add_u32 m0, s61, 72704
  s_nop 0
  buffer_load_dwordx4 v105, s[8:11], s60 offen lds
  v_add_u32 v106, 0, v108
  v_add_u32 v107, 0, v109
  ds_read_b64_tr_b16 a[48:49], v106 offset:0
  ds_read_b64_tr_b16 a[50:51], v106 offset:2048
  ds_read_b64_tr_b16 a[208:209], v107 offset:0
  ds_read_b64_tr_b16 a[210:211], v107 offset:2048
  ds_read_b64_tr_b16 a[52:53], v106 offset:8192
  ds_read_b64_tr_b16 a[54:55], v106 offset:10240
  ds_read_b64_tr_b16 a[212:213], v107 offset:8192
  ds_read_b64_tr_b16 a[214:215], v107 offset:10240
  s_waitcnt lgkmcnt(0)
  ds_read_b64_tr_b16 a[56:57], v106 offset:16384
  ds_read_b64_tr_b16 a[58:59], v106 offset:18432
  ds_read_b64_tr_b16 a[216:217], v107 offset:16384
  ds_read_b64_tr_b16 a[218:219], v107 offset:18432
  ds_read_b64_tr_b16 a[60:61], v106 offset:24576
  ds_read_b64_tr_b16 a[62:63], v106 offset:26624
  ds_read_b64_tr_b16 a[220:221], v107 offset:24576
  ds_read_b64_tr_b16 a[222:223], v107 offset:26624
  s_waitcnt lgkmcnt(0)
  s_waitcnt vmcnt(8)
  s_barrier
  s_lshl_b32 s60, s32, 4
  s_add_u32 s60, s60, 384
  s_mul_i32 s60, s60, s40
  s_add_u32 s60, s60, s41
  s_lshl_b32 s61, s32, 13
  s_lshl_b32 s62, s40, 1
  s_add_u32 m0, s61, 0
  s_nop 0
  buffer_load_dwordx4 v104, s[8:11], s60 offen lds
  s_add_u32 s60, s60, s62
  s_add_u32 m0, s61, 1024
  s_nop 0
  buffer_load_dwordx4 v105, s[8:11], s60 offen lds
  s_add_u32 s60, s60, s62
  s_add_u32 m0, s61, 2048
  s_nop 0
  buffer_load_dwordx4 v104, s[8:11], s60 offen lds
  s_add_u32 s60, s60, s62
  s_add_u32 m0, s61, 3072
  s_nop 0
  buffer_load_dwordx4 v105, s[8:11], s60 offen lds
  s_add_u32 s60, s60, s62
  s_add_u32 m0, s61, 4096
  s_nop 0
  buffer_load_dwordx4 v104, s[8:11], s60 offen lds
  s_add_u32 s60, s60, s62
  s_add_u32 m0, s61, 5120
  s_nop 0
  buffer_load_dwordx4 v105, s[8:11], s60 offen lds
  s_add_u32 s60, s60, s62
  s_add_u32 m0, s61, 6144
  s_nop 0
  buffer_load_dwordx4 v104, s[8:11], s60 offen lds
  s_add_u32 s60, s60, s62
  s_add_u32 m0, s61, 7168
  s_nop 0
  buffer_load_dwordx4 v105, s[8:11], s60 offen lds
  v_add_u32 v106, 32768, v108
  v_add_u32 v107, 32768, v109
  ds_read_b64_tr_b16 a[64:65], v106 offset:0
  ds_read_b64_tr_b16 a[66:67], v106 offset:2048
  ds_read_b64_tr_b16 a[224:225], v107 offset:0
  ds_read_b64_tr_b16 a[226:227], v107 offset:2048
  ds_read_b64_tr_b16 a[68:69], v106 offset:8192
  ds_read_b64_tr_b16 a[70:71], v106 offset:10240
  ds_read_b64_tr_b16 a[228:229], v107 offset:8192
  ds_read_b64_tr_b16 a[230:231], v107 offset:10240
  s_waitcnt lgkmcnt(0)
  ds_read_b64_tr_b16 a[72:73], v106 offset:16384
  ds_read_b64_tr_b16 a[74:75], v106 offset:18432
  ds_read_b64_tr_b16 a[232:233], v107 offset:16384
  ds_read_b64_tr_b16 a[234:235], v107 offset:18432
  ds_read_b64_tr_b16 a[76:77], v106 offset:24576
  ds_read_b64_tr_b16 a[78:79], v106 offset:26624
  ds_read_b64_tr_b16 a[236:237], v107 offset:24576
  ds_read_b64_tr_b16 a[238:239], v107 offset:26624
  s_waitcnt lgkmcnt(0)
  s_waitcnt vmcnt(8)
  s_barrier
  s_lshl_b32 s60, s32, 4
  s_add_u32 s60, s60, 448
  s_mul_i32 s60, s60, s40
  s_add_u32 s60, s60, s41
  s_lshl_b32 s61, s32, 13
  s_lshl_b32 s62, s40, 1
  s_add_u32 m0, s61, 32768
  s_nop 0
  buffer_load_dwordx4 v104, s[8:11], s60 offen lds
  s_add_u32 s60, s60, s62
  s_add_u32 m0, s61, 33792
  s_nop 0
  buffer_load_dwordx4 v105, s[8:11], s60 offen lds
  s_add_u32 s60, s60, s62
  s_add_u32 m0, s61, 34816
  s_nop 0
  buffer_load_dwordx4 v104, s[8:11], s60 offen lds
  s_add_u32 s60, s60, s62
  s_add_u32 m0, s61, 35840
  s_nop 0
  buffer_load_dwordx4 v105, s[8:11], s60 offen lds
  s_add_u32 s60, s60, s62
  s_add_u32 m0, s61, 36864
  s_nop 0
  buffer_load_dwordx4 v104, s[8:11], s60 offen lds
  s_add_u32 s60, s60, s62
  s_add_u32 m0, s61, 37888
  s_nop 0
  buffer_load_dwordx4 v105, s[8:11], s60 offen lds
  s_add_u32 s60, s60, s62
  s_add_u32 m0, s61, 38912
  s_nop 0
  buffer_load_dwordx4 v104, s[8:11], s60 offen lds
  s_add_u32 s60, s60, s62
  s_add_u32 m0, s61, 39936
  s_nop 0
  buffer_load_dwordx4 v105, s[8:11], s60 offen lds
  v_add_u32 v106, 65536, v108
  v_add_u32 v107, 65536, v109
  ds_read_b64_tr_b16 a[80:81], v106 offset:0
  ds_read_b64_tr_b16 a[82:83], v106 offset:2048
  ds_read_b64_tr_b16 a[240:241], v107 offset:0
  ds_read_b64_tr_b16 a[242:243], v107 offset:2048
  ds_read_b64_tr_b16 a[84:85], v106 offset:8192
  ds_read_b64_tr_b16 a[86:87], v106 offset:10240
  ds_read_b64_tr_b16 a[244:245], v107 offset:8192
  ds_read_b64_tr_b16 a[246:247], v107 offset:10240
  s_waitcnt lgkmcnt(0)
  ds_read_b64_tr_b16 a[88:89], v106 offset:16384
  ds_read_b64_tr_b16 a[90:91], v106 offset:18432
  ds_read_b64_tr_b16 a[248:249], v107 offset:16384
  ds_read_b64_tr_b16 a[250:251], v107 offset:18432
  ds_read_b64_tr_b16 a[92:93], v106 offset:24576
  ds_read_b64_tr_b16 a[94:95], v106 offset:26624
  ds_read_b64_tr_b16 a[252:253], v107 offset:24576
  ds_read_b64_tr_b16 a[254:255], v107 offset:26624
  s_waitcnt lgkmcnt(0)
  s_waitcnt vmcnt(8)
  s_barrier
  s_lshl_b32 s60, s32, 4
  s_add_u32 s60, s60, 512
  s_mul_i32 s60, s60, s40
  s_add_u32 s60, s60, s41
  s_lshl_b32 s61, s32, 13
  s_lshl_b32 s62, s40, 1
  s_add_u32 m0, s61, 65536
  s_nop 0
  buffer_load_dwordx4 v104, s[8:11], s60 offen lds
  s_add_u32 s60, s60, s62
  s_add_u32 m0, s61, 66560
  s_nop 0
  buffer_load_dwordx4 v105, s[8:11], s60 offen lds
  s_add_u32 s60, s60, s62
  s_add_u32 m0, s61, 67584
  s_nop 0
  buffer_load_dwordx4 v104, s[8:11], s60 offen lds
  s_add_u32 s60, s60, s62
  s_add_u32 m0, s61, 68608
  s_nop 0
  buffer_load_dwordx4 v105, s[8:11], s60 offen lds
  s_add_u32 s60, s60, s62
  s_add_u32 m0, s61, 69632
  s_nop 0
  buffer_load_dwordx4 v104, s[8:11], s60 offen lds
  s_add_u32 s60, s60, s62
  s_add_u32 m0, s61, 70656
  s_nop 0
  buffer_load_dwordx4 v105, s[8:11], s60 offen lds
  s_add_u32 s60, s60, s62
  s_add_u32 m0, s61, 71680
  s_nop 0
  buffer_load_dwordx4 v104, s[8:11], s60 offen lds
  s_add_u32 s60, s60, s62
  s_add_u32 m0, s61, 72704
  s_nop 0
  buffer_load_dwordx4 v105, s[8:11], s60 offen lds
  v_add_u32 v106, 0, v108
  v_add_u32 v107, 0, v109
  ds_read_b64_tr_b16 a[96:97], v106 offset:0
  ds_read_b64_tr_b16 a[98:99], v106 offset:2048
  ds_read_b64_tr_b16 v[192:193], v107 offset:0
  ds_read_b64_tr_b16 v[194:195], v107 offset:2048
  ds_read_b64_tr_b16 a[100:101], v106 offset:8192
  ds_read_b64_tr_b16 a[102:103], v106 offset:10240
  ds_read_b64_tr_b16 v[196:197], v107 offset:8192
  ds_read_b64_tr_b16 v[198:199], v107 offset:10240
  s_waitcnt lgkmcnt(0)
  ds_read_b64_tr_b16 a[104:105], v106 offset:16384
  ds_read_b64_tr_b16 a[106:107], v106 offset:18432
  ds_read_b64_tr_b16 v[200:201], v107 offset:16384
  ds_read_b64_tr_b16 v[202:203], v107 offset:18432
  ds_read_b64_tr_b16 a[108:109], v106 offset:24576
  ds_read_b64_tr_b16 a[110:111], v106 offset:26624
  ds_read_b64_tr_b16 v[204:205], v107 offset:24576
  ds_read_b64_tr_b16 v[206:207], v107 offset:26624
  s_waitcnt lgkmcnt(0)
  s_waitcnt vmcnt(8)
  s_barrier
  s_lshl_b32 s60, s32, 4
  s_add_u32 s60, s60, 576
  s_mul_i32 s60, s60, s40
  s_add_u32 s60, s60, s41
  s_lshl_b32 s61, s32, 13
  s_lshl_b32 s62, s40, 1
  s_add_u32 m0, s61, 0
  s_nop 0
  buffer_load_dwordx4 v104, s[8:11], s60 offen lds
  s_add_u32 s60, s60, s62
  s_add_u32 m0, s61, 1024
  s_nop 0
  buffer_load_dwordx4 v105, s[8:11], s60 offen lds
  s_add_u32 s60, s60, s62
  s_add_u32 m0, s61, 2048
  s_nop 0
  buffer_load_dwordx4 v104, s[8:11], s60 offen lds
  s_add_u32 s60, s60, s62
  s_add_u32 m0, s61, 3072
  s_nop 0
  buffer_load_dwordx4 v105, s[8:11], s60 offen lds
  s_add_u32 s60, s60, s62
  s_add_u32 m0, s61, 4096
  s_nop 0
  buffer_load_dwordx4 v104, s[8:11], s60 offen lds
  s_add_u32 s60, s60, s62
  s_add_u32 m0, s61, 5120
  s_nop 0
  buffer_load_dwordx4 v105, s[8:11], s60 offen lds
  s_add_u32 s60, s60, s62
  s_add_u32 m0, s61, 6144
  s_nop 0
  buffer_load_dwordx4 v104, s[8:11], s60 offen lds
  s_add_u32 s60, s60, s62
  s_add_u32 m0, s61, 7168
  s_nop 0
  buffer_load_dwordx4 v105, s[8:11], s60 offen lds
  v_add_u32 v106, 32768, v108
  v_add_u32 v107, 32768, v109
  ds_read_b64_tr_b16 a[112:113], v106 offset:0
  ds_read_b64_tr_b16 a[114:115], v106 offset:2048
  ds_read_b64_tr_b16 v[208:209], v107 offset:0
  ds_read_b64_tr_b16 v[210:211], v107 offset:2048
  ds_read_b64_tr_b16 a[116:117], v106 offset:8192
  ds_read_b64_tr_b16 a[118:119], v106 offset:10240
  ds_read_b64_tr_b16 v[212:213], v107 offset:8192
  ds_read_b64_tr_b16 v[214:215], v107 offset:10240
  s_waitcnt lgkmcnt(0)
  ds_read_b64_tr_b16 a[120:121], v106 offset:16384
  ds_read_b64_tr_b16 a[122:123], v106 offset:18432
  ds_read_b64_tr_b16 v[216:217], v107 offset:16384
  ds_read_b64_tr_b16 v[218:219], v107 offset:18432
  ds_read_b64_tr_b16 a[124:125], v106 offset:24576
  ds_read_b64_tr_b16 a[126:127], v106 offset:26624
  ds_read_b64_tr_b16 v[220:221], v107 offset:24576
  ds_read_b64_tr_b16 v[222:223], v107 offset:26624
  s_waitcnt lgkmcnt(0)
  s_waitcnt vmcnt(8)
  s_barrier
  v_add_u32 v106, 65536, v108
  v_add_u32 v107, 65536, v109
  ds_read_b64_tr_b16 a[128:129], v106 offset:0
  ds_read_b64_tr_b16 a[130:131], v106 offset:2048
  ds_read_b64_tr_b16 v[224:225], v107 offset:0
  ds_read_b64_tr_b16 v[226:227], v107 offset:2048
  ds_read_b64_tr_b16 a[132:133], v106 offset:8192
  ds_read_b64_tr_b16 a[134:135], v106 offset:10240
  ds_read_b64_tr_b16 v[228:229], v107 offset:8192
  ds_read_b64_tr_b16 v[230:231], v107 offset:10240
  s_waitcnt lgkmcnt(0)
  ds_read_b64_tr_b16 a[136:137], v106 offset:16384
  ds_read_b64_tr_b16 a[138:139], v106 offset:18432
  ds_read_b64_tr_b16 v[232:233], v107 offset:16384
  ds_read_b64_tr_b16 v[234:235], v107 offset:18432
  ds_read_b64_tr_b16 a[140:141], v106 offset:24576
  ds_read_b64_tr_b16 a[142:143], v106 offset:26624
  ds_read_b64_tr_b16 v[236:237], v107 offset:24576
  ds_read_b64_tr_b16 v[238:239], v107 offset:26624
  s_waitcnt lgkmcnt(0)
  s_waitcnt vmcnt(0)
  s_barrier
  v_add_u32 v106, 0, v108
  v_add_u32 v107, 0, v109
  ds_read_b64_tr_b16 a[144:145], v106 offset:0
  ds_read_b64_tr_b16 a[146:147], v106 offset:2048
  ds_read_b64_tr_b16 v[240:241], v107 offset:0
  ds_read_b64_tr_b16 v[242:243], v107 offset:2048
  ds_read_b64_tr_b16 a[148:149], v106 offset:8192
  ds_read_b64_tr_b16 a[150:151], v106 offset:10240
  ds_read_b64_tr_b16 v[244:245], v107 offset:8192
  ds_read_b64_tr_b16 v[246:247], v107 offset:10240
  s_waitcnt lgkmcnt(0)
  ds_read_b64_tr_b16 a[152:153], v106 offset:16384
  ds_read_b64_tr_b16 a[154:155], v106 offset:18432
  ds_read_b64_tr_b16 v[248:249], v107 offset:16384
  ds_read_b64_tr_b16 v[250:251], v107 offset:18432
  ds_read_b64_tr_b16 a[156:157], v106 offset:24576
  ds_read_b64_tr_b16 a[158:159], v106 offset:26624
  ds_read_b64_tr_b16 v[252:253], v107 offset:24576
  ds_read_b64_tr_b16 v[254:255], v107 offset:26624
  s_waitcnt lgkmcnt(0)
  s_barrier
  v_lshlrev_b32 v88, 4, v0
  v_lshrrev_b32 v98, 4, v0
  s_and_b32 s60, s32, 1
  s_lshl_b32 s60, s60, 3
  v_add_u32 v99, 0, v98
  v_add_u32 v100, s60, v99
  v_and_b32 v101, 15, v0
  v_xor_b32 v101, v101, v100
  v_mul_u32_u24 v99, 1280, v99
  v_lshl_add_u32 v89, v101, 4, v99
  v_add_u32 v89, 1024, v89
  v_add_u32 v99, 4, v98
  v_add_u32 v100, s60, v99
  v_and_b32 v101, 15, v0
  v_xor_b32 v101, v101, v100
  v_mul_u32_u24 v99, 1280, v99
  v_lshl_add_u32 v90, v101, 4, v99
  v_add_u32 v90, 1024, v90
  v_and_b32 v98, 31, v0
  v_bfe_u32 v100, v98, 4, 1
  v_lshlrev_b32 v99, 4, v100
  v_bfe_u32 v100, v98, 2, 1
  v_lshl_add_u32 v99, v100, 3, v99
  v_bfe_u32 v100, v98, 3, 1
  v_lshl_add_u32 v99, v100, 2, v99
  v_and_b32 v100, 3, v98
  v_add_u32 v99, v99, v100
  v_lshrrev_b32 v100, 5, v0
  v_mul_u32_u24 v10, 1040, v99
  v_lshl_add_u32 v10, v100, 4, v10
  v_xor_b32 v101, v100, v99
  v_and_b32 v101, 15, v101
  v_lshlrev_b32 v101, 4, v101
  v_lshl_add_u32 v11, v99, 8, v101
  v_add_u32 v11, 33280, v11
  s_lshl_b32 s60, s32, 12
  s_add_u32 s60, s60, 126976
  s_cmp_eq_u32 s45, 0
  s_cselect_b32 s64, 64, 2048
  s_cselect_b32 s65, 64, 0
  s_cselect_b32 s61, 8, 16
  s_mul_i32 s66, s61, s50
  s_cselect_b64 vcc, -1, 0
  v_and_b32 v102, 3, v99
  v_lshrrev_b32 v103, 1, v99
  v_and_b32 v103, 4, v103
  v_or_b32 v102, v102, v103
  v_xor_b32 v102, v102, v100
  v_lshlrev_b32 v102, 4, v102
  v_lshl_add_u32 v102, v99, 7, v102
  v_and_b32 v103, 31, v0
  v_lshlrev_b32 v103, 6, v103
  v_lshl_add_u32 v103, v100, 4, v103
  v_cndmask_b32 v2, v103, v102, vcc
  v_add_u32 v2, s60, v2
  v_lshrrev_b32 v102, 3, v0
  v_and_b32 v103, 3, v102
  v_and_b32 v104, 7, v0
  v_xor_b32 v103, v103, v104
  v_lshlrev_b32 v103, 4, v103
  v_lshl_add_u32 v103, v102, 7, v103
  v_lshlrev_b32 v105, 4, v0
  v_cndmask_b32 v3, v105, v103, vcc
  v_add_u32 v3, s60, v3
  v_lshrrev_b32 v103, 2, v0
  v_cndmask_b32 v102, v103, v102, vcc
  v_mul_lo_u32 v102, s50, v102
  v_and_b32 v103, 3, v0
  v_cndmask_b32 v103, v103, v104, vcc
  v_lshl_add_u32 v4, v103, 4, v102
  s_cmp_lt_u32 s32, s53
  s_cselect_b32 s48, s48, 0x10000000
  s_mov_b32 s54, 0
  s_mov_b32 s57, 0
  s_mul_i32 s60, s32, 8320
  s_add_u32 s60, s60, s57
  s_mul_i32 s61, s32, 10240
  s_add_u32 s61, s61, s46
  s_mov_b32 s62, s61
  s_add_u32 m0, s60, 0
  s_nop 0
  buffer_load_dwordx4 v88, s[12:15], s62 offen lds
  s_add_u32 s62, s62, 1280
  s_add_u32 m0, s60, 1040
  s_nop 0
  buffer_load_dwordx4 v88, s[12:15], s62 offen lds
  s_add_u32 s62, s62, 1280
  s_add_u32 m0, s60, 2080
  s_nop 0
  buffer_load_dwordx4 v88, s[12:15], s62 offen lds
  s_add_u32 s62, s62, 1280
  s_add_u32 m0, s60, 3120
  s_nop 0
  buffer_load_dwordx4 v88, s[12:15], s62 offen lds
  s_add_u32 s62, s62, 1280
  s_add_u32 m0, s60, 4160
  s_nop 0
  buffer_load_dwordx4 v88, s[12:15], s62 offen lds
  s_add_u32 s62, s62, 1280
  s_add_u32 m0, s60, 5200
  s_nop 0
  buffer_load_dwordx4 v88, s[12:15], s62 offen lds
  s_add_u32 s62, s62, 1280
  s_add_u32 m0, s60, 6240
  s_nop 0
  buffer_load_dwordx4 v88, s[12:15], s62 offen lds
  s_add_u32 s62, s62, 1280
  s_add_u32 m0, s60, 7280
  s_nop 0
  buffer_load_dwordx4 v88, s[12:15], s62 offen lds
  s_add_u32 s62, s62, 1280
  s_lshl_b32 s60, s32, 11
  s_add_u32 s60, s60, s57
  s_add_u32 m0, s60, 33280
  s_nop 0
  buffer_load_dwordx4 v89, s[12:15], s61 offen lds
  s_add_u32 m0, s60, 34304
  s_nop 0
  buffer_load_dwordx4 v90, s[12:15], s61 offen lds
  s_add_u32 s46, s46, 40960
  s_mov_b32 s57, 41472
  s_mul_i32 s60, s32, 8320
  s_add_u32 s60, s60, s57
  s_mul_i32 s61, s32, 10240
  s_add_u32 s61, s61, s46
  s_mov_b32 s62, s61
  s_add_u32 m0, s60, 0
  s_nop 0
  buffer_load_dwordx4 v88, s[12:15], s62 offen lds
  s_add_u32 s62, s62, 1280
  s_add_u32 m0, s60, 1040
  s_nop 0
  buffer_load_dwordx4 v88, s[12:15], s62 offen lds
  s_add_u32 s62, s62, 1280
  s_add_u32 m0, s60, 2080
  s_nop 0
  buffer_load_dwordx4 v88, s[12:15], s62 offen lds
  s_add_u32 s62, s62, 1280
  s_add_u32 m0, s60, 3120
  s_nop 0
  buffer_load_dwordx4 v88, s[12:15], s62 offen lds
  s_add_u32 s62, s62, 1280
  s_add_u32 m0, s60, 4160
  s_nop 0
  buffer_load_dwordx4 v88, s[12:15], s62 offen lds
  s_add_u32 s62, s62, 1280
  s_add_u32 m0, s60, 5200
  s_nop 0
  buffer_load_dwordx4 v88, s[12:15], s62 offen lds
  s_add_u32 s62, s62, 1280
  s_add_u32 m0, s60, 6240
  s_nop 0
  buffer_load_dwordx4 v88, s[12:15], s62 offen lds
  s_add_u32 s62, s62, 1280
  s_add_u32 m0, s60, 7280
  s_nop 0
  buffer_load_dwordx4 v88, s[12:15], s62 offen lds
  s_add_u32 s62, s62, 1280
  s_lshl_b32 s60, s32, 11
  s_add_u32 s60, s60, s57
  s_add_u32 m0, s60, 33280
  s_nop 0
  buffer_load_dwordx4 v89, s[12:15], s61 offen lds
  s_add_u32 m0, s60, 34304
  s_nop 0
  buffer_load_dwordx4 v90, s[12:15], s61 offen lds
  s_add_u32 s46, s46, 40960
  s_mov_b32 s57, 82944
  s_mov_b32 s55, 0
  s_waitcnt vmcnt(10)
  s_cmp_eq_u32 s45, 0
  s_cbranch_scc0 G_t1
  s_barrier
  s_mul_i32 s60, s32, 8320
  s_add_u32 s60, s60, s57
  s_mul_i32 s61, s32, 10240
  s_add_u32 s61, s61, s46
  s_mov_b32 s62, s61
  s_add_u32 m0, s60, 0
  s_nop 0
  buffer_load_dwordx4 v88, s[12:15], s62 offen lds
  s_add_u32 s62, s62, 1280
  s_add_u32 m0, s60, 1040
  s_nop 0
  buffer_load_dwordx4 v88, s[12:15], s62 offen lds
  s_add_u32 s62, s62, 1280
  s_add_u32 m0, s60, 2080
  s_nop 0
  buffer_load_dwordx4 v88, s[12:15], s62 offen lds
  s_add_u32 s62, s62, 1280
  s_add_u32 m0, s60, 3120
  s_nop 0
  buffer_load_dwordx4 v88, s[12:15], s62 offen lds
  s_add_u32 s62, s62, 1280
  s_add_u32 m0, s60, 4160
  s_nop 0
  buffer_load_dwordx4 v88, s[12:15], s62 offen lds
  s_add_u32 s62, s62, 1280
  s_add_u32 m0, s60, 5200
  s_nop 0
  buffer_load_dwordx4 v88, s[12:15], s62 offen lds
  s_add_u32 s62, s62, 1280
  s_add_u32 m0, s60, 6240
  s_nop 0
  buffer_load_dwordx4 v88, s[12:15], s62 offen lds
  s_add_u32 s62, s62, 1280
  s_add_u32 m0, s60, 7280
  s_nop 0
  buffer_load_dwordx4 v88, s[12:15], s62 offen lds
  s_add_u32 s62, s62, 1280
  s_lshl_b32 s60, s32, 11
  s_add_u32 s60, s60, s57
  s_add_u32 m0, s60, 33280
  s_nop 0
  buffer_load_dwordx4 v89, s[12:15], s61 offen lds
  s_add_u32 m0, s60, 34304
  s_nop 0
  buffer_load_dwordx4 v90, s[12:15], s61 offen lds
  s_add_u32 s46, s46, 40960
  v_add_u32 v8, s55, v10
  v_add_u32 v9, s55, v11
  ds_read_b128 v[64:67], v8 offset:0
  ds_read_b128 v[68:71], v8 offset:32
  ds_read_b128 v[72:75], v8 offset:64
  ds_read_b128 v[76:79], v8 offset:96
  ds_read_b128 v[80:83], v8 offset:128
  ds_read_b128 v[84:87], v8 offset:160
  s_waitcnt lgkmcnt(5)
  v_mfma_f32_32x32x16_bf16 v[32:47], a[0:3], v[64:67], 0
  v_mfma_f32_32x32x16_bf16 v[48:63], a[160:163], v[64:67], 0
  ds_read_b128 v[64:67], v8 offset:192
  s_waitcnt lgkmcnt(5)
  v_mfma_f32_32x32x16_bf16 v[32:47], a[4:7], v[68:71], v[32:47]
  v_mfma_f32_32x32x16_bf16 v[48:63], a[164:167], v[68:71], v[48:63]
  ds_read_b128 v[68:71], v8 offset:224
  s_waitcnt lgkmcnt(5)
  v_mfma_f32_32x32x16_bf16 v[32:47], a[8:11], v[72:75], v[32:47]
  v_mfma_f32_32x32x16_bf16 v[48:63], a[168:171], v[72:75], v[48:63]
  ds_read_b128 v[72:75], v8 offset:256
  s_waitcnt lgkmcnt(5)
  v_mfma_f32_32x32x16_bf16 v[32:47], a[12:15], v[76:79], v[32:47]
  v_mfma_f32_32x32x16_bf16 v[48:63], a[172:175], v[76:79], v[48:63]
  ds_read_b128 v[76:79], v8 offset:288
  s_waitcnt lgkmcnt(5)
  v_mfma_f32_32x32x16_bf16 v[32:47], a[16:19], v[80:83], v[32:47]
  v_mfma_f32_32x32x16_bf16 v[48:63], a[176:179], v[80:83], v[48:63]
  ds_read_b128 v[80:83], v8 offset:320
  s_waitcnt lgkmcnt(5)
  v_mfma_f32_32x32x16_bf16 v[32:47], a[20:23], v[84:87], v[32:47]
  v_mfma_f32_32x32x16_bf16 v[48:63], a[180:183], v[84:87], v[48:63]
  ds_read_b128 v[84:87], v8 offset:352
  s_waitcnt lgkmcnt(5)
  v_mfma_f32_32x32x16_bf16 v[32:47], a[24:27], v[64:67], v[32:47]
  v_mfma_f32_32x32x16_bf16 v[48:63], a[184:187], v[64:67], v[48:63]
  ds_read_b128 v[64:67], v8 offset:384
  s_waitcnt lgkmcnt(5)
  v_mfma_f32_32x32x16_bf16 v[32:47], a[28:31], v[68:71], v[32:47]
  v_mfma_f32_32x32x16_bf16 v[48:63], a[188:191], v[68:71], v[48:63]
  ds_read_b128 v[68:71], v8 offset:416
  s_waitcnt lgkmcnt(5)
  v_mfma_f32_32x32x16_bf16 v[32:47], a[32:35], v[72:75], v[32:47]
  v_mfma_f32_32x32x16_bf16 v[48:63], a[192:195], v[72:75], v[48:63]
  ds_read_b128 v[72:75], v8 offset:448
  s_waitcnt lgkmcnt(5)
  v_mfma_f32_32x32x16_bf16 v[32:47], a[36:39], v[76:79], v[32:47]
  v_mfma_f32_32x32x16_bf16 v[48:63], a[196:199], v[76:79], v[48:63]
  ds_read_b128 v[76:79], v8 offset:480
  s_waitcnt lgkmcnt(5)
  v_mfma_f32_32x32x16_bf16 v[32:47], a[40:43], v[80:83], v[32:47]
  v_mfma_f32_32x32x16_bf16 v[48:63], a[200:203], v[80:83], v[48:63]
  ds_read_b128 v[80:83], v8 offset:512
  s_waitcnt lgkmcnt(5)
  v_mfma_f32_32x32x16_bf16 v[32:47], a[44:47], v[84:87], v[32:47]
  v_mfma_f32_32x32x16_bf16 v[48:63], a[204:207], v[84:87], v[48:63]
  ds_read_b128 v[84:87], v8 offset:544
  s_waitcnt lgkmcnt(5)
  v_mfma_f32_32x32x16_bf16 v[32:47], a[48:51], v[64:67], v[32:47]
  v_mfma_f32_32x32x16_bf16 v[48:63], a[208:211], v[64:67], v[48:63]
  ds_read_b128 v[64:67], v8 offset:576
  s_waitcnt lgkmcnt(5)
  v_mfma_f32_32x32x16_bf16 v[32:47], a[52:55], v[68:71], v[32:47]
  v_mfma_f32_32x32x16_bf16 v[48:63], a[212:215], v[68:71], v[48:63]
  ds_read_b128 v[68:71], v8 offset:608
  s_waitcnt lgkmcnt(5)
  v_mfma_f32_32x32x16_bf16 v[32:47], a[56:59], v[72:75], v[32:47]
  v_mfma_f32_32x32x16_bf16 v[48:63], a[216:219], v[72:75], v[48:63]
  ds_read_b128 v[72:75], v8 offset:640
  s_waitcnt lgkmcnt(5)
  v_mfma_f32_32x32x16_bf16 v[32:47], a[60:63], v[76:79], v[32:47]
  v_mfma_f32_32x32x16_bf16 v[48:63], a[220:223], v[76:79], v[48:63]
  ds_read_b128 v[76:79], v8 offset:672
  s_waitcnt lgkmcnt(5)
  v_mfma_f32_32x32x16_bf16 v[32:47], a[64:67], v[80:83], v[32:47]
  v_mfma_f32_32x32x16_bf16 v[48:63], a[224:227], v[80:83], v[48:63]
  ds_read_b128 v[80:83], v8 offset:704
  s_waitcnt lgkmcnt(5)
  v_mfma_f32_32x32x16_bf16 v[32:47], a[68:71], v[84:87], v[32:47]
  v_mfma_f32_32x32x16_bf16 v[48:63], a[228:231], v[84:87], v[48:63]
  ds_read_b128 v[84:87], v8 offset:736
  s_waitcnt lgkmcnt(5)
  v_mfma_f32_32x32x16_bf16 v[32:47], a[72:75], v[64:67], v[32:47]
  v_mfma_f32_32x32x16_bf16 v[48:63], a[232:235], v[64:67], v[48:63]
  ds_read_b128 v[64:67], v8 offset:768
  s_waitcnt lgkmcnt(5)
  v_mfma_f32_32x32x16_bf16 v[32:47], a[76:79], v[68:71], v[32:47]
  v_mfma_f32_32x32x16_bf16 v[48:63], a[236:239], v[68:71], v[48:63]
  ds_read_b128 v[68:71], v8 offset:800
  s_waitcnt lgkmcnt(5)
  v_mfma_f32_32x32x16_bf16 v[32:47], a[80:83], v[72:75], v[32:47]
  v_mfma_f32_32x32x16_bf16 v[48:63], a[240:243], v[72:75], v[48:63]
  ds_read_b128 v[72:75], v8 offset:832
  s_waitcnt lgkmcnt(5)
  v_mfma_f32_32x32x16_bf16 v[32:47], a[84:87], v[76:79], v[32:47]
  v_mfma_f32_32x32x16_bf16 v[48:63], a[244:247], v[76:79], v[48:63]
  ds_read_b128 v[76:79], v8 offset:864
  s_waitcnt lgkmcnt(5)
  v_mfma_f32_32x32x16_bf16 v[32:47], a[88:91], v[80:83], v[32:47]
  v_mfma_f32_32x32x16_bf16 v[48:63], a[248:251], v[80:83], v[48:63]
  ds_read_b128 v[80:83], v8 offset:896
  s_waitcnt lgkmcnt(5)
  v_mfma_f32_32x32x16_bf16 v[32:47], a[92:95], v[84:87], v[32:47]
  v_mfma_f32_32x32x16_bf16 v[48:63], a[252:255], v[84:87], v[48:63]
  ds_read_b128 v[84:87], v8 offset:928
  s_waitcnt lgkmcnt(5)
  v_mfma_f32_32x32x16_bf16 v[32:47], a[96:99], v[64:67], v[32:47]
  v_mfma_f32_32x32x16_bf16 v[48:63], v[192:195], v[64:67], v[48:63]
  ds_read_b128 v[64:67], v8 offset:960
  s_waitcnt lgkmcnt(5)
  v_mfma_f32_32x32x16_bf16 v[32:47], a[100:103], v[68:71], v[32:47]
  v_mfma_f32_32x32x16_bf16 v[48:63], v[196:199], v[68:71], v[48:63]
  ds_read_b128 v[68:71], v8 offset:992
  s_waitcnt lgkmcnt(5)
  v_mfma_f32_32x32x16_bf16 v[32:47], a[104:107], v[72:75], v[32:47]
  v_mfma_f32_32x32x16_bf16 v[48:63], v[200:203], v[72:75], v[48:63]
  v_xor_b32 v12, 0, v9
  ds_read_b128 v[72:75], v12
  s_waitcnt lgkmcnt(5)
  v_mfma_f32_32x32x16_bf16 v[32:47], a[108:111], v[76:79], v[32:47]
  v_mfma_f32_32x32x16_bf16 v[48:63], v[204:207], v[76:79], v[48:63]
  v_xor_b32 v13, 32, v9
  ds_read_b128 v[76:79], v13
  s_waitcnt lgkmcnt(5)
  v_mfma_f32_32x32x16_bf16 v[32:47], a[112:115], v[80:83], v[32:47]
  v_mfma_f32_32x32x16_bf16 v[48:63], v[208:211], v[80:83], v[48:63]
  v_xor_b32 v12, 64, v9
  ds_read_b128 v[80:83], v12
  s_waitcnt lgkmcnt(5)
  v_mfma_f32_32x32x16_bf16 v[32:47], a[116:119], v[84:87], v[32:47]
  v_mfma_f32_32x32x16_bf16 v[48:63], v[212:215], v[84:87], v[48:63]
  v_xor_b32 v13, 96, v9
  ds_read_b128 v[84:87], v13
  s_waitcnt lgkmcnt(5)
  v_mfma_f32_32x32x16_bf16 v[32:47], a[120:123], v[64:67], v[32:47]
  v_mfma_f32_32x32x16_bf16 v[48:63], v[216:219], v[64:67], v[48:63]
  v_xor_b32 v12, 128, v9
  ds_read_b128 v[64:67], v12
  s_waitcnt lgkmcnt(5)
  v_mfma_f32_32x32x16_bf16 v[32:47], a[124:127], v[68:71], v[32:47]
  v_mfma_f32_32x32x16_bf16 v[48:63], v[220:223], v[68:71], v[48:63]
  v_xor_b32 v13, 160, v9
  ds_read_b128 v[68:71], v13
  s_waitcnt lgkmcnt(5)
  v_mfma_f32_32x32x16_bf16 v[32:47], a[128:131], v[72:75], v[32:47]
  v_mfma_f32_32x32x16_bf16 v[48:63], v[224:227], v[72:75], v[48:63]
  v_xor_b32 v12, 192, v9
  ds_read_b128 v[72:75], v12
  s_waitcnt lgkmcnt(5)
  v_mfma_f32_32x32x16_bf16 v[32:47], a[132:135], v[76:79], v[32:47]
  v_mfma_f32_32x32x16_bf16 v[48:63], v[228:231], v[76:79], v[48:63]
  s_waitcnt vmcnt(0)
  s_barrier
  v_xor_b32 v13, 224, v9
  ds_read_b128 v[76:79], v13
  s_waitcnt lgkmcnt(5)
  v_mfma_f32_32x32x16_bf16 v[32:47], a[136:139], v[80:83], v[32:47]
  v_mfma_f32_32x32x16_bf16 v[48:63], v[232:235], v[80:83], v[48:63]
  s_waitcnt lgkmcnt(4)
  v_mfma_f32_32x32x16_bf16 v[32:47], a[140:143], v[84:87], v[32:47]
  v_mfma_f32_32x32x16_bf16 v[48:63], v[236:239], v[84:87], v[48:63]
  s_waitcnt lgkmcnt(3)
  v_mfma_f32_32x32x16_bf16 v[32:47], a[144:147], v[64:67], v[32:47]
  v_mfma_f32_32x32x16_bf16 v[48:63], v[240:243], v[64:67], v[48:63]
  s_waitcnt lgkmcnt(2)
  v_mfma_f32_32x32x16_bf16 v[32:47], a[148:151], v[68:71], v[32:47]
  v_mfma_f32_32x32x16_bf16 v[48:63], v[244:247], v[68:71], v[48:63]
  s_waitcnt lgkmcnt(1)
  v_mfma_f32_32x32x16_bf16 v[32:47], a[152:155], v[72:75], v[32:47]
  v_mfma_f32_32x32x16_bf16 v[48:63], v[248:251], v[72:75], v[48:63]
  s_waitcnt lgkmcnt(0)
  v_mfma_f32_32x32x16_bf16 v[32:47], a[156:159], v[76:79], v[32:47]
  v_mfma_f32_32x32x16_bf16 v[48:63], v[252:255], v[76:79], v[48:63]
  s_mov_b32 s60, s55
  s_add_u32 s55, s55, 41472
  s_cmp_eq_u32 s55, 124416
  s_cselect_b32 s55, 0, s55
  s_mov_b32 s57, s60
  s_add_u32 s54, s54, 1
G_loop0:
  s_barrier
  s_mul_i32 s60, s32, 8320
  s_add_u32 s60, s60, s57
  s_mul_i32 s61, s32, 10240
  s_add_u32 s61, s61, s46
  s_mov_b32 s62, s61
  s_add_u32 m0, s60, 0
  s_nop 0
  buffer_load_dwordx4 v88, s[12:15], s62 offen lds
  s_add_u32 s62, s62, 1280
  s_add_u32 m0, s60, 1040
  s_nop 0
  buffer_load_dwordx4 v88, s[12:15], s62 offen lds
  s_add_u32 s62, s62, 1280
  s_add_u32 m0, s60, 2080
  s_nop 0
  buffer_load_dwordx4 v88, s[12:15], s62 offen lds
  s_add_u32 s62, s62, 1280
  s_add_u32 m0, s60, 3120
  s_nop 0
  buffer_load_dwordx4 v88, s[12:15], s62 offen lds
  s_add_u32 s62, s62, 1280
  s_add_u32 m0, s60, 4160
  s_nop 0
  buffer_load_dwordx4 v88, s[12:15], s62 offen lds
  s_add_u32 s62, s62, 1280
  s_add_u32 m0, s60, 5200
  s_nop 0
  buffer_load_dwordx4 v88, s[12:15], s62 offen lds
  s_add_u32 s62, s62, 1280
  s_add_u32 m0, s60, 6240
  s_nop 0
  buffer_load_dwordx4 v88, s[12:15], s62 offen lds
  s_add_u32 s62, s62, 1280
  s_add_u32 m0, s60, 7280
  s_nop 0
  buffer_load_dwordx4 v88, s[12:15], s62 offen lds
  s_add_u32 s62, s62, 1280
  s_lshl_b32 s60, s32, 11
  s_add_u32 s60, s60, s57
  s_add_u32 m0, s60, 33280
  s_nop 0
  buffer_load_dwordx4 v89, s[12:15], s61 offen lds
  s_add_u32 m0, s60, 34304
  s_nop 0
  buffer_load_dwordx4 v90, s[12:15], s61 offen lds
  s_add_u32 s46, s46, 40960
  v_add_u32 v8, s55, v10
  v_add_u32 v9, s55, v11
  ds_read_b128 v[64:67], v8 offset:0
  ds_read_b128 v[68:71], v8 offset:32
  ds_read_b128 v[72:75], v8 offset:64
  ds_read_b128 v[76:79], v8 offset:96
  ds_read_b128 v[80:83], v8 offset:128
  ds_read_b128 v[84:87], v8 offset:160
  s_waitcnt lgkmcnt(5)
  v_mfma_f32_32x32x16_bf16 v[114:129], a[0:3], v[64:67], 0
  v_mfma_f32_32x32x16_bf16 v[130:145], a[160:163], v[64:67], 0
  ds_read_b128 v[64:67], v8 offset:192
  s_waitcnt lgkmcnt(5)
  v_mfma_f32_32x32x16_bf16 v[114:129], a[4:7], v[68:71], v[114:129]
  v_mfma_f32_32x32x16_bf16 v[130:145], a[164:167], v[68:71], v[130:145]
  ds_read_b128 v[68:71], v8 offset:224
  s_waitcnt lgkmcnt(5)
  v_mfma_f32_32x32x16_bf16 v[114:129], a[8:11], v[72:75], v[114:129]
  v_mfma_f32_32x32x16_bf16 v[130:145], a[168:171], v[72:75], v[130:145]
  v_cvt_pk_bf16_f32 v146, v32, v33
  v_cvt_pk_bf16_f32 v147, v34, v35
  v_cvt_pk_bf16_f32 v148, v36, v37
  v_cvt_pk_bf16_f32 v149, v38, v39
  s_mul_i32 s60, s64, 0
  s_add_u32 s60, s60, 0
  v_xor_b32 v5, s60, v2
  ds_write_b128 v5, v[146:149]
  ds_read_b128 v[72:75], v8 offset:256
  s_waitcnt lgkmcnt(6)
  v_mfma_f32_32x32x16_bf16 v[114:129], a[12:15], v[76:79], v[114:129]
  v_mfma_f32_32x32x16_bf16 v[130:145], a[172:175], v[76:79], v[130:145]
  v_cvt_pk_bf16_f32 v150, v40, v41
  v_cvt_pk_bf16_f32 v151, v42, v43
  v_cvt_pk_bf16_f32 v152, v44, v45
  v_cvt_pk_bf16_f32 v153, v46, v47
  s_mul_i32 s60, s64, 0
  s_add_u32 s60, s60, 32
  v_xor_b32 v6, s60, v2
  ds_write_b128 v6, v[150:153]
  ds_read_b128 v[76:79], v8 offset:288
  s_waitcnt lgkmcnt(7)
  v_mfma_f32_32x32x16_bf16 v[114:129], a[16:19], v[80:83], v[114:129]
  v_mfma_f32_32x32x16_bf16 v[130:145], a[176:179], v[80:83], v[130:145]
  v_cvt_pk_bf16_f32 v154, v48, v49
  v_cvt_pk_bf16_f32 v155, v50, v51
  v_cvt_pk_bf16_f32 v156, v52, v53
  v_cvt_pk_bf16_f32 v157, v54, v55
  s_mul_i32 s60, s64, 1
  s_add_u32 s60, s60, 0
  v_xor_b32 v5, s60, v2
  ds_write_b128 v5, v[154:157]
  ds_read_b128 v[80:83], v8 offset:320
  s_waitcnt lgkmcnt(8)
  v_mfma_f32_32x32x16_bf16 v[114:129], a[20:23], v[84:87], v[114:129]
  v_mfma_f32_32x32x16_bf16 v[130:145], a[180:183], v[84:87], v[130:145]
  v_cvt_pk_bf16_f32 v158, v56, v57
  v_cvt_pk_bf16_f32 v159, v58, v59
  v_cvt_pk_bf16_f32 v160, v60, v61
  v_cvt_pk_bf16_f32 v161, v62, v63
  s_mul_i32 s60, s64, 1
  s_add_u32 s60, s60, 32
  v_xor_b32 v6, s60, v2
  ds_write_b128 v6, v[158:161]
  ds_read_b128 v[84:87], v8 offset:352
  s_waitcnt lgkmcnt(9)
  v_mfma_f32_32x32x16_bf16 v[114:129], a[24:27], v[64:67], v[114:129]
  v_mfma_f32_32x32x16_bf16 v[130:145], a[184:187], v[64:67], v[130:145]
  ds_read_b128 v[64:67], v8 offset:384
  s_waitcnt lgkmcnt(9)
  v_mfma_f32_32x32x16_bf16 v[114:129], a[28:31], v[68:71], v[114:129]
  v_mfma_f32_32x32x16_bf16 v[130:145], a[188:191], v[68:71], v[130:145]
  s_waitcnt lgkmcnt(2)
  v_xor_b32 v5, s65, v3
  ds_read_b128 v[146:149], v3 offset:0
  ds_read_b128 v[150:153], v5 offset:1024
  ds_read_b128 v[154:157], v3 offset:2048
  ds_read_b128 v[158:161], v5 offset:3072
  ds_read_b128 v[68:71], v8 offset:416
  v_mfma_f32_32x32x16_bf16 v[114:129], a[32:35], v[72:75], v[114:129]
  v_mfma_f32_32x32x16_bf16 v[130:145], a[192:195], v[72:75], v[130:145]
  ds_read_b128 v[72:75], v8 offset:448
  v_mfma_f32_32x32x16_bf16 v[114:129], a[36:39], v[76:79], v[114:129]
  v_mfma_f32_32x32x16_bf16 v[130:145], a[196:199], v[76:79], v[130:145]
  s_waitcnt lgkmcnt(5)
  s_mov_b32 s61, s48
  buffer_store_dwordx4 v[146:149], v4, s[4:7], s61 offen sc1
  s_add_u32 s61, s61, s66
  ds_read_b128 v[76:79], v8 offset:480
  v_mfma_f32_32x32x16_bf16 v[114:129], a[40:43], v[80:83], v[114:129]
  v_mfma_f32_32x32x16_bf16 v[130:145], a[200:203], v[80:83], v[130:145]
  s_waitcnt lgkmcnt(5)
  buffer_store_dwordx4 v[150:153], v4, s[4:7], s61 offen sc1
  s_add_u32 s61, s61, s66
  ds_read_b128 v[80:83], v8 offset:512
  v_mfma_f32_32x32x16_bf16 v[114:129], a[44:47], v[84:87], v[114:129]
  v_mfma_f32_32x32x16_bf16 v[130:145], a[204:207], v[84:87], v[130:145]
  s_waitcnt lgkmcnt(5)
  buffer_store_dwordx4 v[154:157], v4, s[4:7], s61 offen sc1
  s_add_u32 s61, s61, s66
  ds_read_b128 v[84:87], v8 offset:544
  v_mfma_f32_32x32x16_bf16 v[114:129], a[48:51], v[64:67], v[114:129]
  v_mfma_f32_32x32x16_bf16 v[130:145], a[208:211], v[64:67], v[130:145]
  s_waitcnt lgkmcnt(5)
  buffer_store_dwordx4 v[158:161], v4, s[4:7], s61 offen sc1
  s_add_u32 s61, s61, s66
  s_add_u32 s48, s48, s49
  ds_read_b128 v[64:67], v8 offset:576
  s_waitcnt lgkmcnt(5)
  v_mfma_f32_32x32x16_bf16 v[114:129], a[52:55], v[68:71], v[114:129]
  v_mfma_f32_32x32x16_bf16 v[130:145], a[212:215], v[68:71], v[130:145]
  ds_read_b128 v[68:71], v8 offset:608
  s_waitcnt lgkmcnt(5)
  v_mfma_f32_32x32x16_bf16 v[114:129], a[56:59], v[72:75], v[114:129]
  v_mfma_f32_32x32x16_bf16 v[130:145], a[216:219], v[72:75], v[130:145]
  ds_read_b128 v[72:75], v8 offset:640
  s_waitcnt lgkmcnt(5)
  v_mfma_f32_32x32x16_bf16 v[114:129], a[60:63], v[76:79], v[114:129]
  v_mfma_f32_32x32x16_bf16 v[130:145], a[220:223], v[76:79], v[130:145]
  ds_read_b128 v[76:79], v8 offset:672
  s_waitcnt lgkmcnt(5)
  v_mfma_f32_32x32x16_bf16 v[114:129], a[64:67], v[80:83], v[114:129]
  v_mfma_f32_32x32x16_bf16 v[130:145], a[224:227], v[80:83], v[130:145]
  ds_read_b128 v[80:83], v8 offset:704
  s_waitcnt lgkmcnt(5)
  v_mfma_f32_32x32x16_bf16 v[114:129], a[68:71], v[84:87], v[114:129]
  v_mfma_f32_32x32x16_bf16 v[130:145], a[228:231], v[84:87], v[130:145]
  ds_read_b128 v[84:87], v8 offset:736
  s_waitcnt lgkmcnt(5)
  v_mfma_f32_32x32x16_bf16 v[114:129], a[72:75], v[64:67], v[114:129]
  v_mfma_f32_32x32x16_bf16 v[130:145], a[232:235], v[64:67], v[130:145]
  ds_read_b128 v[64:67], v8 offset:768
  s_waitcnt lgkmcnt(5)
  v_mfma_f32_32x32x16_bf16 v[114:129], a[76:79], v[68:71], v[114:129]
  v_mfma_f32_32x32x16_bf16 v[130:145], a[236:239], v[68:71], v[130:145]
  ds_read_b128 v[68:71], v8 offset:800
  s_waitcnt lgkmcnt(5)
  v_mfma_f32_32x32x16_bf16 v[114:129], a[80:83], v[72:75], v[114:129]
  v_mfma_f32_32x32x16_bf16 v[130:145], a[240:243], v[72:75], v[130:145]
  ds_read_b128 v[72:75], v8 offset:832
  s_waitcnt lgkmcnt(5)
  v_mfma_f32_32x32x16_bf16 v[114:129], a[84:87], v[76:79], v[114:129]
  v_mfma_f32_32x32x16_bf16 v[130:145], a[244:247], v[76:79], v[130:145]
  ds_read_b128 v[76:79], v8 offset:864
  s_waitcnt lgkmcnt(5)
  v_mfma_f32_32x32x16_bf16 v[114:129], a[88:91], v[80:83], v[114:129]
  v_mfma_f32_32x32x16_bf16 v[130:145], a[248:251], v[80:83], v[130:145]
  ds_read_b128 v[80:83], v8 offset:896
  s_waitcnt lgkmcnt(5)
  v_mfma_f32_32x32x16_bf16 v[114:129], a[92:95], v[84:87], v[114:129]
  v_mfma_f32_32x32x16_bf16 v[130:145], a[252:255], v[84:87], v[130:145]
  ds_read_b128 v[84:87], v8 offset:928
  s_waitcnt lgkmcnt(5)
  v_mfma_f32_32x32x16_bf16 v[114:129], a[96:99], v[64:67], v[114:129]
  v_mfma_f32_32x32x16_bf16 v[130:145], v[192:195], v[64:67], v[130:145]
  ds_read_b128 v[64:67], v8 offset:960
  s_waitcnt lgkmcnt(5)
  v_mfma_f32_32x32x16_bf16 v[114:129], a[100:103], v[68:71], v[114:129]
  v_mfma_f32_32x32x16_bf16 v[130:145], v[196:199], v[68:71], v[130:145]
  ds_read_b128 v[68:71], v8 offset:992
  s_waitcnt lgkmcnt(5)
  v_mfma_f32_32x32x16_bf16 v[114:129], a[104:107], v[72:75], v[114:129]
  v_mfma_f32_32x32x16_bf16 v[130:145], v[200:203], v[72:75], v[130:145]
  v_xor_b32 v12, 0, v9
  ds_read_b128 v[72:75], v12
  s_waitcnt lgkmcnt(5)
  v_mfma_f32_32x32x16_bf16 v[114:129], a[108:111], v[76:79], v[114:129]
  v_mfma_f32_32x32x16_bf16 v[130:145], v[204:207], v[76:79], v[130:145]
  v_xor_b32 v13, 32, v9
  ds_read_b128 v[76:79], v13
  s_waitcnt lgkmcnt(5)
  v_mfma_f32_32x32x16_bf16 v[114:129], a[112:115], v[80:83], v[114:129]
  v_mfma_f32_32x32x16_bf16 v[130:145], v[208:211], v[80:83], v[130:145]
  v_xor_b32 v12, 64, v9
  ds_read_b128 v[80:83], v12
  s_waitcnt lgkmcnt(5)
  v_mfma_f32_32x32x16_bf16 v[114:129], a[116:119], v[84:87], v[114:129]
  v_mfma_f32_32x32x16_bf16 v[130:145], v[212:215], v[84:87], v[130:145]
  v_xor_b32 v13, 96, v9
  ds_read_b128 v[84:87], v13
  s_waitcnt lgkmcnt(5)
  v_mfma_f32_32x32x16_bf16 v[114:129], a[120:123], v[64:67], v[114:129]
  v_mfma_f32_32x32x16_bf16 v[130:145], v[216:219], v[64:67], v[130:145]
  v_xor_b32 v12, 128, v9
  ds_read_b128 v[64:67], v12
  s_waitcnt lgkmcnt(5)
  v_mfma_f32_32x32x16_bf16 v[114:129], a[124:127], v[68:71], v[114:129]
  v_mfma_f32_32x32x16_bf16 v[130:145], v[220:223], v[68:71], v[130:145]
  v_xor_b32 v13, 160, v9
  ds_read_b128 v[68:71], v13
  s_waitcnt lgkmcnt(5)
  v_mfma_f32_32x32x16_bf16 v[114:129], a[128:131], v[72:75], v[114:129]
  v_mfma_f32_32x32x16_bf16 v[130:145], v[224:227], v[72:75], v[130:145]
  v_xor_b32 v12, 192, v9
  ds_read_b128 v[72:75], v12
  s_waitcnt lgkmcnt(5)
  v_mfma_f32_32x32x16_bf16 v[114:129], a[132:135], v[76:79], v[114:129]
  v_mfma_f32_32x32x16_bf16 v[130:145], v[228:231], v[76:79], v[130:145]
  s_waitcnt vmcnt(0)
  s_barrier
  s_cmp_eq_u32 s32, 0
  s_cbranch_scc0 G_nfb0
  v_mov_b32 v98, s54
  v_add_u32 v98, s3, v98
  v_mov_b32 v99, 0
  s_mov_b64 exec, 1
  buffer_store_dword v98, v99, s[4:7], s52 offen sc1
  s_mov_b64 exec, -1
G_nfb0:
  v_xor_b32 v13, 224, v9
  ds_read_b128 v[76:79], v13
  s_waitcnt lgkmcnt(5)
  v_mfma_f32_32x32x16_bf16 v[114:129], a[136:139], v[80:83], v[114:129]
  v_mfma_f32_32x32x16_bf16 v[130:145], v[232:235], v[80:83], v[130:145]
  s_waitcnt lgkmcnt(4)
  v_mfma_f32_32x32x16_bf16 v[114:129], a[140:143], v[84:87], v[114:129]
  v_mfma_f32_32x32x16_bf16 v[130:145], v[236:239], v[84:87], v[130:145]
  s_waitcnt lgkmcnt(3)
  v_mfma_f32_32x32x16_bf16 v[114:129], a[144:147], v[64:67], v[114:129]
  v_mfma_f32_32x32x16_bf16 v[130:145], v[240:243], v[64:67], v[130:145]
  s_waitcnt lgkmcnt(2)
  v_mfma_f32_32x32x16_bf16 v[114:129], a[148:151], v[68:71], v[114:129]
  v_mfma_f32_32x32x16_bf16 v[130:145], v[244:247], v[68:71], v[130:145]
  s_waitcnt lgkmcnt(1)
  v_mfma_f32_32x32x16_bf16 v[114:129], a[152:155], v[72:75], v[114:129]
  v_mfma_f32_32x32x16_bf16 v[130:145], v[248:251], v[72:75], v[130:145]
  s_waitcnt lgkmcnt(0)
  v_mfma_f32_32x32x16_bf16 v[114:129], a[156:159], v[76:79], v[114:129]
  v_mfma_f32_32x32x16_bf16 v[130:145], v[252:255], v[76:79], v[130:145]
  s_mov_b32 s60, s55
  s_add_u32 s55, s55, 41472
  s_cmp_eq_u32 s55, 124416
  s_cselect_b32 s55, 0, s55
  s_mov_b32 s57, s60
  s_add_u32 s54, s54, 1
  s_cmp_lt_u32 s54, s47
  s_cbranch_scc0 G_last1
  s_barrier
  s_mul_i32 s60, s32, 8320
  s_add_u32 s60, s60, s57
  s_mul_i32 s61, s32, 10240
  s_add_u32 s61, s61, s46
  s_mov_b32 s62, s61
  s_add_u32 m0, s60, 0
  s_nop 0
  buffer_load_dwordx4 v88, s[12:15], s62 offen lds
  s_add_u32 s62, s62, 1280
  s_add_u32 m0, s60, 1040
  s_nop 0
  buffer_load_dwordx4 v88, s[12:15], s62 offen lds
  s_add_u32 s62, s62, 1280
  s_add_u32 m0, s60, 2080
  s_nop 0
  buffer_load_dwordx4 v88, s[12:15], s62 offen lds
  s_add_u32 s62, s62, 1280
  s_add_u32 m0, s60, 3120
  s_nop 0
  buffer_load_dwordx4 v88, s[12:15], s62 offen lds
  s_add_u32 s62, s62, 1280
  s_add_u32 m0, s60, 4160
  s_nop 0
  buffer_load_dwordx4 v88, s[12:15], s62 offen lds
  s_add_u32 s62, s62, 1280
  s_add_u32 m0, s60, 5200
  s_nop 0
  buffer_load_dwordx4 v88, s[12:15], s62 offen lds
  s_add_u32 s62, s62, 1280
  s_add_u32 m0, s60, 6240
  s_nop 0
  buffer_load_dwordx4 v88, s[12:15], s62 offen lds
  s_add_u32 s62, s62, 1280
  s_add_u32 m0, s60, 7280
  s_nop 0
  buffer_load_dwordx4 v88, s[12:15], s62 offen lds
  s_add_u32 s62, s62, 1280
  s_lshl_b32 s60, s32, 11
  s_add_u32 s60, s60, s57
  s_add_u32 m0, s60, 33280
  s_nop 0
  buffer_load_dwordx4 v89, s[12:15], s61 offen lds
  s_add_u32 m0, s60, 34304
  s_nop 0
  buffer_load_dwordx4 v90, s[12:15], s61 offen lds
  s_add_u32 s46, s46, 40960
  v_add_u32 v8, s55, v10
  v_add_u32 v9, s55, v11
  ds_read_b128 v[64:67], v8 offset:0
  ds_read_b128 v[68:71], v8 offset:32
  ds_read_b128 v[72:75], v8 offset:64
  ds_read_b128 v[76:79], v8 offset:96
  ds_read_b128 v[80:83], v8 offset:128
  ds_read_b128 v[84:87], v8 offset:160
  s_waitcnt lgkmcnt(5)
  v_mfma_f32_32x32x16_bf16 v[32:47], a[0:3], v[64:67], 0
  v_mfma_f32_32x32x16_bf16 v[48:63], a[160:163], v[64:67], 0
  ds_read_b128 v[64:67], v8 offset:192
  s_waitcnt lgkmcnt(5)
  v_mfma_f32_32x32x16_bf16 v[32:47], a[4:7], v[68:71], v[32:47]
  v_mfma_f32_32x32x16_bf16 v[48:63], a[164:167], v[68:71], v[48:63]
  ds_read_b128 v[68:71], v8 offset:224
  s_waitcnt lgkmcnt(5)
  v_mfma_f32_32x32x16_bf16 v[32:47], a[8:11], v[72:75], v[32:47]
  v_mfma_f32_32x32x16_bf16 v[48:63], a[168:171], v[72:75], v[48:63]
  v_cvt_pk_bf16_f32 v146, v114, v115
  v_cvt_pk_bf16_f32 v147, v116, v117
  v_cvt_pk_bf16_f32 v148, v118, v119
  v_cvt_pk_bf16_f32 v149, v120, v121
  s_mul_i32 s60, s64, 0
  s_add_u32 s60, s60, 0
  v_xor_b32 v5, s60, v2
  ds_write_b128 v5, v[146:149]
  ds_read_b128 v[72:75], v8 offset:256
  s_waitcnt lgkmcnt(6)
  v_mfma_f32_32x32x16_bf16 v[32:47], a[12:15], v[76:79], v[32:47]
  v_mfma_f32_32x32x16_bf16 v[48:63], a[172:175], v[76:79], v[48:63]
  v_cvt_pk_bf16_f32 v150, v122, v123
  v_cvt_pk_bf16_f32 v151, v124, v125
  v_cvt_pk_bf16_f32 v152, v126, v127
  v_cvt_pk_bf16_f32 v153, v128, v129
  s_mul_i32 s60, s64, 0
  s_add_u32 s60, s60, 32
  v_xor_b32 v6, s60, v2
  ds_write_b128 v6, v[150:153]
  ds_read_b128 v[76:79], v8 offset:288
  s_waitcnt lgkmcnt(7)
  v_mfma_f32_32x32x16_bf16 v[32:47], a[16:19], v[80:83], v[32:47]
  v_mfma_f32_32x32x16_bf16 v[48:63], a[176:179], v[80:83], v[48:63]
  v_cvt_pk_bf16_f32 v154, v130, v131
  v_cvt_pk_bf16_f32 v155, v132, v133
  v_cvt_pk_bf16_f32 v156, v134, v135
  v_cvt_pk_bf16_f32 v157, v136, v137
  s_mul_i32 s60, s64, 1
  s_add_u32 s60, s60, 0
  v_xor_b32 v5, s60, v2
  ds_write_b128 v5, v[154:157]
  ds_read_b128 v[80:83], v8 offset:320
  s_waitcnt lgkmcnt(8)
  v_mfma_f32_32x32x16_bf16 v[32:47], a[20:23], v[84:87], v[32:47]
  v_mfma_f32_32x32x16_bf16 v[48:63], a[180:183], v[84:87], v[48:63]
  v_cvt_pk_bf16_f32 v158, v138, v139
  v_cvt_pk_bf16_f32 v159, v140, v141
  v_cvt_pk_bf16_f32 v160, v142, v143
  v_cvt_pk_bf16_f32 v161, v144, v145
  s_mul_i32 s60, s64, 1
  s_add_u32 s60, s60, 32
  v_xor_b32 v6, s60, v2
  ds_write_b128 v6, v[158:161]
  ds_read_b128 v[84:87], v8 offset:352
  s_waitcnt lgkmcnt(9)
  v_mfma_f32_32x32x16_bf16 v[32:47], a[24:27], v[64:67], v[32:47]
  v_mfma_f32_32x32x16_bf16 v[48:63], a[184:187], v[64:67], v[48:63]
  ds_read_b128 v[64:67], v8 offset:384
  s_waitcnt lgkmcnt(9)
  v_mfma_f32_32x32x16_bf16 v[32:47], a[28:31], v[68:71], v[32:47]
  v_mfma_f32_32x32x16_bf16 v[48:63], a[188:191], v[68:71], v[48:63]
  s_waitcnt lgkmcnt(2)
  v_xor_b32 v5, s65, v3
  ds_read_b128 v[146:149], v3 offset:0
  ds_read_b128 v[150:153], v5 offset:1024
  ds_read_b128 v[154:157], v3 offset:2048
  ds_read_b128 v[158:161], v5 offset:3072
  ds_read_b128 v[68:71], v8 offset:416
  v_mfma_f32_32x32x16_bf16 v[32:47], a[32:35], v[72:75], v[32:47]
  v_mfma_f32_32x32x16_bf16 v[48:63], a[192:195], v[72:75], v[48:63]
  ds_read_b128 v[72:75], v8 offset:448
  v_mfma_f32_32x32x16_bf16 v[32:47], a[36:39], v[76:79], v[32:47]
  v_mfma_f32_32x32x16_bf16 v[48:63], a[196:199], v[76:79], v[48:63]
  s_waitcnt lgkmcnt(5)
  s_mov_b32 s61, s48
  buffer_store_dwordx4 v[146:149], v4, s[4:7], s61 offen sc1
  s_add_u32 s61, s61, s66
  ds_read_b128 v[76:79], v8 offset:480
  v_mfma_f32_32x32x16_bf16 v[32:47], a[40:43], v[80:83], v[32:47]
  v_mfma_f32_32x32x16_bf16 v[48:63], a[200:203], v[80:83], v[48:63]
  s_waitcnt lgkmcnt(5)
  buffer_store_dwordx4 v[150:153], v4, s[4:7], s61 offen sc1
  s_add_u32 s61, s61, s66
  ds_read_b128 v[80:83], v8 offset:512
  v_mfma_f32_32x32x16_bf16 v[32:47], a[44:47], v[84:87], v[32:47]
  v_mfma_f32_32x32x16_bf16 v[48:63], a[204:207], v[84:87], v[48:63]
  s_waitcnt lgkmcnt(5)
  buffer_store_dwordx4 v[154:157], v4, s[4:7], s61 offen sc1
  s_add_u32 s61, s61, s66
  ds_read_b128 v[84:87], v8 offset:544
  v_mfma_f32_32x32x16_bf16 v[32:47], a[48:51], v[64:67], v[32:47]
  v_mfma_f32_32x32x16_bf16 v[48:63], a[208:211], v[64:67], v[48:63]
  s_waitcnt lgkmcnt(5)
  buffer_store_dwordx4 v[158:161], v4, s[4:7], s61 offen sc1
  s_add_u32 s61, s61, s66
  s_add_u32 s48, s48, s49
  ds_read_b128 v[64:67], v8 offset:576
  s_waitcnt lgkmcnt(5)
  v_mfma_f32_32x32x16_bf16 v[32:47], a[52:55], v[68:71], v[32:47]
  v_mfma_f32_32x32x16_bf16 v[48:63], a[212:215], v[68:71], v[48:63]
  ds_read_b128 v[68:71], v8 offset:608
  s_waitcnt lgkmcnt(5)
  v_mfma_f32_32x32x16_bf16 v[32:47], a[56:59], v[72:75], v[32:47]
  v_mfma_f32_32x32x16_bf16 v[48:63], a[216:219], v[72:75], v[48:63]
  ds_read_b128 v[72:75], v8 offset:640
  s_waitcnt lgkmcnt(5)
  v_mfma_f32_32x32x16_bf16 v[32:47], a[60:63], v[76:79], v[32:47]
  v_mfma_f32_32x32x16_bf16 v[48:63], a[220:223], v[76:79], v[48:63]
  ds_read_b128 v[76:79], v8 offset:672
  s_waitcnt lgkmcnt(5)
  v_mfma_f32_32x32x16_bf16 v[32:47], a[64:67], v[80:83], v[32:47]
  v_mfma_f32_32x32x16_bf16 v[48:63], a[224:227], v[80:83], v[48:63]
  ds_read_b128 v[80:83], v8 offset:704
  s_waitcnt lgkmcnt(5)
  v_mfma_f32_32x32x16_bf16 v[32:47], a[68:71], v[84:87], v[32:47]
  v_mfma_f32_32x32x16_bf16 v[48:63], a[228:231], v[84:87], v[48:63]
  ds_read_b128 v[84:87], v8 offset:736
  s_waitcnt lgkmcnt(5)
  v_mfma_f32_32x32x16_bf16 v[32:47], a[72:75], v[64:67], v[32:47]
  v_mfma_f32_32x32x16_bf16 v[48:63], a[232:235], v[64:67], v[48:63]
  ds_read_b128 v[64:67], v8 offset:768
  s_waitcnt lgkmcnt(5)
  v_mfma_f32_32x32x16_bf16 v[32:47], a[76:79], v[68:71], v[32:47]
  v_mfma_f32_32x32x16_bf16 v[48:63], a[236:239], v[68:71], v[48:63]
  ds_read_b128 v[68:71], v8 offset:800
  s_waitcnt lgkmcnt(5)
  v_mfma_f32_32x32x16_bf16 v[32:47], a[80:83], v[72:75], v[32:47]
  v_mfma_f32_32x32x16_bf16 v[48:63], a[240:243], v[72:75], v[48:63]
  ds_read_b128 v[72:75], v8 offset:832
  s_waitcnt lgkmcnt(5)
  v_mfma_f32_32x32x16_bf16 v[32:47], a[84:87], v[76:79], v[32:47]
  v_mfma_f32_32x32x16_bf16 v[48:63], a[244:247], v[76:79], v[48:63]
  ds_read_b128 v[76:79], v8 offset:864
  s_waitcnt lgkmcnt(5)
  v_mfma_f32_32x32x16_bf16 v[32:47], a[88:91], v[80:83], v[32:47]
  v_mfma_f32_32x32x16_bf16 v[48:63], a[248:251], v[80:83], v[48:63]
  ds_read_b128 v[80:83], v8 offset:896
  s_waitcnt lgkmcnt(5)
  v_mfma_f32_32x32x16_bf16 v[32:47], a[92:95], v[84:87], v[32:47]
  v_mfma_f32_32x32x16_bf16 v[48:63], a[252:255], v[84:87], v[48:63]
  ds_read_b128 v[84:87], v8 offset:928
  s_waitcnt lgkmcnt(5)
  v_mfma_f32_32x32x16_bf16 v[32:47], a[96:99], v[64:67], v[32:47]
  v_mfma_f32_32x32x16_bf16 v[48:63], v[192:195], v[64:67], v[48:63]
  ds_read_b128 v[64:67], v8 offset:960
  s_waitcnt lgkmcnt(5)
  v_mfma_f32_32x32x16_bf16 v[32:47], a[100:103], v[68:71], v[32:47]
  v_mfma_f32_32x32x16_bf16 v[48:63], v[196:199], v[68:71], v[48:63]
  ds_read_b128 v[68:71], v8 offset:992
  s_waitcnt lgkmcnt(5)
  v_mfma_f32_32x32x16_bf16 v[32:47], a[104:107], v[72:75], v[32:47]
  v_mfma_f32_32x32x16_bf16 v[48:63], v[200:203], v[72:75], v[48:63]
  v_xor_b32 v12, 0, v9
  ds_read_b128 v[72:75], v12
  s_waitcnt lgkmcnt(5)
  v_mfma_f32_32x32x16_bf16 v[32:47], a[108:111], v[76:79], v[32:47]
  v_mfma_f32_32x32x16_bf16 v[48:63], v[204:207], v[76:79], v[48:63]
  v_xor_b32 v13, 32, v9
  ds_read_b128 v[76:79], v13
  s_waitcnt lgkmcnt(5)
  v_mfma_f32_32x32x16_bf16 v[32:47], a[112:115], v[80:83], v[32:47]
  v_mfma_f32_32x32x16_bf16 v[48:63], v[208:211], v[80:83], v[48:63]
  v_xor_b32 v12, 64, v9
  ds_read_b128 v[80:83], v12
  s_waitcnt lgkmcnt(5)
  v_mfma_f32_32x32x16_bf16 v[32:47], a[116:119], v[84:87], v[32:47]
  v_mfma_f32_32x32x16_bf16 v[48:63], v[212:215], v[84:87], v[48:63]
  v_xor_b32 v13, 96, v9
  ds_read_b128 v[84:87], v13
  s_waitcnt lgkmcnt(5)
  v_mfma_f32_32x32x16_bf16 v[32:47], a[120:123], v[64:67], v[32:47]
  v_mfma_f32_32x32x16_bf16 v[48:63], v[216:219], v[64:67], v[48:63]
  v_xor_b32 v12, 128, v9
  ds_read_b128 v[64:67], v12
  s_waitcnt lgkmcnt(5)
  v_mfma_f32_32x32x16_bf16 v[32:47], a[124:127], v[68:71], v[32:47]
  v_mfma_f32_32x32x16_bf16 v[48:63], v[220:223], v[68:71], v[48:63]
  v_xor_b32 v13, 160, v9
  ds_read_b128 v[68:71], v13
  s_waitcnt lgkmcnt(5)
  v_mfma_f32_32x32x16_bf16 v[32:47], a[128:131], v[72:75], v[32:47]
  v_mfma_f32_32x32x16_bf16 v[48:63], v[224:227], v[72:75], v[48:63]
  v_xor_b32 v12, 192, v9
  ds_read_b128 v[72:75], v12
  s_waitcnt lgkmcnt(5)
  v_mfma_f32_32x32x16_bf16 v[32:47], a[132:135], v[76:79], v[32:47]
  v_mfma_f32_32x32x16_bf16 v[48:63], v[228:231], v[76:79], v[48:63]
  s_waitcnt vmcnt(0)
  s_barrier
  s_cmp_eq_u32 s32, 0
  s_cbranch_scc0 G_nfc0
  v_mov_b32 v98, s54
  v_add_u32 v98, s3, v98
  v_mov_b32 v99, 0
  s_mov_b64 exec, 1
  buffer_store_dword v98, v99, s[4:7], s52 offen sc1
  s_mov_b64 exec, -1
G_nfc0:
  v_xor_b32 v13, 224, v9
  ds_read_b128 v[76:79], v13
  s_waitcnt lgkmcnt(5)
  v_mfma_f32_32x32x16_bf16 v[32:47], a[136:139], v[80:83], v[32:47]
  v_mfma_f32_32x32x16_bf16 v[48:63], v[232:235], v[80:83], v[48:63]
  s_waitcnt lgkmcnt(4)
  v_mfma_f32_32x32x16_bf16 v[32:47], a[140:143], v[84:87], v[32:47]
  v_mfma_f32_32x32x16_bf16 v[48:63], v[236:239], v[84:87], v[48:63]
  s_waitcnt lgkmcnt(3)
  v_mfma_f32_32x32x16_bf16 v[32:47], a[144:147], v[64:67], v[32:47]
  v_mfma_f32_32x32x16_bf16 v[48:63], v[240:243], v[64:67], v[48:63]
  s_waitcnt lgkmcnt(2)
  v_mfma_f32_32x32x16_bf16 v[32:47], a[148:151], v[68:71], v[32:47]
  v_mfma_f32_32x32x16_bf16 v[48:63], v[244:247], v[68:71], v[48:63]
  s_waitcnt lgkmcnt(1)
  v_mfma_f32_32x32x16_bf16 v[32:47], a[152:155], v[72:75], v[32:47]
  v_mfma_f32_32x32x16_bf16 v[48:63], v[248:251], v[72:75], v[48:63]
  s_waitcnt lgkmcnt(0)
  v_mfma_f32_32x32x16_bf16 v[32:47], a[156:159], v[76:79], v[32:47]
  v_mfma_f32_32x32x16_bf16 v[48:63], v[252:255], v[76:79], v[48:63]
  s_mov_b32 s60, s55
  s_add_u32 s55, s55, 41472
  s_cmp_eq_u32 s55, 124416
  s_cselect_b32 s55, 0, s55
  s_mov_b32 s57, s60
  s_add_u32 s54, s54, 1
  s_branch G_loop0
G_t1:
  s_barrier
  s_mul_i32 s60, s32, 8320
  s_add_u32 s60, s60, s57
  s_mul_i32 s61, s32, 10240
  s_add_u32 s61, s61, s46
  s_mov_b32 s62, s61
  s_add_u32 m0, s60, 0
  s_nop 0
  buffer_load_dwordx4 v88, s[12:15], s62 offen lds
  s_add_u32 s62, s62, 1280
  s_add_u32 m0, s60, 1040
  s_nop 0
  buffer_load_dwordx4 v88, s[12:15], s62 offen lds
  s_add_u32 s62, s62, 1280
  s_add_u32 m0, s60, 2080
  s_nop 0
  buffer_load_dwordx4 v88, s[12:15], s62 offen lds
  s_add_u32 s62, s62, 1280
  s_add_u32 m0, s60, 3120
  s_nop 0
  buffer_load_dwordx4 v88, s[12:15], s62 offen lds
  s_add_u32 s62, s62, 1280
  s_add_u32 m0, s60, 4160
  s_nop 0
  buffer_load_dwordx4 v88, s[12:15], s62 offen lds
  s_add_u32 s62, s62, 1280
  s_add_u32 m0, s60, 5200
  s_nop 0
  buffer_load_dwordx4 v88, s[12:15], s62 offen lds
  s_add_u32 s62, s62, 1280
  s_add_u32 m0, s60, 6240
  s_nop 0
  buffer_load_dwordx4 v88, s[12:15], s62 offen lds
  s_add_u32 s62, s62, 1280
  s_add_u32 m0, s60, 7280
  s_nop 0
  buffer_load_dwordx4 v88, s[12:15], s62 offen lds
  s_add_u32 s62, s62, 1280
  s_lshl_b32 s60, s32, 11
  s_add_u32 s60, s60, s57
  s_add_u32 m0, s60, 33280
  s_nop 0
  buffer_load_dwordx4 v89, s[12:15], s61 offen lds
  s_add_u32 m0, s60, 34304
  s_nop 0
  buffer_load_dwordx4 v90, s[12:15], s61 offen lds
  s_add_u32 s46, s46, 40960
  v_add_u32 v8, s55, v10
  v_add_u32 v9, s55, v11
  ds_read_b128 v[64:67], v8 offset:0
  ds_read_b128 v[68:71], v8 offset:32
  ds_read_b128 v[72:75], v8 offset:64
  ds_read_b128 v[76:79], v8 offset:96
  ds_read_b128 v[80:83], v8 offset:128
  ds_read_b128 v[84:87], v8 offset:160
  s_waitcnt lgkmcnt(5)
  v_mfma_f32_32x32x16_bf16 v[32:47], v[64:67], a[0:3], 0
  v_mfma_f32_32x32x16_bf16 v[48:63], v[64:67], a[160:163], 0
  ds_read_b128 v[64:67], v8 offset:192
  s_waitcnt lgkmcnt(5)
  v_mfma_f32_32x32x16_bf16 v[32:47], v[68:71], a[4:7], v[32:47]
  v_mfma_f32_32x32x16_bf16 v[48:63], v[68:71], a[164:167], v[48:63]
  ds_read_b128 v[68:71], v8 offset:224
  s_waitcnt lgkmcnt(5)
  v_mfma_f32_32x32x16_bf16 v[32:47], v[72:75], a[8:11], v[32:47]
  v_mfma_f32_32x32x16_bf16 v[48:63], v[72:75], a[168:171], v[48:63]
  ds_read_b128 v[72:75], v8 offset:256
  s_waitcnt lgkmcnt(5)
  v_mfma_f32_32x32x16_bf16 v[32:47], v[76:79], a[12:15], v[32:47]
  v_mfma_f32_32x32x16_bf16 v[48:63], v[76:79], a[172:175], v[48:63]
  ds_read_b128 v[76:79], v8 offset:288
  s_waitcnt lgkmcnt(5)
  v_mfma_f32_32x32x16_bf16 v[32:47], v[80:83], a[16:19], v[32:47]
  v_mfma_f32_32x32x16_bf16 v[48:63], v[80:83], a[176:179], v[48:63]
  ds_read_b128 v[80:83], v8 offset:320
  s_waitcnt lgkmcnt(5)
  v_mfma_f32_32x32x16_bf16 v[32:47], v[84:87], a[20:23], v[32:47]
  v_mfma_f32_32x32x16_bf16 v[48:63], v[84:87], a[180:183], v[48:63]
  ds_read_b128 v[84:87], v8 offset:352
  s_waitcnt lgkmcnt(5)
  v_mfma_f32_32x32x16_bf16 v[32:47], v[64:67], a[24:27], v[32:47]
  v_mfma_f32_32x32x16_bf16 v[48:63], v[64:67], a[184:187], v[48:63]
  ds_read_b128 v[64:67], v8 offset:384
  s_waitcnt lgkmcnt(5)
  v_mfma_f32_32x32x16_bf16 v[32:47], v[68:71], a[28:31], v[32:47]
  v_mfma_f32_32x32x16_bf16 v[48:63], v[68:71], a[188:191], v[48:63]
  ds_read_b128 v[68:71], v8 offset:416
  s_waitcnt lgkmcnt(5)
  v_mfma_f32_32x32x16_bf16 v[32:47], v[72:75], a[32:35], v[32:47]
  v_mfma_f32_32x32x16_bf16 v[48:63], v[72:75], a[192:195], v[48:63]
  ds_read_b128 v[72:75], v8 offset:448
  s_waitcnt lgkmcnt(5)
  v_mfma_f32_32x32x16_bf16 v[32:47], v[76:79], a[36:39], v[32:47]
  v_mfma_f32_32x32x16_bf16 v[48:63], v[76:79], a[196:199], v[48:63]
  ds_read_b128 v[76:79], v8 offset:480
  s_waitcnt lgkmcnt(5)
  v_mfma_f32_32x32x16_bf16 v[32:47], v[80:83], a[40:43], v[32:47]
  v_mfma_f32_32x32x16_bf16 v[48:63], v[80:83], a[200:203], v[48:63]
  ds_read_b128 v[80:83], v8 offset:512
  s_waitcnt lgkmcnt(5)
  v_mfma_f32_32x32x16_bf16 v[32:47], v[84:87], a[44:47], v[32:47]
  v_mfma_f32_32x32x16_bf16 v[48:63], v[84:87], a[204:207], v[48:63]
  ds_read_b128 v[84:87], v8 offset:544
  s_waitcnt lgkmcnt(5)
  v_mfma_f32_32x32x16_bf16 v[32:47], v[64:67], a[48:51], v[32:47]
  v_mfma_f32_32x32x16_bf16 v[48:63], v[64:67], a[208:211], v[48:63]
  ds_read_b128 v[64:67], v8 offset:576
  s_waitcnt lgkmcnt(5)
  v_mfma_f32_32x32x16_bf16 v[32:47], v[68:71], a[52:55], v[32:47]
  v_mfma_f32_32x32x16_bf16 v[48:63], v[68:71], a[212:215], v[48:63]
  ds_read_b128 v[68:71], v8 offset:608
  s_waitcnt lgkmcnt(5)
  v_mfma_f32_32x32x16_bf16 v[32:47], v[72:75], a[56:59], v[32:47]
  v_mfma_f32_32x32x16_bf16 v[48:63], v[72:75], a[216:219], v[48:63]
  ds_read_b128 v[72:75], v8 offset:640
  s_waitcnt lgkmcnt(5)
  v_mfma_f32_32x32x16_bf16 v[32:47], v[76:79], a[60:63], v[32:47]
  v_mfma_f32_32x32x16_bf16 v[48:63], v[76:79], a[220:223], v[48:63]
  ds_read_b128 v[76:79], v8 offset:672
  s_waitcnt lgkmcnt(5)
  v_mfma_f32_32x32x16_bf16 v[32:47], v[80:83], a[64:67], v[32:47]
  v_mfma_f32_32x32x16_bf16 v[48:63], v[80:83], a[224:227], v[48:63]
  ds_read_b128 v[80:83], v8 offset:704
  s_waitcnt lgkmcnt(5)
  v_mfma_f32_32x32x16_bf16 v[32:47], v[84:87], a[68:71], v[32:47]
  v_mfma_f32_32x32x16_bf16 v[48:63], v[84:87], a[228:231], v[48:63]
  ds_read_b128 v[84:87], v8 offset:736
  s_waitcnt lgkmcnt(5)
  v_mfma_f32_32x32x16_bf16 v[32:47], v[64:67], a[72:75], v[32:47]
  v_mfma_f32_32x32x16_bf16 v[48:63], v[64:67], a[232:235], v[48:63]
  ds_read_b128 v[64:67], v8 offset:768
  s_waitcnt lgkmcnt(5)
  v_mfma_f32_32x32x16_bf16 v[32:47], v[68:71], a[76:79], v[32:47]
  v_mfma_f32_32x32x16_bf16 v[48:63], v[68:71], a[236:239], v[48:63]
  ds_read_b128 v[68:71], v8 offset:800
  s_waitcnt lgkmcnt(5)
  v_mfma_f32_32x32x16_bf16 v[32:47], v[72:75], a[80:83], v[32:47]
  v_mfma_f32_32x32x16_bf16 v[48:63], v[72:75], a[240:243], v[48:63]
  ds_read_b128 v[72:75], v8 offset:832
  s_waitcnt lgkmcnt(5)
  v_mfma_f32_32x32x16_bf16 v[32:47], v[76:79], a[84:87], v[32:47]
  v_mfma_f32_32x32x16_bf16 v[48:63], v[76:79], a[244:247], v[48:63]
  ds_read_b128 v[76:79], v8 offset:864
  s_waitcnt lgkmcnt(5)
  v_mfma_f32_32x32x16_bf16 v[32:47], v[80:83], a[88:91], v[32:47]
  v_mfma_f32_32x32x16_bf16 v[48:63], v[80:83], a[248:251], v[48:63]
  ds_read_b128 v[80:83], v8 offset:896
  s_waitcnt lgkmcnt(5)
  v_mfma_f32_32x32x16_bf16 v[32:47], v[84:87], a[92:95], v[32:47]
  v_mfma_f32_32x32x16_bf16 v[48:63], v[84:87], a[252:255], v[48:63]
  ds_read_b128 v[84:87], v8 offset:928
  s_waitcnt lgkmcnt(5)
  v_mfma_f32_32x32x16_bf16 v[32:47], v[64:67], a[96:99], v[32:47]
  v_mfma_f32_32x32x16_bf16 v[48:63], v[64:67], v[192:195], v[48:63]
  ds_read_b128 v[64:67], v8 offset:960
  s_waitcnt lgkmcnt(5)
  v_mfma_f32_32x32x16_bf16 v[32:47], v[68:71], a[100:103], v[32:47]
  v_mfma_f32_32x32x16_bf16 v[48:63], v[68:71], v[196:199], v[48:63]
  ds_read_b128 v[68:71], v8 offset:992
  s_waitcnt lgkmcnt(5)
  v_mfma_f32_32x32x16_bf16 v[32:47], v[72:75], a[104:107], v[32:47]
  v_mfma_f32_32x32x16_bf16 v[48:63], v[72:75], v[200:203], v[48:63]
  v_xor_b32 v12, 0, v9
  ds_read_b128 v[72:75], v12
  s_waitcnt lgkmcnt(5)
  v_mfma_f32_32x32x16_bf16 v[32:47], v[76:79], a[108:111], v[32:47]
  v_mfma_f32_32x32x16_bf16 v[48:63], v[76:79], v[204:207], v[48:63]
  v_xor_b32 v13, 32, v9
  ds_read_b128 v[76:79], v13
  s_waitcnt lgkmcnt(5)
  v_mfma_f32_32x32x16_bf16 v[32:47], v[80:83], a[112:115], v[32:47]
  v_mfma_f32_32x32x16_bf16 v[48:63], v[80:83], v[208:211], v[48:63]
  v_xor_b32 v12, 64, v9
  ds_read_b128 v[80:83], v12
  s_waitcnt lgkmcnt(5)
  v_mfma_f32_32x32x16_bf16 v[32:47], v[84:87], a[116:119], v[32:47]
  v_mfma_f32_32x32x16_bf16 v[48:63], v[84:87], v[212:215], v[48:63]
  v_xor_b32 v13, 96, v9
  ds_read_b128 v[84:87], v13
  s_waitcnt lgkmcnt(5)
  v_mfma_f32_32x32x16_bf16 v[32:47], v[64:67], a[120:123], v[32:47]
  v_mfma_f32_32x32x16_bf16 v[48:63], v[64:67], v[216:219], v[48:63]
  v_xor_b32 v12, 128, v9
  ds_read_b128 v[64:67], v12
  s_waitcnt lgkmcnt(5)
  v_mfma_f32_32x32x16_bf16 v[32:47], v[68:71], a[124:127], v[32:47]
  v_mfma_f32_32x32x16_bf16 v[48:63], v[68:71], v[220:223], v[48:63]
  v_xor_b32 v13, 160, v9
  ds_read_b128 v[68:71], v13
  s_waitcnt lgkmcnt(5)
  v_mfma_f32_32x32x16_bf16 v[32:47], v[72:75], a[128:131], v[32:47]
  v_mfma_f32_32x32x16_bf16 v[48:63], v[72:75], v[224:227], v[48:63]
  v_xor_b32 v12, 192, v9
  ds_read_b128 v[72:75], v12
  s_waitcnt lgkmcnt(5)
  v_mfma_f32_32x32x16_bf16 v[32:47], v[76:79], a[132:135], v[32:47]
  v_mfma_f32_32x32x16_bf16 v[48:63], v[76:79], v[228:231], v[48:63]
  s_waitcnt vmcnt(0)
  s_barrier
  v_xor_b32 v13, 224, v9
  ds_read_b128 v[76:79], v13
  s_waitcnt lgkmcnt(5)
  v_mfma_f32_32x32x16_bf16 v[32:47], v[80:83], a[136:139], v[32:47]
  v_mfma_f32_32x32x16_bf16 v[48:63], v[80:83], v[232:235], v[48:63]
  s_waitcnt lgkmcnt(4)
  v_mfma_f32_32x32x16_bf16 v[32:47], v[84:87], a[140:143], v[32:47]
  v_mfma_f32_32x32x16_bf16 v[48:63], v[84:87], v[236:239], v[48:63]
  s_waitcnt lgkmcnt(3)
  v_mfma_f32_32x32x16_bf16 v[32:47], v[64:67], a[144:147], v[32:47]
  v_mfma_f32_32x32x16_bf16 v[48:63], v[64:67], v[240:243], v[48:63]
  s_waitcnt lgkmcnt(2)
  v_mfma_f32_32x32x16_bf16 v[32:47], v[68:71], a[148:151], v[32:47]
  v_mfma_f32_32x32x16_bf16 v[48:63], v[68:71], v[244:247], v[48:63]
  s_waitcnt lgkmcnt(1)
  v_mfma_f32_32x32x16_bf16 v[32:47], v[72:75], a[152:155], v[32:47]
  v_mfma_f32_32x32x16_bf16 v[48:63], v[72:75], v[248:251], v[48:63]
  s_waitcnt lgkmcnt(0)
  v_mfma_f32_32x32x16_bf16 v[32:47], v[76:79], a[156:159], v[32:47]
  v_mfma_f32_32x32x16_bf16 v[48:63], v[76:79], v[252:255], v[48:63]
  s_mov_b32 s60, s55
  s_add_u32 s55, s55, 41472
  s_cmp_eq_u32 s55, 124416
  s_cselect_b32 s55, 0, s55
  s_mov_b32 s57, s60
  s_add_u32 s54, s54, 1
G_loop1:
  s_barrier
  s_mul_i32 s60, s32, 8320
  s_add_u32 s60, s60, s57
  s_mul_i32 s61, s32, 10240
  s_add_u32 s61, s61, s46
  s_mov_b32 s62, s61
  s_add_u32 m0, s60, 0
  s_nop 0
  buffer_load_dwordx4 v88, s[12:15], s62 offen lds
  s_add_u32 s62, s62, 1280
  s_add_u32 m0, s60, 1040
  s_nop 0
  buffer_load_dwordx4 v88, s[12:15], s62 offen lds
  s_add_u32 s62, s62, 1280
  s_add_u32 m0, s60, 2080
  s_nop 0
  buffer_load_dwordx4 v88, s[12:15], s62 offen lds
  s_add_u32 s62, s62, 1280
  s_add_u32 m0, s60, 3120
  s_nop 0
  buffer_load_dwordx4 v88, s[12:15], s62 offen lds
  s_add_u32 s62, s62, 1280
  s_add_u32 m0, s60, 4160
  s_nop 0
  buffer_load_dwordx4 v88, s[12:15], s62 offen lds
  s_add_u32 s62, s62, 1280
  s_add_u32 m0, s60, 5200
  s_nop 0
  buffer_load_dwordx4 v88, s[12:15], s62 offen lds
  s_add_u32 s62, s62, 1280
  s_add_u32 m0, s60, 6240
  s_nop 0
  buffer_load_dwordx4 v88, s[12:15], s62 offen lds
  s_add_u32 s62, s62, 1280
  s_add_u32 m0, s60, 7280
  s_nop 0
  buffer_load_dwordx4 v88, s[12:15], s62 offen lds
  s_add_u32 s62, s62, 1280
  s_lshl_b32 s60, s32, 11
  s_add_u32 s60, s60, s57
  s_add_u32 m0, s60, 33280
  s_nop 0
  buffer_load_dwordx4 v89, s[12:15], s61 offen lds
  s_add_u32 m0, s60, 34304
  s_nop 0
  buffer_load_dwordx4 v90, s[12:15], s61 offen lds
  s_add_u32 s46, s46, 40960
  v_add_u32 v8, s55, v10
  v_add_u32 v9, s55, v11
  ds_read_b128 v[64:67], v8 offset:0
  ds_read_b128 v[68:71], v8 offset:32
  ds_read_b128 v[72:75], v8 offset:64
  ds_read_b128 v[76:79], v8 offset:96
  ds_read_b128 v[80:83], v8 offset:128
  ds_read_b128 v[84:87], v8 offset:160
  s_waitcnt lgkmcnt(5)
  v_mfma_f32_32x32x16_bf16 v[114:129], v[64:67], a[0:3], 0
  v_mfma_f32_32x32x16_bf16 v[130:145], v[64:67], a[160:163], 0
  ds_read_b128 v[64:67], v8 offset:192
  s_waitcnt lgkmcnt(5)
  v_mfma_f32_32x32x16_bf16 v[114:129], v[68:71], a[4:7], v[114:129]
  v_mfma_f32_32x32x16_bf16 v[130:145], v[68:71], a[164:167], v[130:145]
  ds_read_b128 v[68:71], v8 offset:224
  s_waitcnt lgkmcnt(5)
  v_mfma_f32_32x32x16_bf16 v[114:129], v[72:75], a[8:11], v[114:129]
  v_mfma_f32_32x32x16_bf16 v[130:145], v[72:75], a[168:171], v[130:145]
  v_cvt_pk_bf16_f32 v146, v32, v33
  v_cvt_pk_bf16_f32 v147, v34, v35
  v_cvt_pk_bf16_f32 v148, v36, v37
  v_cvt_pk_bf16_f32 v149, v38, v39
  s_mul_i32 s60, s64, 0
  s_add_u32 s60, s60, 0
  v_xor_b32 v5, s60, v2
  ds_write_b128 v5, v[146:149]
  ds_read_b128 v[72:75], v8 offset:256
  s_waitcnt lgkmcnt(6)
  v_mfma_f32_32x32x16_bf16 v[114:129], v[76:79], a[12:15], v[114:129]
  v_mfma_f32_32x32x16_bf16 v[130:145], v[76:79], a[172:175], v[130:145]
  v_cvt_pk_bf16_f32 v150, v40, v41
  v_cvt_pk_bf16_f32 v151, v42, v43
  v_cvt_pk_bf16_f32 v152, v44, v45
  v_cvt_pk_bf16_f32 v153, v46, v47
  s_mul_i32 s60, s64, 0
  s_add_u32 s60, s60, 32
  v_xor_b32 v6, s60, v2
  ds_write_b128 v6, v[150:153]
  ds_read_b128 v[76:79], v8 offset:288
  s_waitcnt lgkmcnt(7)
  v_mfma_f32_32x32x16_bf16 v[114:129], v[80:83], a[16:19], v[114:129]
  v_mfma_f32_32x32x16_bf16 v[130:145], v[80:83], a[176:179], v[130:145]
  v_cvt_pk_bf16_f32 v154, v48, v49
  v_cvt_pk_bf16_f32 v155, v50, v51
  v_cvt_pk_bf16_f32 v156, v52, v53
  v_cvt_pk_bf16_f32 v157, v54, v55
  s_mul_i32 s60, s64, 1
  s_add_u32 s60, s60, 0
  v_xor_b32 v5, s60, v2
  ds_write_b128 v5, v[154:157]
  ds_read_b128 v[80:83], v8 offset:320
  s_waitcnt lgkmcnt(8)
  v_mfma_f32_32x32x16_bf16 v[114:129], v[84:87], a[20:23], v[114:129]
  v_mfma_f32_32x32x16_bf16 v[130:145], v[84:87], a[180:183], v[130:145]
  v_cvt_pk_bf16_f32 v158, v56, v57
  v_cvt_pk_bf16_f32 v159, v58, v59
  v_cvt_pk_bf16_f32 v160, v60, v61
  v_cvt_pk_bf16_f32 v161, v62, v63
  s_mul_i32 s60, s64, 1
  s_add_u32 s60, s60, 32
  v_xor_b32 v6, s60, v2
  ds_write_b128 v6, v[158:161]
  ds_read_b128 v[84:87], v8 offset:352
  s_waitcnt lgkmcnt(9)
  v_mfma_f32_32x32x16_bf16 v[114:129], v[64:67], a[24:27], v[114:129]
  v_mfma_f32_32x32x16_bf16 v[130:145], v[64:67], a[184:187], v[130:145]
  ds_read_b128 v[64:67], v8 offset:384
  s_waitcnt lgkmcnt(9)
  v_mfma_f32_32x32x16_bf16 v[114:129], v[68:71], a[28:31], v[114:129]
  v_mfma_f32_32x32x16_bf16 v[130:145], v[68:71], a[188:191], v[130:145]
  s_waitcnt lgkmcnt(2)
  v_xor_b32 v5, s65, v3
  ds_read_b128 v[146:149], v3 offset:0
  ds_read_b128 v[150:153], v5 offset:1024
  ds_read_b128 v[154:157], v3 offset:2048
  ds_read_b128 v[158:161], v5 offset:3072
  ds_read_b128 v[68:71], v8 offset:416
  v_mfma_f32_32x32x16_bf16 v[114:129], v[72:75], a[32:35], v[114:129]
  v_mfma_f32_32x32x16_bf16 v[130:145], v[72:75], a[192:195], v[130:145]
  ds_read_b128 v[72:75], v8 offset:448
  v_mfma_f32_32x32x16_bf16 v[114:129], v[76:79], a[36:39], v[114:129]
  v_mfma_f32_32x32x16_bf16 v[130:145], v[76:79], a[196:199], v[130:145]
  s_waitcnt lgkmcnt(5)
  s_mov_b32 s61, s48
  buffer_store_dwordx4 v[146:149], v4, s[4:7], s61 offen sc1
  s_add_u32 s61, s61, s66
  ds_read_b128 v[76:79], v8 offset:480
  v_mfma_f32_32x32x16_bf16 v[114:129], v[80:83], a[40:43], v[114:129]
  v_mfma_f32_32x32x16_bf16 v[130:145], v[80:83], a[200:203], v[130:145]
  s_waitcnt lgkmcnt(5)
  buffer_store_dwordx4 v[150:153], v4, s[4:7], s61 offen sc1
  s_add_u32 s61, s61, s66
  ds_read_b128 v[80:83], v8 offset:512
  v_mfma_f32_32x32x16_bf16 v[114:129], v[84:87], a[44:47], v[114:129]
  v_mfma_f32_32x32x16_bf16 v[130:145], v[84:87], a[204:207], v[130:145]
  s_waitcnt lgkmcnt(5)
  buffer_store_dwordx4 v[154:157], v4, s[4:7], s61 offen sc1
  s_add_u32 s61, s61, s66
  ds_read_b128 v[84:87], v8 offset:544
  v_mfma_f32_32x32x16_bf16 v[114:129], v[64:67], a[48:51], v[114:129]
  v_mfma_f32_32x32x16_bf16 v[130:145], v[64:67], a[208:211], v[130:145]
  s_waitcnt lgkmcnt(5)
  buffer_store_dwordx4 v[158:161], v4, s[4:7], s61 offen sc1
  s_add_u32 s61, s61, s66
  s_add_u32 s48, s48, s49
  ds_read_b128 v[64:67], v8 offset:576
  s_waitcnt lgkmcnt(5)
  v_mfma_f32_32x32x16_bf16 v[114:129], v[68:71], a[52:55], v[114:129]
  v_mfma_f32_32x32x16_bf16 v[130:145], v[68:71], a[212:215], v[130:145]
  ds_read_b128 v[68:71], v8 offset:608
  s_waitcnt lgkmcnt(5)
  v_mfma_f32_32x32x16_bf16 v[114:129], v[72:75], a[56:59], v[114:129]
  v_mfma_f32_32x32x16_bf16 v[130:145], v[72:75], a[216:219], v[130:145]
  ds_read_b128 v[72:75], v8 offset:640
  s_waitcnt lgkmcnt(5)
  v_mfma_f32_32x32x16_bf16 v[114:129], v[76:79], a[60:63], v[114:129]
  v_mfma_f32_32x32x16_bf16 v[130:145], v[76:79], a[220:223], v[130:145]
  ds_read_b128 v[76:79], v8 offset:672
  s_waitcnt lgkmcnt(5)
  v_mfma_f32_32x32x16_bf16 v[114:129], v[80:83], a[64:67], v[114:129]
  v_mfma_f32_32x32x16_bf16 v[130:145], v[80:83], a[224:227], v[130:145]
  ds_read_b128 v[80:83], v8 offset:704
  s_waitcnt lgkmcnt(5)
  v_mfma_f32_32x32x16_bf16 v[114:129], v[84:87], a[68:71], v[114:129]
  v_mfma_f32_32x32x16_bf16 v[130:145], v[84:87], a[228:231], v[130:145]
  ds_read_b128 v[84:87], v8 offset:736
  s_waitcnt lgkmcnt(5)
  v_mfma_f32_32x32x16_bf16 v[114:129], v[64:67], a[72:75], v[114:129]
  v_mfma_f32_32x32x16_bf16 v[130:145], v[64:67], a[232:235], v[130:145]
  ds_read_b128 v[64:67], v8 offset:768
  s_waitcnt lgkmcnt(5)
  v_mfma_f32_32x32x16_bf16 v[114:129], v[68:71], a[76:79], v[114:129]
  v_mfma_f32_32x32x16_bf16 v[130:145], v[68:71], a[236:239], v[130:145]
  ds_read_b128 v[68:71], v8 offset:800
  s_waitcnt lgkmcnt(5)
  v_mfma_f32_32x32x16_bf16 v[114:129], v[72:75], a[80:83], v[114:129]
  v_mfma_f32_32x32x16_bf16 v[130:145], v[72:75], a[240:243], v[130:145]
  ds_read_b128 v[72:75], v8 offset:832
  s_waitcnt lgkmcnt(5)
  v_mfma_f32_32x32x16_bf16 v[114:129], v[76:79], a[84:87], v[114:129]
  v_mfma_f32_32x32x16_bf16 v[130:145], v[76:79], a[244:247], v[130:145]
  ds_read_b128 v[76:79], v8 offset:864
  s_waitcnt lgkmcnt(5)
  v_mfma_f32_32x32x16_bf16 v[114:129], v[80:83], a[88:91], v[114:129]
  v_mfma_f32_32x32x16_bf16 v[130:145], v[80:83], a[248:251], v[130:145]
  ds_read_b128 v[80:83], v8 offset:896
  s_waitcnt lgkmcnt(5)
  v_mfma_f32_32x32x16_bf16 v[114:129], v[84:87], a[92:95], v[114:129]
  v_mfma_f32_32x32x16_bf16 v[130:145], v[84:87], a[252:255], v[130:145]
  ds_read_b128 v[84:87], v8 offset:928
  s_waitcnt lgkmcnt(5)
  v_mfma_f32_32x32x16_bf16 v[114:129], v[64:67], a[96:99], v[114:129]
  v_mfma_f32_32x32x16_bf16 v[130:145], v[64:67], v[192:195], v[130:145]
  ds_read_b128 v[64:67], v8 offset:960
  s_waitcnt lgkmcnt(5)
  v_mfma_f32_32x32x16_bf16 v[114:129], v[68:71], a[100:103], v[114:129]
  v_mfma_f32_32x32x16_bf16 v[130:145], v[68:71], v[196:199], v[130:145]
  ds_read_b128 v[68:71], v8 offset:992
  s_waitcnt lgkmcnt(5)
  v_mfma_f32_32x32x16_bf16 v[114:129], v[72:75], a[104:107], v[114:129]
  v_mfma_f32_32x32x16_bf16 v[130:145], v[72:75], v[200:203], v[130:145]
  v_xor_b32 v12, 0, v9
  ds_read_b128 v[72:75], v12
  s_waitcnt lgkmcnt(5)
  v_mfma_f32_32x32x16_bf16 v[114:129], v[76:79], a[108:111], v[114:129]
  v_mfma_f32_32x32x16_bf16 v[130:145], v[76:79], v[204:207], v[130:145]
  v_xor_b32 v13, 32, v9
  ds_read_b128 v[76:79], v13
  s_waitcnt lgkmcnt(5)
  v_mfma_f32_32x32x16_bf16 v[114:129], v[80:83], a[112:115], v[114:129]
  v_mfma_f32_32x32x16_bf16 v[130:145], v[80:83], v[208:211], v[130:145]
  v_xor_b32 v12, 64, v9
  ds_read_b128 v[80:83], v12
  s_waitcnt lgkmcnt(5)
  v_mfma_f32_32x32x16_bf16 v[114:129], v[84:87], a[116:119], v[114:129]
  v_mfma_f32_32x32x16_bf16 v[130:145], v[84:87], v[212:215], v[130:145]
  v_xor_b32 v13, 96, v9
  ds_read_b128 v[84:87], v13
  s_waitcnt lgkmcnt(5)
  v_mfma_f32_32x32x16_bf16 v[114:129], v[64:67], a[120:123], v[114:129]
  v_mfma_f32_32x32x16_bf16 v[130:145], v[64:67], v[216:219], v[130:145]
  v_xor_b32 v12, 128, v9
  ds_read_b128 v[64:67], v12
  s_waitcnt lgkmcnt(5)
  v_mfma_f32_32x32x16_bf16 v[114:129], v[68:71], a[124:127], v[114:129]
  v_mfma_f32_32x32x16_bf16 v[130:145], v[68:71], v[220:223], v[130:145]
  v_xor_b32 v13, 160, v9
  ds_read_b128 v[68:71], v13
  s_waitcnt lgkmcnt(5)
  v_mfma_f32_32x32x16_bf16 v[114:129], v[72:75], a[128:131], v[114:129]
  v_mfma_f32_32x32x16_bf16 v[130:145], v[72:75], v[224:227], v[130:145]
  v_xor_b32 v12, 192, v9
  ds_read_b128 v[72:75], v12
  s_waitcnt lgkmcnt(5)
  v_mfma_f32_32x32x16_bf16 v[114:129], v[76:79], a[132:135], v[114:129]
  v_mfma_f32_32x32x16_bf16 v[130:145], v[76:79], v[228:231], v[130:145]
  s_waitcnt vmcnt(0)
  s_barrier
  s_cmp_eq_u32 s32, 0
  s_cbranch_scc0 G_nfb1
  v_mov_b32 v98, s54
  v_add_u32 v98, s3, v98
  v_mov_b32 v99, 0
  s_mov_b64 exec, 1
  buffer_store_dword v98, v99, s[4:7], s52 offen sc1
  s_mov_b64 exec, -1
G_nfb1:
  v_xor_b32 v13, 224, v9
  ds_read_b128 v[76:79], v13
  s_waitcnt lgkmcnt(5)
  v_mfma_f32_32x32x16_bf16 v[114:129], v[80:83], a[136:139], v[114:129]
  v_mfma_f32_32x32x16_bf16 v[130:145], v[80:83], v[232:235], v[130:145]
  s_waitcnt lgkmcnt(4)
  v_mfma_f32_32x32x16_bf16 v[114:129], v[84:87], a[140:143], v[114:129]
  v_mfma_f32_32x32x16_bf16 v[130:145], v[84:87], v[236:239], v[130:145]
  s_waitcnt lgkmcnt(3)
  v_mfma_f32_32x32x16_bf16 v[114:129], v[64:67], a[144:147], v[114:129]
  v_mfma_f32_32x32x16_bf16 v[130:145], v[64:67], v[240:243], v[130:145]
  s_waitcnt lgkmcnt(2)
  v_mfma_f32_32x32x16_bf16 v[114:129], v[68:71], a[148:151], v[114:129]
  v_mfma_f32_32x32x16_bf16 v[130:145], v[68:71], v[244:247], v[130:145]
  s_waitcnt lgkmcnt(1)
  v_mfma_f32_32x32x16_bf16 v[114:129], v[72:75], a[152:155], v[114:129]
  v_mfma_f32_32x32x16_bf16 v[130:145], v[72:75], v[248:251], v[130:145]
  s_waitcnt lgkmcnt(0)
  v_mfma_f32_32x32x16_bf16 v[114:129], v[76:79], a[156:159], v[114:129]
  v_mfma_f32_32x32x16_bf16 v[130:145], v[76:79], v[252:255], v[130:145]
  s_mov_b32 s60, s55
  s_add_u32 s55, s55, 41472
  s_cmp_eq_u32 s55, 124416
  s_cselect_b32 s55, 0, s55
  s_mov_b32 s57, s60
  s_add_u32 s54, s54, 1
  s_cmp_lt_u32 s54, s47
  s_cbranch_scc0 G_last1
  s_barrier
  s_mul_i32 s60, s32, 8320
  s_add_u32 s60, s60, s57
  s_mul_i32 s61, s32, 10240
  s_add_u32 s61, s61, s46
  s_mov_b32 s62, s61
  s_add_u32 m0, s60, 0
  s_nop 0
  buffer_load_dwordx4 v88, s[12:15], s62 offen lds
  s_add_u32 s62, s62, 1280
  s_add_u32 m0, s60, 1040
  s_nop 0
  buffer_load_dwordx4 v88, s[12:15], s62 offen lds
  s_add_u32 s62, s62, 1280
  s_add_u32 m0, s60, 2080
  s_nop 0
  buffer_load_dwordx4 v88, s[12:15], s62 offen lds
  s_add_u32 s62, s62, 1280
  s_add_u32 m0, s60, 3120
  s_nop 0
  buffer_load_dwordx4 v88, s[12:15], s62 offen lds
  s_add_u32 s62, s62, 1280
  s_add_u32 m0, s60, 4160
  s_nop 0
  buffer_load_dwordx4 v88, s[12:15], s62 offen lds
  s_add_u32 s62, s62, 1280
  s_add_u32 m0, s60, 5200
  s_nop 0
  buffer_load_dwordx4 v88, s[12:15], s62 offen lds
  s_add_u32 s62, s62, 1280
  s_add_u32 m0, s60, 6240
  s_nop 0
  buffer_load_dwordx4 v88, s[12:15], s62 offen lds
  s_add_u32 s62, s62, 1280
  s_add_u32 m0, s60, 7280
  s_nop 0
  buffer_load_dwordx4 v88, s[12:15], s62 offen lds
  s_add_u32 s62, s62, 1280
  s_lshl_b32 s60, s32, 11
  s_add_u32 s60, s60, s57
  s_add_u32 m0, s60, 33280
  s_nop 0
  buffer_load_dwordx4 v89, s[12:15], s61 offen lds
  s_add_u32 m0, s60, 34304
  s_nop 0
  buffer_load_dwordx4 v90, s[12:15], s61 offen lds
  s_add_u32 s46, s46, 40960
  v_add_u32 v8, s55, v10
  v_add_u32 v9, s55, v11
  ds_read_b128 v[64:67], v8 offset:0
  ds_read_b128 v[68:71], v8 offset:32
  ds_read_b128 v[72:75], v8 offset:64
  ds_read_b128 v[76:79], v8 offset:96
  ds_read_b128 v[80:83], v8 offset:128
  ds_read_b128 v[84:87], v8 offset:160
  s_waitcnt lgkmcnt(5)
  v_mfma_f32_32x32x16_bf16 v[32:47], v[64:67], a[0:3], 0
  v_mfma_f32_32x32x16_bf16 v[48:63], v[64:67], a[160:163], 0
  ds_read_b128 v[64:67], v8 offset:192
  s_waitcnt lgkmcnt(5)
  v_mfma_f32_32x32x16_bf16 v[32:47], v[68:71], a[4:7], v[32:47]
  v_mfma_f32_32x32x16_bf16 v[48:63], v[68:71], a[164:167], v[48:63]
  ds_read_b128 v[68:71], v8 offset:224
  s_waitcnt lgkmcnt(5)
  v_mfma_f32_32x32x16_bf16 v[32:47], v[72:75], a[8:11], v[32:47]
  v_mfma_f32_32x32x16_bf16 v[48:63], v[72:75], a[168:171], v[48:63]
  v_cvt_pk_bf16_f32 v146, v114, v115
  v_cvt_pk_bf16_f32 v147, v116, v117
  v_cvt_pk_bf16_f32 v148, v118, v119
  v_cvt_pk_bf16_f32 v149, v120, v121
  s_mul_i32 s60, s64, 0
  s_add_u32 s60, s60, 0
  v_xor_b32 v5, s60, v2
  ds_write_b128 v5, v[146:149]
  ds_read_b128 v[72:75], v8 offset:256
  s_waitcnt lgkmcnt(6)
  v_mfma_f32_32x32x16_bf16 v[32:47], v[76:79], a[12:15], v[32:47]
  v_mfma_f32_32x32x16_bf16 v[48:63], v[76:79], a[172:175], v[48:63]
  v_cvt_pk_bf16_f32 v150, v122, v123
  v_cvt_pk_bf16_f32 v151, v124, v125
  v_cvt_pk_bf16_f32 v152, v126, v127
  v_cvt_pk_bf16_f32 v153, v128, v129
  s_mul_i32 s60, s64, 0
  s_add_u32 s60, s60, 32
  v_xor_b32 v6, s60, v2
  ds_write_b128 v6, v[150:153]
  ds_read_b128 v[76:79], v8 offset:288
  s_waitcnt lgkmcnt(7)
  v_mfma_f32_32x32x16_bf16 v[32:47], v[80:83], a[16:19], v[32:47]
  v_mfma_f32_32x32x16_bf16 v[48:63], v[80:83], a[176:179], v[48:63]
  v_cvt_pk_bf16_f32 v154, v130, v131
  v_cvt_pk_bf16_f32 v155, v132, v133
  v_cvt_pk_bf16_f32 v156, v134, v135
  v_cvt_pk_bf16_f32 v157, v136, v137
  s_mul_i32 s60, s64, 1
  s_add_u32 s60, s60, 0
  v_xor_b32 v5, s60, v2
  ds_write_b128 v5, v[154:157]
  ds_read_b128 v[80:83], v8 offset:320
  s_waitcnt lgkmcnt(8)
  v_mfma_f32_32x32x16_bf16 v[32:47], v[84:87], a[20:23], v[32:47]
  v_mfma_f32_32x32x16_bf16 v[48:63], v[84:87], a[180:183], v[48:63]
  v_cvt_pk_bf16_f32 v158, v138, v139
  v_cvt_pk_bf16_f32 v159, v140, v141
  v_cvt_pk_bf16_f32 v160, v142, v143
  v_cvt_pk_bf16_f32 v161, v144, v145
  s_mul_i32 s60, s64, 1
  s_add_u32 s60, s60, 32
  v_xor_b32 v6, s60, v2
  ds_write_b128 v6, v[158:161]
  ds_read_b128 v[84:87], v8 offset:352
  s_waitcnt lgkmcnt(9)
  v_mfma_f32_32x32x16_bf16 v[32:47], v[64:67], a[24:27], v[32:47]
  v_mfma_f32_32x32x16_bf16 v[48:63], v[64:67], a[184:187], v[48:63]
  ds_read_b128 v[64:67], v8 offset:384
  s_waitcnt lgkmcnt(9)
  v_mfma_f32_32x32x16_bf16 v[32:47], v[68:71], a[28:31], v[32:47]
  v_mfma_f32_32x32x16_bf16 v[48:63], v[68:71], a[188:191], v[48:63]
  s_waitcnt lgkmcnt(2)
  v_xor_b32 v5, s65, v3
  ds_read_b128 v[146:149], v3 offset:0
  ds_read_b128 v[150:153], v5 offset:1024
  ds_read_b128 v[154:157], v3 offset:2048
  ds_read_b128 v[158:161], v5 offset:3072
  ds_read_b128 v[68:71], v8 offset:416
  v_mfma_f32_32x32x16_bf16 v[32:47], v[72:75], a[32:35], v[32:47]
  v_mfma_f32_32x32x16_bf16 v[48:63], v[72:75], a[192:195], v[48:63]
  ds_read_b128 v[72:75], v8 offset:448
  v_mfma_f32_32x32x16_bf16 v[32:47], v[76:79], a[36:39], v[32:47]
  v_mfma_f32_32x32x16_bf16 v[48:63], v[76:79], a[196:199], v[48:63]
  s_waitcnt lgkmcnt(5)
  s_mov_b32 s61, s48
  buffer_store_dwordx4 v[146:149], v4, s[4:7], s61 offen sc1
  s_add_u32 s61, s61, s66
  ds_read_b128 v[76:79], v8 offset:480
  v_mfma_f32_32x32x16_bf16 v[32:47], v[80:83], a[40:43], v[32:47]
  v_mfma_f32_32x32x16_bf16 v[48:63], v[80:83], a[200:203], v[48:63]
  s_waitcnt lgkmcnt(5)
  buffer_store_dwordx4 v[150:153], v4, s[4:7], s61 offen sc1
  s_add_u32 s61, s61, s66
  ds_read_b128 v[80:83], v8 offset:512
  v_mfma_f32_32x32x16_bf16 v[32:47], v[84:87], a[44:47], v[32:47]
  v_mfma_f32_32x32x16_bf16 v[48:63], v[84:87], a[204:207], v[48:63]
  s_waitcnt lgkmcnt(5)
  buffer_store_dwordx4 v[154:157], v4, s[4:7], s61 offen sc1
  s_add_u32 s61, s61, s66
  ds_read_b128 v[84:87], v8 offset:544
  v_mfma_f32_32x32x16_bf16 v[32:47], v[64:67], a[48:51], v[32:47]
  v_mfma_f32_32x32x16_bf16 v[48:63], v[64:67], a[208:211], v[48:63]
  s_waitcnt lgkmcnt(5)
  buffer_store_dwordx4 v[158:161], v4, s[4:7], s61 offen sc1
  s_add_u32 s61, s61, s66
  s_add_u32 s48, s48, s49
  ds_read_b128 v[64:67], v8 offset:576
  s_waitcnt lgkmcnt(5)
  v_mfma_f32_32x32x16_bf16 v[32:47], v[68:71], a[52:55], v[32:47]
  v_mfma_f32_32x32x16_bf16 v[48:63], v[68:71], a[212:215], v[48:63]
  ds_read_b128 v[68:71], v8 offset:608
  s_waitcnt lgkmcnt(5)
  v_mfma_f32_32x32x16_bf16 v[32:47], v[72:75], a[56:59], v[32:47]
  v_mfma_f32_32x32x16_bf16 v[48:63], v[72:75], a[216:219], v[48:63]
  ds_read_b128 v[72:75], v8 offset:640
  s_waitcnt lgkmcnt(5)
  v_mfma_f32_32x32x16_bf16 v[32:47], v[76:79], a[60:63], v[32:47]
  v_mfma_f32_32x32x16_bf16 v[48:63], v[76:79], a[220:223], v[48:63]
  ds_read_b128 v[76:79], v8 offset:672
  s_waitcnt lgkmcnt(5)
  v_mfma_f32_32x32x16_bf16 v[32:47], v[80:83], a[64:67], v[32:47]
  v_mfma_f32_32x32x16_bf16 v[48:63], v[80:83], a[224:227], v[48:63]
  ds_read_b128 v[80:83], v8 offset:704
  s_waitcnt lgkmcnt(5)
  v_mfma_f32_32x32x16_bf16 v[32:47], v[84:87], a[68:71], v[32:47]
  v_mfma_f32_32x32x16_bf16 v[48:63], v[84:87], a[228:231], v[48:63]
  ds_read_b128 v[84:87], v8 offset:736
  s_waitcnt lgkmcnt(5)
  v_mfma_f32_32x32x16_bf16 v[32:47], v[64:67], a[72:75], v[32:47]
  v_mfma_f32_32x32x16_bf16 v[48:63], v[64:67], a[232:235], v[48:63]
  ds_read_b128 v[64:67], v8 offset:768
  s_waitcnt lgkmcnt(5)
  v_mfma_f32_32x32x16_bf16 v[32:47], v[68:71], a[76:79], v[32:47]
  v_mfma_f32_32x32x16_bf16 v[48:63], v[68:71], a[236:239], v[48:63]
  ds_read_b128 v[68:71], v8 offset:800
  s_waitcnt lgkmcnt(5)
  v_mfma_f32_32x32x16_bf16 v[32:47], v[72:75], a[80:83], v[32:47]
  v_mfma_f32_32x32x16_bf16 v[48:63], v[72:75], a[240:243], v[48:63]
  ds_read_b128 v[72:75], v8 offset:832
  s_waitcnt lgkmcnt(5)
  v_mfma_f32_32x32x16_bf16 v[32:47], v[76:79], a[84:87], v[32:47]
  v_mfma_f32_32x32x16_bf16 v[48:63], v[76:79], a[244:247], v[48:63]
  ds_read_b128 v[76:79], v8 offset:864
  s_waitcnt lgkmcnt(5)
  v_mfma_f32_32x32x16_bf16 v[32:47], v[80:83], a[88:91], v[32:47]
  v_mfma_f32_32x32x16_bf16 v[48:63], v[80:83], a[248:251], v[48:63]
  ds_read_b128 v[80:83], v8 offset:896
  s_waitcnt lgkmcnt(5)
  v_mfma_f32_32x32x16_bf16 v[32:47], v[84:87], a[92:95], v[32:47]
  v_mfma_f32_32x32x16_bf16 v[48:63], v[84:87], a[252:255], v[48:63]
  ds_read_b128 v[84:87], v8 offset:928
  s_waitcnt lgkmcnt(5)
  v_mfma_f32_32x32x16_bf16 v[32:47], v[64:67], a[96:99], v[32:47]
  v_mfma_f32_32x32x16_bf16 v[48:63], v[64:67], v[192:195], v[48:63]
  ds_read_b128 v[64:67], v8 offset:960
  s_waitcnt lgkmcnt(5)
  v_mfma_f32_32x32x16_bf16 v[32:47], v[68:71], a[100:103], v[32:47]
  v_mfma_f32_32x32x16_bf16 v[48:63], v[68:71], v[196:199], v[48:63]
  ds_read_b128 v[68:71], v8 offset:992
  s_waitcnt lgkmcnt(5)
  v_mfma_f32_32x32x16_bf16 v[32:47], v[72:75], a[104:107], v[32:47]
  v_mfma_f32_32x32x16_bf16 v[48:63], v[72:75], v[200:203], v[48:63]
  v_xor_b32 v12, 0, v9
  ds_read_b128 v[72:75], v12
  s_waitcnt lgkmcnt(5)
  v_mfma_f32_32x32x16_bf16 v[32:47], v[76:79], a[108:111], v[32:47]
  v_mfma_f32_32x32x16_bf16 v[48:63], v[76:79], v[204:207], v[48:63]
  v_xor_b32 v13, 32, v9
  ds_read_b128 v[76:79], v13
  s_waitcnt lgkmcnt(5)
  v_mfma_f32_32x32x16_bf16 v[32:47], v[80:83], a[112:115], v[32:47]
  v_mfma_f32_32x32x16_bf16 v[48:63], v[80:83], v[208:211], v[48:63]
  v_xor_b32 v12, 64, v9
  ds_read_b128 v[80:83], v12
  s_waitcnt lgkmcnt(5)
  v_mfma_f32_32x32x16_bf16 v[32:47], v[84:87], a[116:119], v[32:47]
  v_mfma_f32_32x32x16_bf16 v[48:63], v[84:87], v[212:215], v[48:63]
  v_xor_b32 v13, 96, v9
  ds_read_b128 v[84:87], v13
  s_waitcnt lgkmcnt(5)
  v_mfma_f32_32x32x16_bf16 v[32:47], v[64:67], a[120:123], v[32:47]
  v_mfma_f32_32x32x16_bf16 v[48:63], v[64:67], v[216:219], v[48:63]
  v_xor_b32 v12, 128, v9
  ds_read_b128 v[64:67], v12
  s_waitcnt lgkmcnt(5)
  v_mfma_f32_32x32x16_bf16 v[32:47], v[68:71], a[124:127], v[32:47]
  v_mfma_f32_32x32x16_bf16 v[48:63], v[68:71], v[220:223], v[48:63]
  v_xor_b32 v13, 160, v9
  ds_read_b128 v[68:71], v13
  s_waitcnt lgkmcnt(5)
  v_mfma_f32_32x32x16_bf16 v[32:47], v[72:75], a[128:131], v[32:47]
  v_mfma_f32_32x32x16_bf16 v[48:63], v[72:75], v[224:227], v[48:63]
  v_xor_b32 v12, 192, v9
  ds_read_b128 v[72:75], v12
  s_waitcnt lgkmcnt(5)
  v_mfma_f32_32x32x16_bf16 v[32:47], v[76:79], a[132:135], v[32:47]
  v_mfma_f32_32x32x16_bf16 v[48:63], v[76:79], v[228:231], v[48:63]
  s_waitcnt vmcnt(0)
  s_barrier
  s_cmp_eq_u32 s32, 0
  s_cbranch_scc0 G_nfc1
  v_mov_b32 v98, s54
  v_add_u32 v98, s3, v98
  v_mov_b32 v99, 0
  s_mov_b64 exec, 1
  buffer_store_dword v98, v99, s[4:7], s52 offen sc1
  s_mov_b64 exec, -1
G_nfc1:
  v_xor_b32 v13, 224, v9
  ds_read_b128 v[76:79], v13
  s_waitcnt lgkmcnt(5)
  v_mfma_f32_32x32x16_bf16 v[32:47], v[80:83], a[136:139], v[32:47]
  v_mfma_f32_32x32x16_bf16 v[48:63], v[80:83], v[232:235], v[48:63]
  s_waitcnt lgkmcnt(4)
  v_mfma_f32_32x32x16_bf16 v[32:47], v[84:87], a[140:143], v[32:47]
  v_mfma_f32_32x32x16_bf16 v[48:63], v[84:87], v[236:239], v[48:63]
  s_waitcnt lgkmcnt(3)
  v_mfma_f32_32x32x16_bf16 v[32:47], v[64:67], a[144:147], v[32:47]
  v_mfma_f32_32x32x16_bf16 v[48:63], v[64:67], v[240:243], v[48:63]
  s_waitcnt lgkmcnt(2)
  v_mfma_f32_32x32x16_bf16 v[32:47], v[68:71], a[148:151], v[32:47]
  v_mfma_f32_32x32x16_bf16 v[48:63], v[68:71], v[244:247], v[48:63]
  s_waitcnt lgkmcnt(1)
  v_mfma_f32_32x32x16_bf16 v[32:47], v[72:75], a[152:155], v[32:47]
  v_mfma_f32_32x32x16_bf16 v[48:63], v[72:75], v[248:251], v[48:63]
  s_waitcnt lgkmcnt(0)
  v_mfma_f32_32x32x16_bf16 v[32:47], v[76:79], a[156:159], v[32:47]
  v_mfma_f32_32x32x16_bf16 v[48:63], v[76:79], v[252:255], v[48:63]
  s_mov_b32 s60, s55
  s_add_u32 s55, s55, 41472
  s_cmp_eq_u32 s55, 124416
  s_cselect_b32 s55, 0, s55
  s_mov_b32 s57, s60
  s_add_u32 s54, s54, 1
  s_branch G_loop1
G_last1:
  s_nop 11
  v_cvt_pk_bf16_f32 v146, v114, v115
  v_cvt_pk_bf16_f32 v147, v116, v117
  v_cvt_pk_bf16_f32 v148, v118, v119
  v_cvt_pk_bf16_f32 v149, v120, v121
  s_mul_i32 s60, s64, 0
  s_add_u32 s60, s60, 0
  v_xor_b32 v5, s60, v2
  ds_write_b128 v5, v[146:149]
  v_cvt_pk_bf16_f32 v150, v122, v123
  v_cvt_pk_bf16_f32 v151, v124, v125
  v_cvt_pk_bf16_f32 v152, v126, v127
  v_cvt_pk_bf16_f32 v153, v128, v129
  s_mul_i32 s60, s64, 0
  s_add_u32 s60, s60, 32
  v_xor_b32 v6, s60, v2
  ds_write_b128 v6, v[150:153]
  v_cvt_pk_bf16_f32 v154, v130, v131
  v_cvt_pk_bf16_f32 v155, v132, v133
  v_cvt_pk_bf16_f32 v156, v134, v135
  v_cvt_pk_bf16_f32 v157, v136, v137
  s_mul_i32 s60, s64, 1
  s_add_u32 s60, s60, 0
  v_xor_b32 v5, s60, v2
  ds_write_b128 v5, v[154:157]
  v_cvt_pk_bf16_f32 v158, v138, v139
  v_cvt_pk_bf16_f32 v159, v140, v141
  v_cvt_pk_bf16_f32 v160, v142, v143
  v_cvt_pk_bf16_f32 v161, v144, v145
  s_mul_i32 s60, s64, 1
  s_add_u32 s60, s60, 32
  v_xor_b32 v6, s60, v2
  ds_write_b128 v6, v[158:161]
  s_waitcnt lgkmcnt(0)
  v_xor_b32 v5, s65, v3
  ds_read_b128 v[146:149], v3 offset:0
  ds_read_b128 v[150:153], v5 offset:1024
  ds_read_b128 v[154:157], v3 offset:2048
  ds_read_b128 v[158:161], v5 offset:3072
  s_waitcnt lgkmcnt(3)
  s_mov_b32 s61, s48
  buffer_store_dwordx4 v[146:149], v4, s[4:7], s61 offen sc1
  s_add_u32 s61, s61, s66
  s_waitcnt lgkmcnt(2)
  buffer_store_dwordx4 v[150:153], v4, s[4:7], s61 offen sc1
  s_add_u32 s61, s61, s66
  s_waitcnt lgkmcnt(1)
  buffer_store_dwordx4 v[154:157], v4, s[4:7], s61 offen sc1
  s_add_u32 s61, s61, s66
  s_waitcnt lgkmcnt(0)
  buffer_store_dwordx4 v[158:161], v4, s[4:7], s61 offen sc1
  s_add_u32 s61, s61, s66
  s_add_u32 s48, s48, s49
  s_waitcnt vmcnt(0)
  s_barrier
  s_cmp_eq_u32 s32, 0
  s_cbranch_scc0 G_done
  v_mov_b32 v98, s54
  v_add_u32 v98, s3, v98
  v_mov_b32 v99, 0
  s_mov_b64 exec, 1
  buffer_store_dword v98, v99, s[4:7], s52 offen sc1
  s_mov_b64 exec, -1
G_done:
  s_waitcnt vmcnt(0)
  s_barrier
  s_cmp_eq_u32 s96, 1
  s_cbranch_scc1 K_b_after_p3
  s_cmp_eq_u32 s96, 2
  s_cbranch_scc1 K_a_after_p1
  s_cmp_eq_u32 s96, 3
  s_cbranch_scc1 K_c_after_p1
  s_branch K_a_final
K_chain:
  s_mul_i32 s85, s33, 16
  s_add_u32 s85, s85, s34
  s_lshl_b32 s85, s85, 7
  s_add_u32 s85, s85, 1867776
  s_lshr_b32 s60, s34, 1
  s_mul_i32 s35, s33, 8
  s_add_u32 s35, s35, s60
  s_and_b32 s36, s34, 1
  s_lshr_b32 s61, s34, 3
  s_mul_i32 s37, s33, 2
  s_add_u32 s37, s37, s61
  s_and_b32 s38, s34, 7
  s_lshl_b32 s82, s33, 16
  s_add_u32 s82, s82, 1310720
  s_lshl_b32 s44, s60, 11
  s_lshl_b32 s62, s36, 10
  s_add_u32 s44, s44, s62
  s_lshl_b32 s62, s32, 8
  s_add_u32 s44, s44, s62
  s_add_u32 s44, s44, s82
  s_add_u32 s46, s44, 0x8000
  s_lshl_b32 s45, s61, 2
  s_add_u32 s45, s45, s32
  s_lshl_b32 s45, s45, 11
  s_add_u32 s45, s45, s82
  s_lshl_b32 s62, s37, 3
  s_add_u32 s62, s62, s38
  s_lshr_b32 s63, s62, 2
  s_lshl_b32 s63, s63, 14
  s_and_b32 s62, s62, 3
  s_mul_i32 s62, s62, 1280
  s_add_u32 s47, s63, s62
  s_add_u32 s47, s47, 0
  s_mul_i32 s62, s32, 16
  s_add_u32 s62, s62, s34
  s_cmp_lt_u32 s62, 40
  s_cselect_b32 s52, 1, 0
  s_min_u32 s62, s62, 39
  s_mul_i32 s63, s62, 52429
  s_lshr_b32 s63, s63, 18
  s_mul_i32 s64, s63, 5
  s_sub_u32 s64, s62, s64
  s_lshr_b32 s48, s63, 2
  s_lshl_b32 s48, s48, 14
  s_and_b32 s63, s63, 3
  s_mul_i32 s63, s63, 1280
  s_add_u32 s48, s48, s63
  s_lshl_b32 s64, s64, 8
  s_add_u32 s48, s48, s64
  s_add_u32 s48, s48, 0
  s_lshl_b32 s84, s33, 16
  s_add_u32 s84, s84, 1048576
  s_lshl_b32 s62, s62, 8
  s_add_u32 s49, s84, s62
  s_lshl_b32 s62, s35, 19
  s_add_u32 s40, s62, 2097152
  s_add_u32 s41, s62, 18874368
  s_lshl_b32 s62, s35, 11
  s_add_u32 s42, s62, 52428800
  s_add_u32 s43, s62, 56623104
  s_mov_b32 s54, 0x3e0293ee
  s_mov_b32 s76, 4096
  s_mov_b32 s66, 0xff00ff00
  s_mov_b32 s67, 0xff00ff00
  s_mov_b32 s68, 0xffffffff
  s_mov_b32 s69, 0xff
  s_cmp_eq_u32 s36, 0
  s_mov_b32 s80, 0x000f000f
  s_lshl_b32 s62, s36, 2
  s_lshl_b32 s80, s80, s62
  s_mov_b32 s81, s80
  s_mov_b32 s70, 0x00ff00ff
  s_mov_b32 s71, 0x00ff00ff
  v_bfe_u32 v84, v0, 2, 2
  v_lshlrev_b32 v84, 1, v84
  v_and_b32 v85, 1, v0
  v_or_b32 v84, v84, v85
  v_bfe_u32 v85, v0, 1, 1
  v_lshrrev_b32 v86, 4, v0
  v_and_b32 v87, 15, v0
  v_mov_b32 v76, 0x4444
  v_mov_b32 v77, 0xeeee
  v_cmp_eq_u32 vcc, 1, v85
  s_nop 1
  v_cndmask_b32 v1, v76, v77, vcc
  v_and_b32 v76, 1, v0
  v_mov_b32 v77, 0x3f80
  v_mov_b32 v78, 0x3f800000
  v_cmp_eq_u32 vcc, 1, v76
  s_nop 1
  v_cndmask_b32 v77, v77, v78, vcc
  v_lshrrev_b32 v78, 2, v87
  v_cmp_eq_u32 vcc, v78, v86
  s_nop 1
  v_cndmask_b32 v79, 0, v77, vcc
  v_cmp_eq_u32 vcc, 0, v85
  s_nop 1
  v_cndmask_b32 v2, 0, v79, vcc
  v_mov_b32 v3, 0
  v_lshrrev_b32 v78, 1, v87
  v_cmp_eq_u32 vcc, v78, v86
  s_nop 1
  v_cndmask_b32 v4, 0, v77, vcc
  v_mov_b32 v5, 0
  v_mov_b32 v79, 0x3f803f80
  v_mov_b32 v8, v79
  v_mov_b32 v9, 0
  v_mov_b32 v10, 0
  v_mov_b32 v11, 0
  v_mov_b32 v12, v79
  v_mov_b32 v13, v79
  v_mov_b32 v14, v79
  v_mov_b32 v15, v79
  v_mov_b32 v79, 0xf149f2ca
  v_cmp_gt_u32 vcc, 2, v86
  s_nop 1
  v_cndmask_b32 v110, 0, v79, vcc
  v_cmp_eq_u32 vcc, 1, v85
  s_nop 1
  v_cndmask_b32 v109, 0, v110, vcc
  v_and_b32 v78, 1, v0
  v_cmp_eq_u32 vcc, 1, v78
  v_mov_b32 v79, 0x05040100
  v_mov_b32 v80, 0x03020706
  v_cndmask_b32 v6, v79, v80, vcc
  v_lshlrev_b32 v7, 4, v0
  v_add_u32 v7, 18432, v7
  v_lshrrev_b32 v78, 2, v0
  v_lshlrev_b32 v96, 8, v78
  v_lshrrev_b32 v79, 5, v0
  v_xor_b32 v79, v79, v0
  v_and_b32 v79, 3, v79
  v_lshl_add_u32 v96, v79, 4, v96
  s_lshl_b32 s63, s36, 12
  v_lshlrev_b32 v97, 4, v0
  v_add_u32 v97, s63, v97
  s_mul_i32 s98, s32, 3072
  s_add_u32 s98, s98, 111616
  v_bfe_u32 v79, v87, 2, 1
  v_lshlrev_b32 v79, 4, v79
  v_and_b32 v80, 1, v87
  v_add_u32 v79, v79, v80
  v_bfe_u32 v80, v87, 1, 1
  v_lshl_add_u32 v79, v80, 3, v79
  v_lshlrev_b32 v103, 6, v79
  v_lshrrev_b32 v79, 3, v79
  v_xor_b32 v79, v79, v86
  v_and_b32 v79, 3, v79
  v_lshl_add_u32 v103, v79, 4, v103
  v_add_u32 v103, s98, v103
  s_lshl_b32 s62, s36, 6
  s_lshl_b32 s63, s32, 4
  s_add_u32 s62, s62, s63
  v_add_u32 v78, s62, v87
  v_lshlrev_b32 v104, 4, v78
  v_lshl_add_u32 v104, v86, 2, v104
  v_and_b32 v79, 1, v0
  v_lshl_add_u32 v79, v86, 1, v79
  v_lshlrev_b32 v100, 5, v79
  v_lshrrev_b32 v79, 1, v87
  v_lshl_add_u32 v100, v79, 2, v100
  v_lshlrev_b32 v101, 8, v86
  v_lshl_add_u32 v101, v84, 5, v101
  v_lshl_add_u32 v101, v85, 4, v101
  s_lshl_b32 s62, s32, 11
  s_add_u32 s62, s62, 0
  v_lshlrev_b32 v102, 4, v0
  v_add_u32 v102, s62, v102
  s_lshl_b32 s100, s32, 10
  s_mul_i32 s99, s32, 2560
  s_add_u32 s99, s99, 8192
  s_mul_i32 s76, s32, 640
  v_lshlrev_b32 v80, 4, v0
  v_add_u32 v80, s76, v80
  v_lshrrev_b32 v78, 4, v80
  v_bfe_u32 v79, v78, 3, 1
  v_xor_b32 v79, v79, v78
  v_and_b32 v79, 1, v79
  v_lshrrev_b32 v78, 1, v78
  v_lshlrev_b32 v107, 4, v78
  v_lshl_add_u32 v107, v79, 3, v107
  v_lshlrev_b32 v105, 15, v86
  v_lshl_add_u32 v105, v87, 4, v105
  v_lshlrev_b32 v106, 5, v87
  v_lshl_add_u32 v106, v86, 3, v106
  v_mov_b32 v16, 0
  v_mov_b32 v17, 0
  v_mov_b32 v18, 0
  v_mov_b32 v19, 0
  v_mov_b32 v20, 0
  v_mov_b32 v21, 0
  v_mov_b32 v22, 0
  v_mov_b32 v23, 0
  v_mov_b32 v24, 0
  v_mov_b32 v25, 0
  v_mov_b32 v26, 0
  v_mov_b32 v27, 0
  v_mov_b32 v28, 0
  v_mov_b32 v29, 0
  v_mov_b32 v30, 0
  v_mov_b32 v31, 0
  v_mov_b32 v32, 0
  v_mov_b32 v33, 0
  v_mov_b32 v34, 0
  v_mov_b32 v35, 0
  v_mov_b32 v36, 0
  v_mov_b32 v37, 0
  v_mov_b32 v38, 0
  v_mov_b32 v39, 0
  s_cmp_eq_u32 s32, 3
  s_cbranch_scc1 CH_nosp
  v_mov_b32 v76, 0x3f80
  v_mov_b32 v77, 0x3f800000
  v_cmp_eq_u32 vcc, 0, v87
  s_nop 1
  v_cndmask_b32 v96, 0, v76, vcc
  v_cmp_eq_u32 vcc, 1, v87
  s_nop 1
  v_cndmask_b32 v96, v96, v77, vcc
  v_cmp_eq_u32 vcc, 2, v87
  s_nop 1
  v_cndmask_b32 v97, 0, v76, vcc
  v_cmp_eq_u32 vcc, 3, v87
  s_nop 1
  v_cndmask_b32 v97, v97, v77, vcc
  v_cmp_eq_u32 vcc, 4, v87
  s_nop 1
  v_cndmask_b32 v98, 0, v76, vcc
  v_cmp_eq_u32 vcc, 5, v87
  s_nop 1
  v_cndmask_b32 v98, v98, v77, vcc
  v_cmp_eq_u32 vcc, 6, v87
  s_nop 1
  v_cndmask_b32 v99, 0, v76, vcc
  v_cmp_eq_u32 vcc, 7, v87
  s_nop 1
  v_cndmask_b32 v99, v99, v77, vcc
CH_nosp:
  v_mov_b32 v76, -1
  v_mov_b32 v77, -1
  s_add_u32 s62, s44, 0x8000
  buffer_store_dword v76, v100, s[4:7], s44 offen sc1
  buffer_store_dword v76, v100, s[4:7], s62 offen sc1
  s_cmp_eq_u32 s52, 0
  s_cbranch_scc1 CH_nored0
  s_mov_b64 exec, s[70:71]
  s_add_u32 s62, s49, 0
  buffer_store_dwordx2 v[76:77], v106, s[4:7], s62 offen sc1
  s_add_u32 s62, s49, 16384
  buffer_store_dwordx2 v[76:77], v106, s[4:7], s62 offen sc1
  s_add_u32 s62, s49, 32768
  buffer_store_dwordx2 v[76:77], v106, s[4:7], s62 offen sc1
  s_mov_b64 exec, -1
CH_nored0:
  s_mov_b64 exec, s[68:69]
  s_add_u32 s62, s47, 0
  buffer_store_dwordx2 v[76:77], v107, s[4:7], s62 offen sc1
  s_add_u32 s62, s47, 8192
  buffer_store_dwordx2 v[76:77], v107, s[4:7], s62 offen sc1
  s_add_u32 s62, s47, 262144
  buffer_store_dwordx2 v[76:77], v107, s[4:7], s62 offen sc1
  s_add_u32 s62, s47, 270336
  buffer_store_dwordx2 v[76:77], v107, s[4:7], s62 offen sc1
  s_add_u32 s62, s47, 524288
  buffer_store_dwordx2 v[76:77], v107, s[4:7], s62 offen sc1
  s_add_u32 s62, s47, 532480
  buffer_store_dwordx2 v[76:77], v107, s[4:7], s62 offen sc1
  s_mov_b64 exec, -1
  s_mul_i32 s86, s32, 18432
  s_add_u32 s86, s86, 29696
  s_load_dwordx2 s[8:9], s[0:1], 8
  s_mov_b32 s10, 10240
  s_mov_b32 s11, 0x20000
  s_waitcnt lgkmcnt(0)
  v_bfe_u32 v92, v0, 2, 2
  v_lshlrev_b32 v92, 1, v92
  v_and_b32 v93, 1, v0
  v_or_b32 v92, v92, v93
  v_mul_u32_u24 v92, 1280, v92
  v_lshrrev_b32 v93, 4, v0
  v_lshl_add_u32 v92, v93, 5, v92
  v_bfe_u32 v93, v0, 1, 1
  v_lshl_add_u32 v92, v93, 4, v92
  s_cmp_lt_u32 s32, 3
  s_cbranch_scc0 CH_m0skip
  s_mul_i32 s89, s32, 1024
  s_add_u32 m0, s89, 18432
  s_mul_i32 s89, s32, 128
  s_add_u32 s89, s89, 0
  buffer_load_dwordx4 v92, s[8:11], s89 offen  lds
  s_mul_i32 s89, s32, 1024
  s_add_u32 m0, s89, 21504
  s_mul_i32 s89, s32, 128
  s_add_u32 s89, s89, 384
  buffer_load_dwordx4 v92, s[8:11], s89 offen  lds
  s_mul_i32 s89, s32, 1024
  s_add_u32 m0, s89, 24576
  s_mul_i32 s89, s32, 128
  s_add_u32 s89, s89, 768
  buffer_load_dwordx4 v92, s[8:11], s89 offen  lds
  s_cmp_eq_u32 s32, 0
  s_cbranch_scc0 CH_m0_4
  s_mov_b32 m0, 27648
  s_mov_b32 s89, 1152
  buffer_load_dwordx4 v92, s[8:11], s89 offen  lds
CH_m0_4:
CH_m0skip:
  s_load_dwordx2 s[8:9], s[0:1], 16
  s_mov_b32 s10, 5242880
  s_mov_b32 s11, 0x20000
  s_load_dwordx2 s[12:13], s[0:1], 24
  s_mov_b32 s14, 5242880
  s_mov_b32 s15, 0x20000
  s_load_dwordx2 s[16:17], s[0:1], 32
  s_mov_b32 s18, 5242880
  s_mov_b32 s19, 0x20000
  s_load_dwordx2 s[20:21], s[0:1], 40
  s_mov_b32 s22, 5242880
  s_mov_b32 s23, 0x20000
  s_waitcnt lgkmcnt(0)
  v_lshrrev_b32 v76, 4, v0
  v_bfe_u32 v77, v0, 1, 3
  v_and_b32 v78, 1, v76
  v_or_b32 v78, 0, v78
  v_xor_b32 v78, v77, v78
  v_lshlrev_b32 v78, 5, v78
  v_and_b32 v79, 1, v0
  v_lshl_add_u32 v78, v79, 4, v78
  v_add_u32 v79, 0, v76
  v_lshl_add_u32 v60, v79, 13, v78
  v_and_b32 v78, 1, v76
  v_or_b32 v78, 2, v78
  v_xor_b32 v78, v77, v78
  v_lshlrev_b32 v78, 5, v78
  v_and_b32 v79, 1, v0
  v_lshl_add_u32 v78, v79, 4, v78
  v_add_u32 v79, 4, v76
  v_lshl_add_u32 v61, v79, 13, v78
  v_and_b32 v78, 1, v76
  v_or_b32 v78, 4, v78
  v_xor_b32 v78, v77, v78
  v_lshlrev_b32 v78, 5, v78
  v_and_b32 v79, 1, v0
  v_lshl_add_u32 v78, v79, 4, v78
  v_add_u32 v79, 8, v76
  v_lshl_add_u32 v62, v79, 13, v78
  v_and_b32 v78, 1, v76
  v_or_b32 v78, 6, v78
  v_xor_b32 v78, v77, v78
  v_lshlrev_b32 v78, 5, v78
  v_and_b32 v79, 1, v0
  v_lshl_add_u32 v78, v79, 4, v78
  v_add_u32 v79, 12, v76
  v_lshl_add_u32 v63, v79, 13, v78
  s_lshl_b32 s60, s32, 17
  s_lshl_b32 s61, s35, 8
  s_add_u32 s60, s60, s61
  v_add_u32 v60, s60, v60
  v_add_u32 v61, s60, v61
  v_add_u32 v62, s60, v62
  v_add_u32 v63, s60, v63
  v_lshrrev_b32 v76, 3, v0
  v_bfe_u32 v77, v0, 1, 2
  v_add_u32 v78, 0, v76
  v_bfe_u32 v79, v78, 2, 2
  v_xor_b32 v79, v77, v79
  v_lshlrev_b32 v79, 5, v79
  v_lshl_add_u32 v79, v78, 13, v79
  v_and_b32 v78, 1, v0
  v_lshl_add_u32 v64, v78, 4, v79
  v_add_u32 v78, 8, v76
  v_bfe_u32 v79, v78, 2, 2
  v_xor_b32 v79, v77, v79
  v_lshlrev_b32 v79, 5, v79
  v_lshl_add_u32 v79, v78, 13, v79
  v_and_b32 v78, 1, v0
  v_lshl_add_u32 v65, v78, 4, v79
  s_lshl_b32 s61, s36, 7
  s_add_u32 s60, s60, s61
  v_add_u32 v64, s60, v64
  v_add_u32 v65, s60, v65
  v_lshrrev_b32 v80, 4, v0
  v_bfe_u32 v81, v0, 2, 2
  v_and_b32 v82, 3, v0
  v_lshrrev_b32 v76, 1, v80
  v_lshlrev_b32 v76, 4, v76
  v_and_b32 v77, 1, v80
  v_lshl_add_u32 v76, v77, 2, v76
  v_and_b32 v78, 1, v81
  v_add_u32 v76, v76, v78
  v_lshrrev_b32 v79, 1, v81
  v_lshl_add_u32 v76, v79, 3, v76
  v_lshl_or_b32 v78, v77, 1, v78
  v_lshl_or_b32 v78, v79, 2, v78
  s_lshl_b32 s61, s32, 1
  s_add_u32 s61, s61, 0
  v_xor_b32 v66, s61, v78
  v_lshlrev_b32 v66, 5, v66
  v_lshl_add_u32 v66, v76, 8, v66
  v_lshl_add_u32 v66, v82, 3, v66
  s_lshl_b32 s61, s32, 1
  s_add_u32 s61, s61, 1
  v_xor_b32 v67, s61, v78
  v_lshlrev_b32 v67, 5, v67
  v_lshl_add_u32 v67, v76, 8, v67
  v_lshl_add_u32 v67, v82, 3, v67
  v_lshl_add_u32 v78, v79, 1, v77
  v_xor_b32 v68, s32, v78
  v_lshlrev_b32 v68, 5, v68
  v_lshl_add_u32 v68, v76, 7, v68
  v_lshl_add_u32 v68, v82, 3, v68
  v_mov_b32 v69, v76
  s_mov_b32 s62, 0
  s_lshl_b32 s63, s32, 12
  s_add_u32 m0, s63, 29696
  s_nop 0
  buffer_load_dwordx4 v60, s[8:11], s62 offen lds
  s_lshl_b32 s63, s32, 12
  s_add_u32 m0, s63, 30720
  s_nop 0
  buffer_load_dwordx4 v61, s[8:11], s62 offen lds
  s_lshl_b32 s63, s32, 12
  s_add_u32 m0, s63, 31744
  s_nop 0
  buffer_load_dwordx4 v62, s[8:11], s62 offen lds
  s_lshl_b32 s63, s32, 12
  s_add_u32 m0, s63, 32768
  s_nop 0
  buffer_load_dwordx4 v63, s[8:11], s62 offen lds
  s_add_u32 m0, s63, 46080
  s_nop 0
  buffer_load_dwordx4 v60, s[12:15], s62 offen lds
  s_add_u32 m0, s63, 47104
  s_nop 0
  buffer_load_dwordx4 v61, s[12:15], s62 offen lds
  s_add_u32 m0, s63, 48128
  s_nop 0
  buffer_load_dwordx4 v62, s[12:15], s62 offen lds
  s_add_u32 m0, s63, 49152
  s_nop 0
  buffer_load_dwordx4 v63, s[12:15], s62 offen lds
  s_lshl_b32 s63, s32, 11
  s_add_u32 m0, s63, 62464
  s_nop 0
  buffer_load_dwordx4 v64, s[16:19], s62 offen lds
  s_add_u32 m0, s63, 63488
  s_nop 0
  buffer_load_dwordx4 v65, s[16:19], s62 offen lds
  s_mov_b32 s62, 524288
  s_lshl_b32 s63, s32, 12
  s_add_u32 m0, s63, 70656
  s_nop 0
  buffer_load_dwordx4 v60, s[8:11], s62 offen lds
  s_lshl_b32 s63, s32, 12
  s_add_u32 m0, s63, 71680
  s_nop 0
  buffer_load_dwordx4 v61, s[8:11], s62 offen lds
  s_lshl_b32 s63, s32, 12
  s_add_u32 m0, s63, 72704
  s_nop 0
  buffer_load_dwordx4 v62, s[8:11], s62 offen lds
  s_lshl_b32 s63, s32, 12
  s_add_u32 m0, s63, 73728
  s_nop 0
  buffer_load_dwordx4 v63, s[8:11], s62 offen lds
  s_add_u32 m0, s63, 87040
  s_nop 0
  buffer_load_dwordx4 v60, s[12:15], s62 offen lds
  s_add_u32 m0, s63, 88064
  s_nop 0
  buffer_load_dwordx4 v61, s[12:15], s62 offen lds
  s_add_u32 m0, s63, 89088
  s_nop 0
  buffer_load_dwordx4 v62, s[12:15], s62 offen lds
  s_add_u32 m0, s63, 90112
  s_nop 0
  buffer_load_dwordx4 v63, s[12:15], s62 offen lds
  s_lshl_b32 s63, s32, 11
  s_add_u32 m0, s63, 103424
  s_nop 0
  buffer_load_dwordx4 v64, s[16:19], s62 offen lds
  s_add_u32 m0, s63, 104448
  s_nop 0
  buffer_load_dwordx4 v65, s[16:19], s62 offen lds
  s_waitcnt vmcnt(10)
  s_barrier
  s_mov_b32 s62, 1048576
  s_lshl_b32 s63, s32, 12
  s_add_u32 m0, s63, 111616
  s_nop 0
  buffer_load_dwordx4 v60, s[8:11], s62 offen lds
  s_lshl_b32 s63, s32, 12
  s_add_u32 m0, s63, 112640
  s_nop 0
  buffer_load_dwordx4 v61, s[8:11], s62 offen lds
  s_lshl_b32 s63, s32, 12
  s_add_u32 m0, s63, 113664
  s_nop 0
  buffer_load_dwordx4 v62, s[8:11], s62 offen lds
  s_lshl_b32 s63, s32, 12
  s_add_u32 m0, s63, 114688
  s_nop 0
  buffer_load_dwordx4 v63, s[8:11], s62 offen lds
  s_add_u32 m0, s63, 128000
  s_nop 0
  buffer_load_dwordx4 v60, s[12:15], s62 offen lds
  s_add_u32 m0, s63, 129024
  s_nop 0
  buffer_load_dwordx4 v61, s[12:15], s62 offen lds
  s_add_u32 m0, s63, 130048
  s_nop 0
  buffer_load_dwordx4 v62, s[12:15], s62 offen lds
  s_add_u32 m0, s63, 131072
  s_nop 0
  buffer_load_dwordx4 v63, s[12:15], s62 offen lds
  s_lshl_b32 s63, s32, 11
  s_add_u32 m0, s63, 144384
  s_nop 0
  buffer_load_dwordx4 v64, s[16:19], s62 offen lds
  s_add_u32 m0, s63, 145408
  s_nop 0
  buffer_load_dwordx4 v65, s[16:19], s62 offen lds
  s_cmp_eq_u32 s32, 0
  s_cbranch_scc0 CH_arr
  v_mov_b32 v92, 1
  v_mov_b32 v93, 48
  s_mov_b64 exec, 1
  buffer_atomic_add v92, v93, s[24:27], 0 offen
  s_mov_b64 exec, -1
CH_arr:
  v_add_u32 v88, 29696, v66
  v_add_u32 v89, 29696, v67
  v_add_u32 v90, 62464, v68
  ds_read_b64_tr_b16 a[0:1], v88 offset:0
  ds_read_b64_tr_b16 a[2:3], v88 offset:512
  ds_read_b64_tr_b16 a[4:5], v88 offset:8192
  ds_read_b64_tr_b16 a[6:7], v88 offset:8704
  ds_read_b64_tr_b16 a[80:81], v89 offset:0
  ds_read_b64_tr_b16 a[82:83], v89 offset:512
  ds_read_b64_tr_b16 a[84:85], v89 offset:8192
  ds_read_b64_tr_b16 a[86:87], v89 offset:8704
  ds_read_b64_tr_b16 a[160:161], v88 offset:16384
  ds_read_b64_tr_b16 a[162:163], v88 offset:16896
  ds_read_b64_tr_b16 a[164:165], v88 offset:24576
  ds_read_b64_tr_b16 a[166:167], v88 offset:25088
  s_waitcnt lgkmcnt(4)
  ds_read_b64_tr_b16 a[240:241], v89 offset:16384
  ds_read_b64_tr_b16 a[242:243], v89 offset:16896
  ds_read_b64_tr_b16 a[244:245], v89 offset:24576
  ds_read_b64_tr_b16 a[246:247], v89 offset:25088
  ds_read_b64_tr_b16 v[176:177], v90 offset:0
  ds_read_b64_tr_b16 v[178:179], v90 offset:256
  ds_read_b64_tr_b16 v[180:181], v90 offset:4096
  ds_read_b64_tr_b16 v[182:183], v90 offset:4352
  s_waitcnt lgkmcnt(0)
  s_waitcnt vmcnt(10)
  s_barrier
  s_mov_b32 s62, 1572864
  s_lshl_b32 s63, s32, 12
  s_add_u32 m0, s63, 29696
  s_nop 0
  buffer_load_dwordx4 v60, s[8:11], s62 offen lds
  s_lshl_b32 s63, s32, 12
  s_add_u32 m0, s63, 30720
  s_nop 0
  buffer_load_dwordx4 v61, s[8:11], s62 offen lds
  s_lshl_b32 s63, s32, 12
  s_add_u32 m0, s63, 31744
  s_nop 0
  buffer_load_dwordx4 v62, s[8:11], s62 offen lds
  s_lshl_b32 s63, s32, 12
  s_add_u32 m0, s63, 32768
  s_nop 0
  buffer_load_dwordx4 v63, s[8:11], s62 offen lds
  s_add_u32 m0, s63, 46080
  s_nop 0
  buffer_load_dwordx4 v60, s[12:15], s62 offen lds
  s_add_u32 m0, s63, 47104
  s_nop 0
  buffer_load_dwordx4 v61, s[12:15], s62 offen lds
  s_add_u32 m0, s63, 48128
  s_nop 0
  buffer_load_dwordx4 v62, s[12:15], s62 offen lds
  s_add_u32 m0, s63, 49152
  s_nop 0
  buffer_load_dwordx4 v63, s[12:15], s62 offen lds
  s_lshl_b32 s63, s32, 11
  s_add_u32 m0, s63, 62464
  s_nop 0
  buffer_load_dwordx4 v64, s[16:19], s62 offen lds
  s_add_u32 m0, s63, 63488
  s_nop 0
  buffer_load_dwordx4 v65, s[16:19], s62 offen lds
  v_add_u32 v88, 70656, v66
  v_add_u32 v89, 70656, v67
  v_add_u32 v90, 103424, v68
  ds_read_b64_tr_b16 a[8:9], v88 offset:0
  ds_read_b64_tr_b16 a[10:11], v88 offset:512
  ds_read_b64_tr_b16 a[12:13], v88 offset:8192
  ds_read_b64_tr_b16 a[14:15], v88 offset:8704
  ds_read_b64_tr_b16 a[88:89], v89 offset:0
  ds_read_b64_tr_b16 a[90:91], v89 offset:512
  ds_read_b64_tr_b16 a[92:93], v89 offset:8192
  ds_read_b64_tr_b16 a[94:95], v89 offset:8704
  ds_read_b64_tr_b16 a[168:169], v88 offset:16384
  ds_read_b64_tr_b16 a[170:171], v88 offset:16896
  ds_read_b64_tr_b16 a[172:173], v88 offset:24576
  ds_read_b64_tr_b16 a[174:175], v88 offset:25088
  s_waitcnt lgkmcnt(4)
  ds_read_b64_tr_b16 a[248:249], v89 offset:16384
  ds_read_b64_tr_b16 a[250:251], v89 offset:16896
  ds_read_b64_tr_b16 a[252:253], v89 offset:24576
  ds_read_b64_tr_b16 a[254:255], v89 offset:25088
  ds_read_b64_tr_b16 v[184:185], v90 offset:0
  ds_read_b64_tr_b16 v[186:187], v90 offset:256
  ds_read_b64_tr_b16 v[188:189], v90 offset:4096
  ds_read_b64_tr_b16 v[190:191], v90 offset:4352
  s_waitcnt lgkmcnt(0)
  s_waitcnt vmcnt(10)
  s_barrier
  s_mov_b32 s62, 2097152
  s_lshl_b32 s63, s32, 12
  s_add_u32 m0, s63, 70656
  s_nop 0
  buffer_load_dwordx4 v60, s[8:11], s62 offen lds
  s_lshl_b32 s63, s32, 12
  s_add_u32 m0, s63, 71680
  s_nop 0
  buffer_load_dwordx4 v61, s[8:11], s62 offen lds
  s_lshl_b32 s63, s32, 12
  s_add_u32 m0, s63, 72704
  s_nop 0
  buffer_load_dwordx4 v62, s[8:11], s62 offen lds
  s_lshl_b32 s63, s32, 12
  s_add_u32 m0, s63, 73728
  s_nop 0
  buffer_load_dwordx4 v63, s[8:11], s62 offen lds
  s_add_u32 m0, s63, 87040
  s_nop 0
  buffer_load_dwordx4 v60, s[12:15], s62 offen lds
  s_add_u32 m0, s63, 88064
  s_nop 0
  buffer_load_dwordx4 v61, s[12:15], s62 offen lds
  s_add_u32 m0, s63, 89088
  s_nop 0
  buffer_load_dwordx4 v62, s[12:15], s62 offen lds
  s_add_u32 m0, s63, 90112
  s_nop 0
  buffer_load_dwordx4 v63, s[12:15], s62 offen lds
  s_lshl_b32 s63, s32, 11
  s_add_u32 m0, s63, 103424
  s_nop 0
  buffer_load_dwordx4 v64, s[16:19], s62 offen lds
  s_add_u32 m0, s63, 104448
  s_nop 0
  buffer_load_dwordx4 v65, s[16:19], s62 offen lds
  v_add_u32 v88, 111616, v66
  v_add_u32 v89, 111616, v67
  v_add_u32 v90, 144384, v68
  ds_read_b64_tr_b16 a[16:17], v88 offset:0
  ds_read_b64_tr_b16 a[18:19], v88 offset:512
  ds_read_b64_tr_b16 a[20:21], v88 offset:8192
  ds_read_b64_tr_b16 a[22:23], v88 offset:8704
  ds_read_b64_tr_b16 a[96:97], v89 offset:0
  ds_read_b64_tr_b16 a[98:99], v89 offset:512
  ds_read_b64_tr_b16 a[100:101], v89 offset:8192
  ds_read_b64_tr_b16 a[102:103], v89 offset:8704
  ds_read_b64_tr_b16 a[176:177], v88 offset:16384
  ds_read_b64_tr_b16 a[178:179], v88 offset:16896
  ds_read_b64_tr_b16 a[180:181], v88 offset:24576
  ds_read_b64_tr_b16 a[182:183], v88 offset:25088
  s_waitcnt lgkmcnt(4)
  ds_read_b64_tr_b16 v[112:113], v89 offset:16384
  ds_read_b64_tr_b16 v[114:115], v89 offset:16896
  ds_read_b64_tr_b16 v[116:117], v89 offset:24576
  ds_read_b64_tr_b16 v[118:119], v89 offset:25088
  ds_read_b64_tr_b16 v[192:193], v90 offset:0
  ds_read_b64_tr_b16 v[194:195], v90 offset:256
  ds_read_b64_tr_b16 v[196:197], v90 offset:4096
  ds_read_b64_tr_b16 v[198:199], v90 offset:4352
  s_waitcnt lgkmcnt(0)
  s_waitcnt vmcnt(10)
  s_barrier
  s_mov_b32 s62, 2621440
  s_lshl_b32 s63, s32, 12
  s_add_u32 m0, s63, 111616
  s_nop 0
  buffer_load_dwordx4 v60, s[8:11], s62 offen lds
  s_lshl_b32 s63, s32, 12
  s_add_u32 m0, s63, 112640
  s_nop 0
  buffer_load_dwordx4 v61, s[8:11], s62 offen lds
  s_lshl_b32 s63, s32, 12
  s_add_u32 m0, s63, 113664
  s_nop 0
  buffer_load_dwordx4 v62, s[8:11], s62 offen lds
  s_lshl_b32 s63, s32, 12
  s_add_u32 m0, s63, 114688
  s_nop 0
  buffer_load_dwordx4 v63, s[8:11], s62 offen lds
  s_add_u32 m0, s63, 128000
  s_nop 0
  buffer_load_dwordx4 v60, s[12:15], s62 offen lds
  s_add_u32 m0, s63, 129024
  s_nop 0
  buffer_load_dwordx4 v61, s[12:15], s62 offen lds
  s_add_u32 m0, s63, 130048
  s_nop 0
  buffer_load_dwordx4 v62, s[12:15], s62 offen lds
  s_add_u32 m0, s63, 131072
  s_nop 0
  buffer_load_dwordx4 v63, s[12:15], s62 offen lds
  s_lshl_b32 s63, s32, 11
  s_add_u32 m0, s63, 144384
  s_nop 0
  buffer_load_dwordx4 v64, s[16:19], s62 offen lds
  s_add_u32 m0, s63, 145408
  s_nop 0
  buffer_load_dwordx4 v65, s[16:19], s62 offen lds
  v_add_u32 v88, 29696, v66
  v_add_u32 v89, 29696, v67
  v_add_u32 v90, 62464, v68
  ds_read_b64_tr_b16 a[24:25], v88 offset:0
  ds_read_b64_tr_b16 a[26:27], v88 offset:512
  ds_read_b64_tr_b16 a[28:29], v88 offset:8192
  ds_read_b64_tr_b16 a[30:31], v88 offset:8704
  ds_read_b64_tr_b16 a[104:105], v89 offset:0
  ds_read_b64_tr_b16 a[106:107], v89 offset:512
  ds_read_b64_tr_b16 a[108:109], v89 offset:8192
  ds_read_b64_tr_b16 a[110:111], v89 offset:8704
  ds_read_b64_tr_b16 a[184:185], v88 offset:16384
  ds_read_b64_tr_b16 a[186:187], v88 offset:16896
  ds_read_b64_tr_b16 a[188:189], v88 offset:24576
  ds_read_b64_tr_b16 a[190:191], v88 offset:25088
  s_waitcnt lgkmcnt(4)
  ds_read_b64_tr_b16 v[120:121], v89 offset:16384
  ds_read_b64_tr_b16 v[122:123], v89 offset:16896
  ds_read_b64_tr_b16 v[124:125], v89 offset:24576
  ds_read_b64_tr_b16 v[126:127], v89 offset:25088
  ds_read_b64_tr_b16 v[200:201], v90 offset:0
  ds_read_b64_tr_b16 v[202:203], v90 offset:256
  ds_read_b64_tr_b16 v[204:205], v90 offset:4096
  ds_read_b64_tr_b16 v[206:207], v90 offset:4352
  s_waitcnt lgkmcnt(0)
  s_waitcnt vmcnt(10)
  s_barrier
  s_mov_b32 s62, 3145728
  s_lshl_b32 s63, s32, 12
  s_add_u32 m0, s63, 29696
  s_nop 0
  buffer_load_dwordx4 v60, s[8:11], s62 offen lds
  s_lshl_b32 s63, s32, 12
  s_add_u32 m0, s63, 30720
  s_nop 0
  buffer_load_dwordx4 v61, s[8:11], s62 offen lds
  s_lshl_b32 s63, s32, 12
  s_add_u32 m0, s63, 31744
  s_nop 0
  buffer_load_dwordx4 v62, s[8:11], s62 offen lds
  s_lshl_b32 s63, s32, 12
  s_add_u32 m0, s63, 32768
  s_nop 0
  buffer_load_dwordx4 v63, s[8:11], s62 offen lds
  s_add_u32 m0, s63, 46080
  s_nop 0
  buffer_load_dwordx4 v60, s[12:15], s62 offen lds
  s_add_u32 m0, s63, 47104
  s_nop 0
  buffer_load_dwordx4 v61, s[12:15], s62 offen lds
  s_add_u32 m0, s63, 48128
  s_nop 0
  buffer_load_dwordx4 v62, s[12:15], s62 offen lds
  s_add_u32 m0, s63, 49152
  s_nop 0
  buffer_load_dwordx4 v63, s[12:15], s62 offen lds
  s_lshl_b32 s63, s32, 11
  s_add_u32 m0, s63, 62464
  s_nop 0
  buffer_load_dwordx4 v64, s[16:19], s62 offen lds
  s_add_u32 m0, s63, 63488
  s_nop 0
  buffer_load_dwordx4 v65, s[16:19], s62 offen lds
  v_add_u32 v88, 70656, v66
  v_add_u32 v89, 70656, v67
  v_add_u32 v90, 103424, v68
  ds_read_b64_tr_b16 a[32:33], v88 offset:0
  ds_read_b64_tr_b16 a[34:35], v88 offset:512
  ds_read_b64_tr_b16 a[36:37], v88 offset:8192
  ds_read_b64_tr_b16 a[38:39], v88 offset:8704
  ds_read_b64_tr_b16 a[112:113], v89 offset:0
  ds_read_b64_tr_b16 a[114:115], v89 offset:512
  ds_read_b64_tr_b16 a[116:117], v89 offset:8192
  ds_read_b64_tr_b16 a[118:119], v89 offset:8704
  ds_read_b64_tr_b16 a[192:193], v88 offset:16384
  ds_read_b64_tr_b16 a[194:195], v88 offset:16896
  ds_read_b64_tr_b16 a[196:197], v88 offset:24576
  ds_read_b64_tr_b16 a[198:199], v88 offset:25088
  s_waitcnt lgkmcnt(4)
  ds_read_b64_tr_b16 v[128:129], v89 offset:16384
  ds_read_b64_tr_b16 v[130:131], v89 offset:16896
  ds_read_b64_tr_b16 v[132:133], v89 offset:24576
  ds_read_b64_tr_b16 v[134:135], v89 offset:25088
  ds_read_b64_tr_b16 v[208:209], v90 offset:0
  ds_read_b64_tr_b16 v[210:211], v90 offset:256
  ds_read_b64_tr_b16 v[212:213], v90 offset:4096
  ds_read_b64_tr_b16 v[214:215], v90 offset:4352
  s_waitcnt lgkmcnt(0)
  s_waitcnt vmcnt(10)
  s_barrier
  s_mov_b32 s62, 3670016
  s_lshl_b32 s63, s32, 12
  s_add_u32 m0, s63, 70656
  s_nop 0
  buffer_load_dwordx4 v60, s[8:11], s62 offen lds
  s_lshl_b32 s63, s32, 12
  s_add_u32 m0, s63, 71680
  s_nop 0
  buffer_load_dwordx4 v61, s[8:11], s62 offen lds
  s_lshl_b32 s63, s32, 12
  s_add_u32 m0, s63, 72704
  s_nop 0
  buffer_load_dwordx4 v62, s[8:11], s62 offen lds
  s_lshl_b32 s63, s32, 12
  s_add_u32 m0, s63, 73728
  s_nop 0
  buffer_load_dwordx4 v63, s[8:11], s62 offen lds
  s_add_u32 m0, s63, 87040
  s_nop 0
  buffer_load_dwordx4 v60, s[12:15], s62 offen lds
  s_add_u32 m0, s63, 88064
  s_nop 0
  buffer_load_dwordx4 v61, s[12:15], s62 offen lds
  s_add_u32 m0, s63, 89088
  s_nop 0
  buffer_load_dwordx4 v62, s[12:15], s62 offen lds
  s_add_u32 m0, s63, 90112
  s_nop 0
  buffer_load_dwordx4 v63, s[12:15], s62 offen lds
  s_lshl_b32 s63, s32, 11
  s_add_u32 m0, s63, 103424
  s_nop 0
  buffer_load_dwordx4 v64, s[16:19], s62 offen lds
  s_add_u32 m0, s63, 104448
  s_nop 0
  buffer_load_dwordx4 v65, s[16:19], s62 offen lds
  v_add_u32 v88, 111616, v66
  v_add_u32 v89, 111616, v67
  v_add_u32 v90, 144384, v68
  ds_read_b64_tr_b16 a[40:41], v88 offset:0
  ds_read_b64_tr_b16 a[42:43], v88 offset:512
  ds_read_b64_tr_b16 a[44:45], v88 offset:8192
  ds_read_b64_tr_b16 a[46:47], v88 offset:8704
  ds_read_b64_tr_b16 a[120:121], v89 offset:0
  ds_read_b64_tr_b16 a[122:123], v89 offset:512
  ds_read_b64_tr_b16 a[124:125], v89 offset:8192
  ds_read_b64_tr_b16 a[126:127], v89 offset:8704
  ds_read_b64_tr_b16 a[200:201], v88 offset:16384
  ds_read_b64_tr_b16 a[202:203], v88 offset:16896
  ds_read_b64_tr_b16 a[204:205], v88 offset:24576
  ds_read_b64_tr_b16 a[206:207], v88 offset:25088
  s_waitcnt lgkmcnt(4)
  ds_read_b64_tr_b16 v[136:137], v89 offset:16384
  ds_read_b64_tr_b16 v[138:139], v89 offset:16896
  ds_read_b64_tr_b16 v[140:141], v89 offset:24576
  ds_read_b64_tr_b16 v[142:143], v89 offset:25088
  ds_read_b64_tr_b16 v[216:217], v90 offset:0
  ds_read_b64_tr_b16 v[218:219], v90 offset:256
  ds_read_b64_tr_b16 v[220:221], v90 offset:4096
  ds_read_b64_tr_b16 v[222:223], v90 offset:4352
  s_waitcnt lgkmcnt(0)
  s_waitcnt vmcnt(10)
  s_barrier
  s_mov_b32 s62, 4194304
  s_lshl_b32 s63, s32, 12
  s_add_u32 m0, s63, 111616
  s_nop 0
  buffer_load_dwordx4 v60, s[8:11], s62 offen lds
  s_lshl_b32 s63, s32, 12
  s_add_u32 m0, s63, 112640
  s_nop 0
  buffer_load_dwordx4 v61, s[8:11], s62 offen lds
  s_lshl_b32 s63, s32, 12
  s_add_u32 m0, s63, 113664
  s_nop 0
  buffer_load_dwordx4 v62, s[8:11], s62 offen lds
  s_lshl_b32 s63, s32, 12
  s_add_u32 m0, s63, 114688
  s_nop 0
  buffer_load_dwordx4 v63, s[8:11], s62 offen lds
  s_add_u32 m0, s63, 128000
  s_nop 0
  buffer_load_dwordx4 v60, s[12:15], s62 offen lds
  s_add_u32 m0, s63, 129024
  s_nop 0
  buffer_load_dwordx4 v61, s[12:15], s62 offen lds
  s_add_u32 m0, s63, 130048
  s_nop 0
  buffer_load_dwordx4 v62, s[12:15], s62 offen lds
  s_add_u32 m0, s63, 131072
  s_nop 0
  buffer_load_dwordx4 v63, s[12:15], s62 offen lds
  s_lshl_b32 s63, s32, 11
  s_add_u32 m0, s63, 144384
  s_nop 0
  buffer_load_dwordx4 v64, s[16:19], s62 offen lds
  s_add_u32 m0, s63, 145408
  s_nop 0
  buffer_load_dwordx4 v65, s[16:19], s62 offen lds
  v_add_u32 v88, 29696, v66
  v_add_u32 v89, 29696, v67
  v_add_u32 v90, 62464, v68
  ds_read_b64_tr_b16 a[48:49], v88 offset:0
  ds_read_b64_tr_b16 a[50:51], v88 offset:512
  ds_read_b64_tr_b16 a[52:53], v88 offset:8192
  ds_read_b64_tr_b16 a[54:55], v88 offset:8704
  ds_read_b64_tr_b16 a[128:129], v89 offset:0
  ds_read_b64_tr_b16 a[130:131], v89 offset:512
  ds_read_b64_tr_b16 a[132:133], v89 offset:8192
  ds_read_b64_tr_b16 a[134:135], v89 offset:8704
  ds_read_b64_tr_b16 a[208:209], v88 offset:16384
  ds_read_b64_tr_b16 a[210:211], v88 offset:16896
  ds_read_b64_tr_b16 a[212:213], v88 offset:24576
  ds_read_b64_tr_b16 a[214:215], v88 offset:25088
  s_waitcnt lgkmcnt(4)
  ds_read_b64_tr_b16 v[144:145], v89 offset:16384
  ds_read_b64_tr_b16 v[146:147], v89 offset:16896
  ds_read_b64_tr_b16 v[148:149], v89 offset:24576
  ds_read_b64_tr_b16 v[150:151], v89 offset:25088
  ds_read_b64_tr_b16 v[224:225], v90 offset:0
  ds_read_b64_tr_b16 v[226:227], v90 offset:256
  ds_read_b64_tr_b16 v[228:229], v90 offset:4096
  ds_read_b64_tr_b16 v[230:231], v90 offset:4352
  s_waitcnt lgkmcnt(0)
  s_waitcnt vmcnt(10)
  s_barrier
  s_mov_b32 s62, 4718592
  s_lshl_b32 s63, s32, 12
  s_add_u32 m0, s63, 29696
  s_nop 0
  buffer_load_dwordx4 v60, s[8:11], s62 offen lds
  s_lshl_b32 s63, s32, 12
  s_add_u32 m0, s63, 30720
  s_nop 0
  buffer_load_dwordx4 v61, s[8:11], s62 offen lds
  s_lshl_b32 s63, s32, 12
  s_add_u32 m0, s63, 31744
  s_nop 0
  buffer_load_dwordx4 v62, s[8:11], s62 offen lds
  s_lshl_b32 s63, s32, 12
  s_add_u32 m0, s63, 32768
  s_nop 0
  buffer_load_dwordx4 v63, s[8:11], s62 offen lds
  s_add_u32 m0, s63, 46080
  s_nop 0
  buffer_load_dwordx4 v60, s[12:15], s62 offen lds
  s_add_u32 m0, s63, 47104
  s_nop 0
  buffer_load_dwordx4 v61, s[12:15], s62 offen lds
  s_add_u32 m0, s63, 48128
  s_nop 0
  buffer_load_dwordx4 v62, s[12:15], s62 offen lds
  s_add_u32 m0, s63, 49152
  s_nop 0
  buffer_load_dwordx4 v63, s[12:15], s62 offen lds
  s_lshl_b32 s63, s32, 11
  s_add_u32 m0, s63, 62464
  s_nop 0
  buffer_load_dwordx4 v64, s[16:19], s62 offen lds
  s_add_u32 m0, s63, 63488
  s_nop 0
  buffer_load_dwordx4 v65, s[16:19], s62 offen lds
  v_add_u32 v88, 70656, v66
  v_add_u32 v89, 70656, v67
  v_add_u32 v90, 103424, v68
  ds_read_b64_tr_b16 a[56:57], v88 offset:0
  ds_read_b64_tr_b16 a[58:59], v88 offset:512
  ds_read_b64_tr_b16 a[60:61], v88 offset:8192
  ds_read_b64_tr_b16 a[62:63], v88 offset:8704
  ds_read_b64_tr_b16 a[136:137], v89 offset:0
  ds_read_b64_tr_b16 a[138:139], v89 offset:512
  ds_read_b64_tr_b16 a[140:141], v89 offset:8192
  ds_read_b64_tr_b16 a[142:143], v89 offset:8704
  ds_read_b64_tr_b16 a[216:217], v88 offset:16384
  ds_read_b64_tr_b16 a[218:219], v88 offset:16896
  ds_read_b64_tr_b16 a[220:221], v88 offset:24576
  ds_read_b64_tr_b16 a[222:223], v88 offset:25088
  s_waitcnt lgkmcnt(4)
  ds_read_b64_tr_b16 v[152:153], v89 offset:16384
  ds_read_b64_tr_b16 v[154:155], v89 offset:16896
  ds_read_b64_tr_b16 v[156:157], v89 offset:24576
  ds_read_b64_tr_b16 v[158:159], v89 offset:25088
  ds_read_b64_tr_b16 v[232:233], v90 offset:0
  ds_read_b64_tr_b16 v[234:235], v90 offset:256
  ds_read_b64_tr_b16 v[236:237], v90 offset:4096
  ds_read_b64_tr_b16 v[238:239], v90 offset:4352
  s_waitcnt lgkmcnt(0)
  s_waitcnt vmcnt(10)
  s_barrier
  v_add_u32 v88, 111616, v66
  v_add_u32 v89, 111616, v67
  v_add_u32 v90, 144384, v68
  ds_read_b64_tr_b16 a[64:65], v88 offset:0
  ds_read_b64_tr_b16 a[66:67], v88 offset:512
  ds_read_b64_tr_b16 a[68:69], v88 offset:8192
  ds_read_b64_tr_b16 a[70:71], v88 offset:8704
  ds_read_b64_tr_b16 a[144:145], v89 offset:0
  ds_read_b64_tr_b16 a[146:147], v89 offset:512
  ds_read_b64_tr_b16 a[148:149], v89 offset:8192
  ds_read_b64_tr_b16 a[150:151], v89 offset:8704
  ds_read_b64_tr_b16 a[224:225], v88 offset:16384
  ds_read_b64_tr_b16 a[226:227], v88 offset:16896
  ds_read_b64_tr_b16 a[228:229], v88 offset:24576
  ds_read_b64_tr_b16 a[230:231], v88 offset:25088
  s_waitcnt lgkmcnt(4)
  ds_read_b64_tr_b16 v[160:161], v89 offset:16384
  ds_read_b64_tr_b16 v[162:163], v89 offset:16896
  ds_read_b64_tr_b16 v[164:165], v89 offset:24576
  ds_read_b64_tr_b16 v[166:167], v89 offset:25088
  ds_read_b64_tr_b16 v[240:241], v90 offset:0
  ds_read_b64_tr_b16 v[242:243], v90 offset:256
  ds_read_b64_tr_b16 v[244:245], v90 offset:4096
  ds_read_b64_tr_b16 v[246:247], v90 offset:4352
  s_waitcnt lgkmcnt(0)
  s_waitcnt vmcnt(0)
  s_barrier
  v_add_u32 v88, 29696, v66
  v_add_u32 v89, 29696, v67
  v_add_u32 v90, 62464, v68
  ds_read_b64_tr_b16 a[72:73], v88 offset:0
  ds_read_b64_tr_b16 a[74:75], v88 offset:512
  ds_read_b64_tr_b16 a[76:77], v88 offset:8192
  ds_read_b64_tr_b16 a[78:79], v88 offset:8704
  ds_read_b64_tr_b16 a[152:153], v89 offset:0
  ds_read_b64_tr_b16 a[154:155], v89 offset:512
  ds_read_b64_tr_b16 a[156:157], v89 offset:8192
  ds_read_b64_tr_b16 a[158:159], v89 offset:8704
  ds_read_b64_tr_b16 a[232:233], v88 offset:16384
  ds_read_b64_tr_b16 a[234:235], v88 offset:16896
  ds_read_b64_tr_b16 a[236:237], v88 offset:24576
  ds_read_b64_tr_b16 a[238:239], v88 offset:25088
  s_waitcnt lgkmcnt(4)
  ds_read_b64_tr_b16 v[168:169], v89 offset:16384
  ds_read_b64_tr_b16 v[170:171], v89 offset:16896
  ds_read_b64_tr_b16 v[172:173], v89 offset:24576
  ds_read_b64_tr_b16 v[174:175], v89 offset:25088
  ds_read_b64_tr_b16 v[248:249], v90 offset:0
  ds_read_b64_tr_b16 v[250:251], v90 offset:256
  ds_read_b64_tr_b16 v[252:253], v90 offset:4096
  ds_read_b64_tr_b16 v[254:255], v90 offset:4352
  s_waitcnt lgkmcnt(0)
  s_barrier
  s_lshl_b32 s60, s37, 2
  s_add_u32 s60, s60, s32
  s_mul_i32 s60, s60, 163840
  s_mul_i32 s61, s38, 160
  s_add_u32 s60, s60, s61
  s_mov_b32 s64, 6554
  v_add_u32 v76, 0, v0
  v_mul_lo_u32 v77, s64, v76
  v_lshrrev_b32 v77, 16, v77
  v_mul_u32_u24 v78, 10, v77
  v_sub_u32 v78, v76, v78
  v_mul_u32_u24 v77, 1280, v77
  v_lshl_add_u32 v77, v78, 4, v77
  v_add_u32 v84, s60, v77
  v_add_u32 v76, 64, v0
  v_mul_lo_u32 v77, s64, v76
  v_lshrrev_b32 v77, 16, v77
  v_mul_u32_u24 v78, 10, v77
  v_sub_u32 v78, v76, v78
  v_mul_u32_u24 v77, 1280, v77
  v_lshl_add_u32 v77, v78, 4, v77
  v_add_u32 v85, s60, v77
  v_add_u32 v76, 128, v0
  v_mul_lo_u32 v77, s64, v76
  v_lshrrev_b32 v77, 16, v77
  v_mul_u32_u24 v78, 10, v77
  v_sub_u32 v78, v76, v78
  v_mul_u32_u24 v77, 1280, v77
  v_lshl_add_u32 v77, v78, 4, v77
  v_add_u32 v86, s60, v77
  v_add_u32 v76, 192, v0
  v_mul_lo_u32 v77, s64, v76
  v_lshrrev_b32 v77, 16, v77
  v_mul_u32_u24 v78, 10, v77
  v_sub_u32 v78, v76, v78
  v_mul_u32_u24 v77, 1280, v77
  v_lshl_add_u32 v77, v78, 4, v77
  v_add_u32 v87, s60, v77
  v_add_u32 v76, 256, v0
  v_mul_lo_u32 v77, s64, v76
  v_lshrrev_b32 v77, 16, v77
  v_mul_u32_u24 v78, 10, v77
  v_sub_u32 v78, v76, v78
  v_mul_u32_u24 v77, 1280, v77
  v_lshl_add_u32 v77, v78, 4, v77
  v_add_u32 v88, s60, v77
  v_add_u32 v76, 320, v0
  v_mul_lo_u32 v77, s64, v76
  v_lshrrev_b32 v77, 16, v77
  v_mul_u32_u24 v78, 10, v77
  v_sub_u32 v78, v76, v78
  v_mul_u32_u24 v77, 1280, v77
  v_lshl_add_u32 v77, v78, 4, v77
  v_add_u32 v89, s60, v77
  v_add_u32 v76, 384, v0
  v_mul_lo_u32 v77, s64, v76
  v_lshrrev_b32 v77, 16, v77
  v_mul_u32_u24 v78, 10, v77
  v_sub_u32 v78, v76, v78
  v_mul_u32_u24 v77, 1280, v77
  v_lshl_add_u32 v77, v78, 4, v77
  v_add_u32 v90, s60, v77
  v_add_u32 v76, 448, v0
  v_mul_lo_u32 v77, s64, v76
  v_lshrrev_b32 v77, 16, v77
  v_mul_u32_u24 v78, 10, v77
  v_sub_u32 v78, v76, v78
  v_mul_u32_u24 v77, 1280, v77
  v_lshl_add_u32 v77, v78, 4, v77
  v_add_u32 v91, s60, v77
  v_add_u32 v76, 512, v0
  v_mul_lo_u32 v77, s64, v76
  v_lshrrev_b32 v77, 16, v77
  v_mul_u32_u24 v78, 10, v77
  v_sub_u32 v78, v76, v78
  v_mul_u32_u24 v77, 1280, v77
  v_lshl_add_u32 v77, v78, 4, v77
  v_add_u32 v92, s60, v77
  v_add_u32 v76, 576, v0
  v_mul_lo_u32 v77, s64, v76
  v_lshrrev_b32 v77, 16, v77
  v_mul_u32_u24 v78, 10, v77
  v_sub_u32 v78, v76, v78
  v_mul_u32_u24 v77, 1280, v77
  v_lshl_add_u32 v77, v78, 4, v77
  v_add_u32 v93, s60, v77
  v_mul_u32_u24 v70, 160, v69
  v_lshl_add_u32 v70, v82, 3, v70
  s_mul_i32 s61, s32, 10240
  s_add_u32 s61, s61, 111616
  v_add_u32 v70, s61, v70
  s_mul_i32 s63, s32, 20480
  s_add_u32 s63, s63, 29696
  v_lshlrev_b32 v71, 4, v0
  v_add_u32 v71, s63, v71
  s_mov_b32 s62, 0
  s_add_u32 m0, s61, 0
  s_nop 0
  buffer_load_dwordx4 v84, s[20:23], s62 offen lds
  s_add_u32 m0, s61, 1024
  s_nop 0
  buffer_load_dwordx4 v85, s[20:23], s62 offen lds
  s_add_u32 m0, s61, 2048
  s_nop 0
  buffer_load_dwordx4 v86, s[20:23], s62 offen lds
  s_add_u32 m0, s61, 3072
  s_nop 0
  buffer_load_dwordx4 v87, s[20:23], s62 offen lds
  s_add_u32 m0, s61, 4096
  s_nop 0
  buffer_load_dwordx4 v88, s[20:23], s62 offen lds
  s_add_u32 m0, s61, 5120
  s_nop 0
  buffer_load_dwordx4 v89, s[20:23], s62 offen lds
  s_add_u32 m0, s61, 6144
  s_nop 0
  buffer_load_dwordx4 v90, s[20:23], s62 offen lds
  s_add_u32 m0, s61, 7168
  s_nop 0
  buffer_load_dwordx4 v91, s[20:23], s62 offen lds
  s_add_u32 m0, s61, 8192
  s_nop 0
  buffer_load_dwordx4 v92, s[20:23], s62 offen lds
  s_add_u32 m0, s61, 9216
  s_nop 0
  buffer_load_dwordx4 v93, s[20:23], s62 offen lds
  s_waitcnt vmcnt(0)
  ds_read_b64_tr_b16 v[40:41], v70 offset:0
  ds_read_b64_tr_b16 v[42:43], v70 offset:320
  ds_read_b64_tr_b16 v[44:45], v70 offset:5120
  ds_read_b64_tr_b16 v[46:47], v70 offset:5440
  s_waitcnt lgkmcnt(0)
  ds_write_b128 v71, v[40:43] offset:0
  ds_write_b128 v71, v[44:47] offset:1024
  ds_read_b64_tr_b16 v[48:49], v70 offset:32
  ds_read_b64_tr_b16 v[50:51], v70 offset:352
  ds_read_b64_tr_b16 v[52:53], v70 offset:5152
  ds_read_b64_tr_b16 v[54:55], v70 offset:5472
  s_waitcnt lgkmcnt(0)
  ds_write_b128 v71, v[48:51] offset:2048
  ds_write_b128 v71, v[52:55] offset:3072
  ds_read_b64_tr_b16 v[40:41], v70 offset:64
  ds_read_b64_tr_b16 v[42:43], v70 offset:384
  ds_read_b64_tr_b16 v[44:45], v70 offset:5184
  ds_read_b64_tr_b16 v[46:47], v70 offset:5504
  s_waitcnt lgkmcnt(0)
  ds_write_b128 v71, v[40:43] offset:4096
  ds_write_b128 v71, v[44:47] offset:5120
  ds_read_b64_tr_b16 v[48:49], v70 offset:96
  ds_read_b64_tr_b16 v[50:51], v70 offset:416
  ds_read_b64_tr_b16 v[52:53], v70 offset:5216
  ds_read_b64_tr_b16 v[54:55], v70 offset:5536
  s_waitcnt lgkmcnt(0)
  ds_write_b128 v71, v[48:51] offset:6144
  ds_write_b128 v71, v[52:55] offset:7168
  ds_read_b64_tr_b16 v[40:41], v70 offset:128
  ds_read_b64_tr_b16 v[42:43], v70 offset:448
  ds_read_b64_tr_b16 v[44:45], v70 offset:5248
  ds_read_b64_tr_b16 v[46:47], v70 offset:5568
  s_waitcnt lgkmcnt(0)
  ds_write_b128 v71, v[40:43] offset:8192
  ds_write_b128 v71, v[44:47] offset:9216
  s_waitcnt lgkmcnt(0)
  s_mov_b32 s62, 81920
  s_add_u32 m0, s61, 0
  s_nop 0
  buffer_load_dwordx4 v84, s[20:23], s62 offen lds
  s_add_u32 m0, s61, 1024
  s_nop 0
  buffer_load_dwordx4 v85, s[20:23], s62 offen lds
  s_add_u32 m0, s61, 2048
  s_nop 0
  buffer_load_dwordx4 v86, s[20:23], s62 offen lds
  s_add_u32 m0, s61, 3072
  s_nop 0
  buffer_load_dwordx4 v87, s[20:23], s62 offen lds
  s_add_u32 m0, s61, 4096
  s_nop 0
  buffer_load_dwordx4 v88, s[20:23], s62 offen lds
  s_add_u32 m0, s61, 5120
  s_nop 0
  buffer_load_dwordx4 v89, s[20:23], s62 offen lds
  s_add_u32 m0, s61, 6144
  s_nop 0
  buffer_load_dwordx4 v90, s[20:23], s62 offen lds
  s_add_u32 m0, s61, 7168
  s_nop 0
  buffer_load_dwordx4 v91, s[20:23], s62 offen lds
  s_add_u32 m0, s61, 8192
  s_nop 0
  buffer_load_dwordx4 v92, s[20:23], s62 offen lds
  s_add_u32 m0, s61, 9216
  s_nop 0
  buffer_load_dwordx4 v93, s[20:23], s62 offen lds
  s_waitcnt vmcnt(0)
  ds_read_b64_tr_b16 v[40:41], v70 offset:0
  ds_read_b64_tr_b16 v[42:43], v70 offset:320
  ds_read_b64_tr_b16 v[44:45], v70 offset:5120
  ds_read_b64_tr_b16 v[46:47], v70 offset:5440
  s_waitcnt lgkmcnt(0)
  ds_write_b128 v71, v[40:43] offset:10240
  ds_write_b128 v71, v[44:47] offset:11264
  ds_read_b64_tr_b16 v[48:49], v70 offset:32
  ds_read_b64_tr_b16 v[50:51], v70 offset:352
  ds_read_b64_tr_b16 v[52:53], v70 offset:5152
  ds_read_b64_tr_b16 v[54:55], v70 offset:5472
  s_waitcnt lgkmcnt(0)
  ds_write_b128 v71, v[48:51] offset:12288
  ds_write_b128 v71, v[52:55] offset:13312
  ds_read_b64_tr_b16 v[40:41], v70 offset:64
  ds_read_b64_tr_b16 v[42:43], v70 offset:384
  ds_read_b64_tr_b16 v[44:45], v70 offset:5184
  ds_read_b64_tr_b16 v[46:47], v70 offset:5504
  s_waitcnt lgkmcnt(0)
  ds_write_b128 v71, v[40:43] offset:14336
  ds_write_b128 v71, v[44:47] offset:15360
  ds_read_b64_tr_b16 v[48:49], v70 offset:96
  ds_read_b64_tr_b16 v[50:51], v70 offset:416
  ds_read_b64_tr_b16 v[52:53], v70 offset:5216
  ds_read_b64_tr_b16 v[54:55], v70 offset:5536
  s_waitcnt lgkmcnt(0)
  ds_write_b128 v71, v[48:51] offset:16384
  ds_write_b128 v71, v[52:55] offset:17408
  ds_read_b64_tr_b16 v[40:41], v70 offset:128
  ds_read_b64_tr_b16 v[42:43], v70 offset:448
  ds_read_b64_tr_b16 v[44:45], v70 offset:5248
  ds_read_b64_tr_b16 v[46:47], v70 offset:5568
  s_waitcnt lgkmcnt(0)
  ds_write_b128 v71, v[40:43] offset:18432
  ds_write_b128 v71, v[44:47] offset:19456
  s_waitcnt lgkmcnt(0)
  s_barrier
  s_cmp_eq_u32 s32, 0
  s_cbranch_scc0 CH_nowl
  v_mov_b32 v76, 1
  v_mov_b32 v77, 144
  s_mov_b64 exec, 1
  buffer_atomic_add v76, v77, s[24:27], 0 offen
  s_mov_b64 exec, -1
CH_nowl:
  v_mov_b32 v76, 48
  v_lshlrev_b32 v77, 5, v0
  v_mov_b32 v78, 1904640
  s_mov_b32 s59, 0
CH_su_w:
  buffer_load_dword v80, v76, s[24:27], 0 offen sc1
  s_mov_b64 exec, 15
  buffer_load_dword v81, v77, s[24:27], 0 offen sc1
  s_mov_b64 exec, -1
  buffer_load_dword v82, v78, s[4:7], 0 offen sc1
  s_waitcnt vmcnt(0)
  v_readfirstlane_b32 s62, v80
  v_readfirstlane_b32 s57, v82
  s_sub_u32 s57, s57, s3
  s_sub_u32 s63, s57, 1
  s_cmp_lt_u32 s63, 2
  s_cselect_b32 s63, s62, 0
  s_cmp_ge_u32 s63, 64
  s_cbranch_scc1 CH_su_d
  s_mov_b64 exec, 1
  s_mov_b64 exec, -1
  s_sleep 1
  s_add_u32 s59, s59, 4
  s_cmp_lt_u32 s59, s56
  s_cbranch_scc1 CH_su_w
  s_mov_b32 s56, 0
CH_su_d:
  v_readlane_b32 s62, v81, 0
  v_readlane_b32 s63, v81, 1
  s_min_u32 s62, s62, s63
  v_readlane_b32 s63, v81, 2
  s_min_u32 s62, s62, s63
  v_readlane_b32 s63, v81, 3
  s_min_u32 s62, s62, s63
  s_cmp_lt_u32 s62, 16
  s_cselect_b32 s58, 1, 0
  s_lshr_b32 s57, s57, 1
  s_and_b32 s57, s57, 1
  s_lshl_b32 s62, s57, 13
  s_add_u32 s47, s47, s62
  s_add_u32 s48, s48, s62
  s_mov_b32 s53, s47
  s_mov_b32 s73, s48
  s_add_u32 s101, s47, 262144
  s_mov_b32 s39, 0
  s_mov_b32 s72, 0
  s_mov_b32 s77, 0
  s_add_u32 s50, s84, 0x4000
  s_add_u32 s88, s49, 0x4000
  s_add_u32 s51, s49, 0x8000
  s_cmp_eq_u32 s32, 3
  s_cbranch_scc0 CH_nokv
  s_lshr_b32 s89, s35, 1
  v_lshlrev_b32 v76, 5, v0
  v_add_u32 v76, s89, v76
  v_lshlrev_b32 v76, 2, v76
  s_lshr_b32 s89, s39, 4
  v_add_u32 v76, s89, v76
  v_lshlrev_b32 v76, 7, v76
  v_add_u32 v76, 1835008, v76
  s_and_b32 s89, s39, 15
  s_add_u32 s89, s89, 1
  s_add_u32 s89, s89, s3
  s_mov_b32 s59, 0
  s_mov_b64 exec, 3
CH_kv0_w:
  buffer_load_dword v77, v76, s[4:7], 0 offen sc1
  s_waitcnt vmcnt(0)
  v_subrev_u32 v78, s89, v77
  v_cmp_lt_u32 vcc, 0x7f, v78
  s_cbranch_vccz CH_kv0_d
  s_sleep 1
  s_add_u32 s59, s59, 2
  s_cmp_lt_u32 s59, s56
  s_cbranch_scc1 CH_kv0_w
  s_mov_b32 s56, 0
CH_kv0_d:
  s_mov_b64 exec, -1
  v_readlane_b32 s89, v77, 0
  v_readlane_b32 s77, v77, 1
  s_min_u32 s77, s77, s89
  s_sub_u32 s77, s77, s3
  s_min_u32 s77, s77, 16
  s_and_b32 s89, s39, 0x30
  s_add_u32 s77, s77, s89
  v_xor_b32 v80, 32, v96
  s_mov_b32 m0, 111616
  s_add_u32 s89, s40, 0
  buffer_load_dwordx4 v96, s[4:7], s89 offen sc1 lds
  s_mov_b32 m0, 112640
  s_add_u32 s89, s40, 4096
  buffer_load_dwordx4 v80, s[4:7], s89 offen sc1 lds
  s_mov_b32 m0, 113664
  s_add_u32 s89, s41, 0
  buffer_load_dwordx4 v97, s[4:7], s89 offen sc1 lds
  s_mov_b32 m0, 114688
  s_add_u32 s89, s40, 64
  buffer_load_dwordx4 v96, s[4:7], s89 offen sc1 lds
  s_mov_b32 m0, 115712
  s_add_u32 s89, s40, 4160
  buffer_load_dwordx4 v80, s[4:7], s89 offen sc1 lds
  s_mov_b32 m0, 116736
  s_add_u32 s89, s41, 1024
  buffer_load_dwordx4 v97, s[4:7], s89 offen sc1 lds
  s_mov_b32 m0, 117760
  s_add_u32 s89, s40, 128
  buffer_load_dwordx4 v96, s[4:7], s89 offen sc1 lds
  s_mov_b32 m0, 118784
  s_add_u32 s89, s40, 4224
  buffer_load_dwordx4 v80, s[4:7], s89 offen sc1 lds
  s_mov_b32 m0, 119808
  s_add_u32 s89, s41, 2048
  buffer_load_dwordx4 v97, s[4:7], s89 offen sc1 lds
  s_mov_b32 m0, 120832
  s_add_u32 s89, s40, 192
  buffer_load_dwordx4 v96, s[4:7], s89 offen sc1 lds
  s_mov_b32 m0, 121856
  s_add_u32 s89, s40, 4288
  buffer_load_dwordx4 v80, s[4:7], s89 offen sc1 lds
  s_mov_b32 m0, 122880
  s_add_u32 s89, s41, 3072
  buffer_load_dwordx4 v97, s[4:7], s89 offen sc1 lds
CH_nokv:
  s_waitcnt vmcnt(0)
  v_mov_b32 v40, 0
  v_mov_b32 v41, 0
  v_mov_b32 v42, 0
  v_mov_b32 v43, 0
  v_mov_b32 v44, 0
  v_mov_b32 v45, 0
  v_mov_b32 v46, 0
  v_mov_b32 v47, 0
  v_mov_b32 v48, 0
  v_mov_b32 v49, 0
  v_mov_b32 v50, 0
  v_mov_b32 v51, 0
  v_mov_b32 v52, 0
  v_mov_b32 v53, 0
  v_mov_b32 v54, 0
  v_mov_b32 v55, 0
  v_mov_b32 v56, 0
  v_mov_b32 v57, 0
  v_mov_b32 v58, 0
  v_mov_b32 v59, 0
  s_barrier
  s_cmp_eq_u32 s58, 0
  s_cbranch_scc0 CH_slow
CHf_step:
  v_mov_b32 v76, -1
  v_mov_b32 v77, -1
  buffer_store_dword v76, v100, s[4:7], s46 offen
  s_mov_b64 exec, s[68:69]
  buffer_store_dwordx2 v[76:77], v107, s[4:7], s101 offen sc1
  s_cmp_eq_u32 s52, 0
  s_cbranch_scc1 CHf_nr1
  s_mov_b64 exec, s[70:71]
  buffer_store_dwordx2 v[76:77], v106, s[4:7], s51 offen
CHf_nr1:
  s_mov_b64 exec, -1
  s_cmp_eq_u32 s32, 3
  s_cbranch_scc0 CHf_nofl
  v_mov_b32 v80, s39
  v_add_u32 v80, s3, v80
  v_mov_b32 v81, 0
  s_mov_b64 exec, 1
  buffer_store_dword v80, v81, s[4:7], s85 offen sc1
  s_mov_b64 exec, -1
CHf_nofl:
  ds_read_b128 v[60:63], v7 offset:0
  ds_read_b128 v[64:67], v7 offset:1024
  ds_read_b128 v[68:71], v7 offset:2048
  ds_read_b128 v[72:75], v7 offset:3072
  s_waitcnt lgkmcnt(3)
  v_smfmac_f32_16x16x64_bf16 v[40:43], v[60:63], a[0:7], v1
  v_smfmac_f32_16x16x64_bf16 v[44:47], v[60:63], a[80:87], v1
  ds_read_b128 v[60:63], v7 offset:4096
  v_and_b32 v92, 15, v0
  v_lshlrev_b32 v92, 6, v92
  v_lshrrev_b32 v93, 4, v0
  v_lshl_add_u32 v92, v93, 4, v92
  v_add_u32 v92, s98, v92
  ds_read_b128 v[20:23], v92 offset:2048
  s_mov_b64 exec, s[66:67]
  ds_read_b128 v[24:27], v103 offset:0
  ds_read_b128 v[28:31], v103 offset:128
  ds_read_b128 v[32:35], v103 offset:256
  ds_read_b128 v[36:39], v103 offset:384
  s_mov_b64 exec, -1
  s_waitcnt lgkmcnt(8)
  v_smfmac_f32_16x16x64_bf16 v[40:43], v[64:67], a[8:15], v1
  v_smfmac_f32_16x16x64_bf16 v[44:47], v[64:67], a[88:95], v1
  ds_read_b128 v[64:67], v7 offset:5120
  v_mov_b32 v77, 0
  v_mov_b32 v79, 0
  s_waitcnt lgkmcnt(8)
  v_smfmac_f32_16x16x64_bf16 v[40:43], v[68:71], a[16:23], v1
  v_smfmac_f32_16x16x64_bf16 v[44:47], v[68:71], a[96:103], v1
  ds_read_b128 v[68:71], v7 offset:6144
  s_waitcnt lgkmcnt(8)
  v_smfmac_f32_16x16x64_bf16 v[40:43], v[72:75], a[24:31], v1
  v_smfmac_f32_16x16x64_bf16 v[44:47], v[72:75], a[104:111], v1
  ds_read_b128 v[72:75], v7 offset:7168
  s_waitcnt lgkmcnt(8)
  v_smfmac_f32_16x16x64_bf16 v[40:43], v[60:63], a[32:39], v1
  v_smfmac_f32_16x16x64_bf16 v[44:47], v[60:63], a[112:119], v1
  ds_read_b128 v[60:63], v7 offset:8192
  s_waitcnt lgkmcnt(3)
  v_smfmac_f32_16x16x64_bf16 v[40:43], v[64:67], a[40:47], v1
  v_smfmac_f32_16x16x64_bf16 v[44:47], v[64:67], a[120:127], v1
  ds_read_b128 v[64:67], v7 offset:9216
  s_waitcnt lgkmcnt(3)
  v_smfmac_f32_16x16x64_bf16 v[40:43], v[68:71], a[48:55], v1
  v_smfmac_f32_16x16x64_bf16 v[44:47], v[68:71], a[128:135], v1
  ds_read_b128 v[68:71], v7 offset:0
  s_waitcnt lgkmcnt(3)
  v_smfmac_f32_16x16x64_bf16 v[40:43], v[72:75], a[56:63], v1
  v_smfmac_f32_16x16x64_bf16 v[44:47], v[72:75], a[136:143], v1
  ds_read_b128 v[72:75], v7 offset:1024
  s_waitcnt lgkmcnt(3)
  v_smfmac_f32_16x16x64_bf16 v[40:43], v[60:63], a[64:71], v1
  v_smfmac_f32_16x16x64_bf16 v[44:47], v[60:63], a[144:151], v1
  ds_read_b128 v[60:63], v7 offset:2048
  s_waitcnt lgkmcnt(3)
  v_smfmac_f32_16x16x64_bf16 v[40:43], v[64:67], a[72:79], v1
  v_smfmac_f32_16x16x64_bf16 v[44:47], v[64:67], a[152:159], v1
  ds_read_b128 v[64:67], v7 offset:3072
  s_waitcnt lgkmcnt(3)
  v_smfmac_f32_16x16x64_bf16 v[48:51], v[68:71], a[160:167], v1
  v_smfmac_f32_16x16x64_bf16 v[52:55], v[68:71], a[240:247], v1
  ds_read_b128 v[68:71], v7 offset:4096
  s_waitcnt lgkmcnt(3)
  v_smfmac_f32_16x16x64_bf16 v[48:51], v[72:75], a[168:175], v1
  v_smfmac_f32_16x16x64_bf16 v[52:55], v[72:75], a[248:255], v1
  ds_read_b128 v[72:75], v7 offset:5120
  v_pk_add_f32 v[40:41], v[40:41], v[42:43]
  v_pk_add_f32 v[44:45], v[44:45], v[46:47]
  v_cvt_pk_bf16_f32 v76, v40, v41
  v_cvt_pk_bf16_f32 v78, v44, v45
  s_waitcnt lgkmcnt(3)
  v_smfmac_f32_16x16x64_bf16 v[48:51], v[60:63], a[176:183], v1
  v_smfmac_f32_16x16x64_bf16 v[52:55], v[60:63], v[112:119], v1
  ds_read_b128 v[60:63], v7 offset:6144
  v_mfma_f32_16x16x16_bf16 v[40:43], v[76:77], v[2:3], 0
  v_mfma_f32_16x16x16_bf16 v[44:47], v[78:79], v[2:3], 0
  s_waitcnt lgkmcnt(3)
  v_smfmac_f32_16x16x64_bf16 v[48:51], v[64:67], a[184:191], v1
  v_smfmac_f32_16x16x64_bf16 v[52:55], v[64:67], v[120:127], v1
  ds_read_b128 v[64:67], v7 offset:7168
  s_waitcnt lgkmcnt(3)
  v_smfmac_f32_16x16x64_bf16 v[48:51], v[68:71], a[192:199], v1
  v_smfmac_f32_16x16x64_bf16 v[52:55], v[68:71], v[128:135], v1
  ds_read_b128 v[68:71], v7 offset:8192
  s_waitcnt lgkmcnt(3)
  v_smfmac_f32_16x16x64_bf16 v[48:51], v[72:75], a[200:207], v1
  v_smfmac_f32_16x16x64_bf16 v[52:55], v[72:75], v[136:143], v1
  ds_read_b128 v[72:75], v7 offset:9216
  v_cvt_pk_bf16_f32 v80, v40, v41
  v_cvt_pk_bf16_f32 v81, v42, v43
  v_cvt_pk_bf16_f32 v82, v44, v45
  v_cvt_pk_bf16_f32 v83, v46, v47
  s_waitcnt lgkmcnt(3)
  v_smfmac_f32_16x16x64_bf16 v[48:51], v[60:63], a[208:215], v1
  v_smfmac_f32_16x16x64_bf16 v[52:55], v[60:63], v[144:151], v1
  ds_read_b128 v[60:63], v7 offset:0
  v_mov_b32_dpp v84, v80 quad_perm:[2,3,0,1] row_mask:0xf bank_mask:0xf
  v_mov_b32_dpp v85, v81 quad_perm:[2,3,0,1] row_mask:0xf bank_mask:0xf
  v_mov_b32_dpp v86, v82 quad_perm:[2,3,0,1] row_mask:0xf bank_mask:0xf
  v_mov_b32_dpp v87, v83 quad_perm:[2,3,0,1] row_mask:0xf bank_mask:0xf
  s_waitcnt lgkmcnt(3)
  v_smfmac_f32_16x16x64_bf16 v[48:51], v[64:67], a[216:223], v1
  v_smfmac_f32_16x16x64_bf16 v[52:55], v[64:67], v[152:159], v1
  ds_read_b128 v[64:67], v7 offset:1024
  v_mfma_f32_16x16x32_bf16 v[88:91], v[32:35], v[80:83], 0
  v_mfma_f32_16x16x32_bf16 v[92:95], v[28:31], v[84:87], 0
  v_mfma_f32_16x16x32_bf16 v[88:91], v[36:39], v[84:87], v[88:91]
  s_waitcnt lgkmcnt(3)
  v_smfmac_f32_16x16x64_bf16 v[48:51], v[68:71], a[224:231], v1
  v_smfmac_f32_16x16x64_bf16 v[52:55], v[68:71], v[160:167], v1
  ds_read_b128 v[68:71], v7 offset:2048
  s_waitcnt lgkmcnt(3)
  v_smfmac_f32_16x16x64_bf16 v[48:51], v[72:75], a[232:239], v1
  v_smfmac_f32_16x16x64_bf16 v[52:55], v[72:75], v[168:175], v1
  ds_read_b128 v[72:75], v7 offset:3072
  s_waitcnt lgkmcnt(3)
  v_smfmac_f32_16x16x64_bf16 v[56:59], v[60:63], v[176:183], v1
  ds_read_b128 v[60:63], v7 offset:4096
  s_waitcnt lgkmcnt(3)
  v_smfmac_f32_16x16x64_bf16 v[56:59], v[64:67], v[184:191], v1
  ds_read_b128 v[64:67], v7 offset:5120
  v_pk_add_f32 v[48:49], v[48:49], v[50:51]
  v_pk_add_f32 v[52:53], v[52:53], v[54:55]
  v_cvt_pk_bf16_f32 v76, v48, v49
  v_cvt_pk_bf16_f32 v78, v52, v53
  ds_write_b128 v102, v[88:91] offset:1024
  v_mfma_f32_16x16x16_bf16 v[48:51], v[76:77], v[4:5], 0
  v_mfma_f32_16x16x16_bf16 v[52:55], v[78:79], v[4:5], 0
  s_waitcnt lgkmcnt(4)
  v_smfmac_f32_16x16x64_bf16 v[56:59], v[68:71], v[192:199], v1
  ds_read_b128 v[68:71], v7 offset:6144
  s_waitcnt lgkmcnt(4)
  v_smfmac_f32_16x16x64_bf16 v[56:59], v[72:75], v[200:207], v1
  ds_read_b128 v[72:75], v7 offset:7168
  s_mov_b64 exec, s[70:71]
  v_cvt_pk_bf16_f32 v24, v48, v49
  v_cvt_pk_bf16_f32 v25, v50, v51
  v_cvt_pk_bf16_f32 v26, v52, v53
  v_cvt_pk_bf16_f32 v27, v54, v55
  s_mov_b64 exec, -1
  s_nop 1
  v_mfma_f32_16x16x32_bf16 v[92:95], v[24:27], v[80:83], v[92:95]
  s_waitcnt lgkmcnt(4)
  v_smfmac_f32_16x16x64_bf16 v[56:59], v[60:63], v[208:215], v1
  ds_read_b128 v[60:63], v7 offset:8192
  s_waitcnt lgkmcnt(4)
  v_smfmac_f32_16x16x64_bf16 v[56:59], v[64:67], v[216:223], v1
  ds_read_b128 v[64:67], v7 offset:9216
  s_nop 1
  ds_write_b128 v102, v[92:95]
  s_waitcnt lgkmcnt(0)
  s_cmp_eq_u32 s39, 63
  s_cbranch_scc1 CHf_last
  s_barrier
  v_xor_b32 v76, 2048, v102
  v_xor_b32 v77, 4096, v102
  v_xor_b32 v78, 6144, v102
  ds_read_b128 v[40:43], v76
  ds_read_b128 v[44:47], v76 offset:1024
  ds_read_b128 v[48:51], v77
  ds_read_b128 v[52:55], v77 offset:1024
  ds_read_b128 v[80:83], v78
  ds_read_b128 v[84:87], v78 offset:1024
  v_smfmac_f32_16x16x64_bf16 v[56:59], v[68:71], v[224:231], v1
  v_smfmac_f32_16x16x64_bf16 v[56:59], v[72:75], v[232:239], v1
  v_smfmac_f32_16x16x64_bf16 v[56:59], v[60:63], v[240:247], v1
  v_smfmac_f32_16x16x64_bf16 v[56:59], v[64:67], v[248:255], v1
  s_waitcnt lgkmcnt(5)
  v_pk_add_f32 v[92:93], v[92:93], v[40:41]
  v_pk_add_f32 v[94:95], v[94:95], v[42:43]
  s_waitcnt lgkmcnt(4)
  v_pk_add_f32 v[88:89], v[88:89], v[44:45]
  v_pk_add_f32 v[90:91], v[90:91], v[46:47]
  s_waitcnt lgkmcnt(3)
  v_pk_add_f32 v[92:93], v[92:93], v[48:49]
  v_pk_add_f32 v[94:95], v[94:95], v[50:51]
  s_waitcnt lgkmcnt(2)
  v_pk_add_f32 v[88:89], v[88:89], v[52:53]
  v_pk_add_f32 v[90:91], v[90:91], v[54:55]
  s_waitcnt lgkmcnt(1)
  v_pk_add_f32 v[92:93], v[92:93], v[80:81]
  v_pk_add_f32 v[94:95], v[94:95], v[82:83]
  s_waitcnt lgkmcnt(0)
  v_pk_add_f32 v[88:89], v[88:89], v[84:85]
  v_pk_add_f32 v[90:91], v[90:91], v[86:87]
  v_max3_f32 v76, v92, v93, v94
  v_max3_f32 v77, v88, v89, v90
  v_max_f32 v76, v76, v95
  v_max_f32 v77, v77, v91
  v_add_f32 v76, v76, v109
  v_add_f32 v77, v77, v110
  v_max_f32 v76, v76, v77
  v_pk_add_f32 v[56:57], v[56:57], v[58:59]
  v_mov_b32 v40, 0
  v_max_f32_dpp v76, v76, v76 quad_perm:[2,3,0,1] row_mask:0xf bank_mask:0xf
  v_cvt_pk_bf16_f32 v16, v56, v57
  v_mov_b32 v77, v76
  v_mov_b32 v41, 0
  v_mov_b32 v42, 0
  v_permlane16_swap_b32 v76, v77
  v_max_f32 v76, v76, v77
  v_mov_b32 v77, v76
  v_mov_b32 v43, 0
  v_mov_b32 v44, 0
  v_permlane32_swap_b32 v76, v77
  v_max_f32 v76, v76, v77
  v_mul_f32 v76, s54, v76
  v_sub_f32 v80, v109, v76
  v_sub_f32 v82, v110, v76
  v_pk_fma_f32 v[92:93], v[92:93], s[54:55], v[80:81] op_sel_hi:[1,0,0]
  v_pk_fma_f32 v[94:95], v[94:95], s[54:55], v[80:81] op_sel_hi:[1,0,0]
  v_pk_fma_f32 v[88:89], v[88:89], s[54:55], v[82:83] op_sel_hi:[1,0,0]
  v_pk_fma_f32 v[90:91], v[90:91], s[54:55], v[82:83] op_sel_hi:[1,0,0]
  v_exp_f32 v92, v92
  v_exp_f32 v93, v93
  v_exp_f32 v94, v94
  v_exp_f32 v95, v95
  v_exp_f32 v88, v88
  v_exp_f32 v89, v89
  v_cvt_pk_bf16_f32 v76, v92, v93
  v_exp_f32 v90, v90
  v_cvt_pk_bf16_f32 v78, v94, v95
  v_exp_f32 v91, v91
  v_cvt_pk_bf16_f32 v77, v88, v89
  v_mov_b32 v45, 0
  v_mov_b32 v46, 0
  v_cvt_pk_bf16_f32 v79, v90, v91
  v_mov_b32 v47, 0
  v_mov_b32 v108, v16
  v_smfmac_f32_16x16x64_bf16 v[40:43], v[76:79], v[16:23], v1
  v_smfmac_f32_16x16x64_bf16 v[44:47], v[76:79], v[8:15], v1
  v_add_u32 v111, s86, v102
  s_nop 5
  v_pk_add_f32 v[40:41], v[40:41], v[42:43]
  v_pk_add_f32 v[44:45], v[44:45], v[46:47]
  v_rcp_f32 v44, v44
  v_rcp_f32 v45, v45
  s_nop 0
  v_pk_mul_f32 v[40:41], v[40:41], v[44:45]
  v_cvt_pk_bf16_f32 v40, v40, v41
  s_nop 1
  v_mov_b32_dpp v41, v40 quad_perm:[1,0,3,2] row_mask:0xf bank_mask:0xf
  v_perm_b32 v40, v41, v40, v6
  v_min_u32 v40, -2, v40
  buffer_store_dword v40, v100, s[4:7], s44 offen
  s_sleep 1
  buffer_load_dwordx4 v[84:87], v101, s[4:7], s45 offen sc1
  buffer_load_dwordx4 v[88:91], v101, s[4:7], s45 offen offset:1024 sc1
  ds_read_b128 v[60:63], v111 offset:0
  ds_read_b128 v[64:67], v111 offset:1024
  ds_read_b128 v[68:71], v111 offset:10240
  ds_read_b128 v[72:75], v111 offset:11264
  ds_read_b128 v[32:35], v111 offset:2048
  ds_read_b128 v[36:39], v111 offset:3072
  ds_read_b128 v[16:19], v111 offset:12288
  ds_read_b128 v[20:23], v111 offset:13312
  v_mov_b64 v[40:41], 0
  v_mov_b64 v[42:43], 0
  v_mov_b64 v[44:45], 0
  v_mov_b64 v[46:47], 0
  v_mov_b64 v[48:49], 0
  v_mov_b64 v[50:51], 0
  v_mov_b64 v[52:53], 0
  v_mov_b64 v[54:55], 0
  v_mov_b64 v[56:57], 0
  v_mov_b64 v[58:59], 0
  v_lshrrev_b32 v95, 4, v0
  v_bfe_u32 v94, v0, 2, 1
  v_lshlrev_b32 v94, 1, v94
  v_xor_b32 v95, v95, v94
  v_and_b32 v94, 15, v0
  v_lshlrev_b32 v94, 5, v94
  v_lshl_add_u32 v94, v95, 3, v94
  v_add_u32 v94, s99, v94
  buffer_load_dwordx4 v[76:79], v101, s[4:7], s45 offen sc1
  buffer_load_dwordx4 v[80:83], v101, s[4:7], s45 offen offset:1024 sc1
  s_mov_b32 s59, 0
  s_waitcnt vmcnt(2)
  v_max3_u32 v92, v84, v85, v86
  v_max3_u32 v93, v87, v88, v89
  v_max3_u32 v92, v92, v90, v91
  v_max_u32 v92, v92, v93
  v_cmp_eq_u32 vcc, -1, v92
  s_cbranch_vccz CHf_og_s0
  buffer_load_dwordx4 v[84:87], v101, s[4:7], s45 offen sc1
  buffer_load_dwordx4 v[88:91], v101, s[4:7], s45 offen offset:1024 sc1
  s_branch CHf_og_l1
CHf_og_l0:
  s_waitcnt vmcnt(2)
  v_max3_u32 v92, v84, v85, v86
  v_max3_u32 v93, v87, v88, v89
  v_max3_u32 v92, v92, v90, v91
  v_max_u32 v92, v92, v93
  v_cmp_eq_u32 vcc, -1, v92
  s_cbranch_vccz CHf_og_s0
  buffer_load_dwordx4 v[84:87], v101, s[4:7], s45 offen sc1
  buffer_load_dwordx4 v[88:91], v101, s[4:7], s45 offen offset:1024 sc1
CHf_og_l1:
  s_waitcnt vmcnt(2)
  v_max3_u32 v92, v76, v77, v78
  v_max3_u32 v93, v79, v80, v81
  v_max3_u32 v92, v92, v82, v83
  v_max_u32 v92, v92, v93
  v_cmp_eq_u32 vcc, -1, v92
  s_cbranch_vccz CHf_og_s1
  buffer_load_dwordx4 v[76:79], v101, s[4:7], s45 offen sc1
  buffer_load_dwordx4 v[80:83], v101, s[4:7], s45 offen offset:1024 sc1
  s_add_u32 s59, s59, 1
  s_cmp_lt_u32 s59, s56
  s_cbranch_scc1 CHf_og_l0
  s_mov_b32 s56, 0
  s_waitcnt vmcnt(0)
CHf_og_s1:
  v_mov_b64 v[84:85], v[76:77]
  v_mov_b64 v[86:87], v[78:79]
  v_mov_b64 v[88:89], v[80:81]
  v_mov_b64 v[90:91], v[82:83]
  s_branch CHf_og_done
CHf_og_s0:
CHf_og_done:
  s_waitcnt lgkmcnt(6)
  v_smfmac_f32_16x16x64_bf16 v[40:43], v[84:87], v[60:67], v1
  ds_read_b128 v[60:63], v111 offset:4096
  ds_read_b128 v[64:67], v111 offset:5120
  s_waitcnt lgkmcnt(6)
  v_smfmac_f32_16x16x64_bf16 v[40:43], v[88:91], v[68:75], v1
  ds_read_b128 v[68:71], v111 offset:14336
  ds_read_b128 v[72:75], v111 offset:15360
  s_waitcnt lgkmcnt(6)
  v_smfmac_f32_16x16x64_bf16 v[44:47], v[84:87], v[32:39], v1
  ds_read_b128 v[32:35], v111 offset:6144
  ds_read_b128 v[36:39], v111 offset:7168
  s_waitcnt lgkmcnt(6)
  v_smfmac_f32_16x16x64_bf16 v[44:47], v[88:91], v[16:23], v1
  ds_read_b128 v[16:19], v111 offset:16384
  ds_read_b128 v[20:23], v111 offset:17408
  s_waitcnt lgkmcnt(6)
  v_smfmac_f32_16x16x64_bf16 v[48:51], v[84:87], v[60:67], v1
  ds_read_b128 v[60:63], v111 offset:8192
  ds_read_b128 v[64:67], v111 offset:9216
  s_waitcnt lgkmcnt(6)
  v_smfmac_f32_16x16x64_bf16 v[48:51], v[88:91], v[68:75], v1
  ds_read_b128 v[68:71], v111 offset:18432
  ds_read_b128 v[72:75], v111 offset:19456
  v_pk_add_f32 v[40:41], v[40:41], v[42:43]
  ds_write_b64 v94, v[40:41] offset:0
  s_waitcnt lgkmcnt(7)
  v_smfmac_f32_16x16x64_bf16 v[52:55], v[84:87], v[32:39], v1
  s_waitcnt lgkmcnt(5)
  v_smfmac_f32_16x16x64_bf16 v[52:55], v[88:91], v[16:23], v1
  v_pk_add_f32 v[44:45], v[44:45], v[46:47]
  ds_write_b64 v94, v[44:45] offset:512
  s_waitcnt lgkmcnt(4)
  v_smfmac_f32_16x16x64_bf16 v[56:59], v[84:87], v[60:67], v1
  s_waitcnt lgkmcnt(2)
  v_smfmac_f32_16x16x64_bf16 v[56:59], v[88:91], v[68:75], v1
  v_pk_add_f32 v[48:49], v[48:49], v[50:51]
  ds_write_b64 v94, v[48:49] offset:1024
  v_pk_add_f32 v[52:53], v[52:53], v[54:55]
  ds_write_b64 v94, v[52:53] offset:1536
  v_mov_b32 v17, 0
  v_mov_b32 v18, 0
  v_mov_b32 v19, 0
  s_nop 0
  v_pk_add_f32 v[56:57], v[56:57], v[58:59]
  ds_write_b64 v94, v[56:57] offset:2048
  v_lshlrev_b32 v111, 4, v0
  v_add_u32 v111, s76, v111
  s_waitcnt vmcnt(0) lgkmcnt(0)
  s_barrier
  s_mov_b64 exec, s[68:69]
  ds_read_b128 v[76:79], v111 offset:8192
  ds_read_b128 v[80:83], v111 offset:10752
  ds_read_b128 v[84:87], v111 offset:13312
  ds_read_b128 v[88:91], v111 offset:15872
  s_waitcnt lgkmcnt(2)
  v_pk_add_f32 v[76:77], v[76:77], v[80:81]
  v_pk_add_f32 v[78:79], v[78:79], v[82:83]
  s_waitcnt lgkmcnt(0)
  v_pk_add_f32 v[84:85], v[84:85], v[88:89]
  v_pk_add_f32 v[86:87], v[86:87], v[90:91]
  v_pk_add_f32 v[76:77], v[76:77], v[84:85]
  v_pk_add_f32 v[78:79], v[78:79], v[86:87]
  v_cvt_pk_bf16_f32 v76, v76, v77
  v_cvt_pk_bf16_f32 v77, v78, v79
  v_min_u32 v76, -2, v76
  v_min_u32 v77, -2, v77
  buffer_store_dwordx2 v[76:77], v107, s[4:7], s47 offen sc1
  s_mov_b64 exec, -1
  s_cmp_eq_u32 s32, 3
  s_cbranch_scc0 CHf_notw3
  s_add_u32 s40, s40, 8192
  s_add_u32 s41, s41, 8192
  v_and_b32 v84, 15, v0
  v_lshlrev_b32 v84, 8, v84
  v_lshrrev_b32 v85, 4, v0
  v_lshl_add_u32 v84, v85, 4, v84
  s_lshl_b32 s89, s32, 6
  v_add_u32 v84, s89, v84
  s_mov_b64 exec, s[80:81]
  buffer_store_dwordx4 v[24:27], v84, s[4:7], s42 offen sc1
  s_mov_b64 exec, -1
  buffer_store_dword v108, v104, s[4:7], s43 offen sc1
  s_add_u32 s65, s39, 1
  s_cmp_lt_u32 s65, s77
  s_cbranch_scc1 CHf_kvok
  s_min_u32 s65, s65, 63
  s_lshr_b32 s89, s35, 1
  v_lshlrev_b32 v76, 5, v0
  v_add_u32 v76, s89, v76
  v_lshlrev_b32 v76, 2, v76
  s_lshr_b32 s89, s65, 4
  v_add_u32 v76, s89, v76
  v_lshlrev_b32 v76, 7, v76
  v_add_u32 v76, 1835008, v76
  s_and_b32 s89, s65, 15
  s_add_u32 s89, s89, 1
  s_add_u32 s89, s89, s3
  s_mov_b32 s59, 0
  s_mov_b64 exec, 3
CHf_kvw_w:
  buffer_load_dword v77, v76, s[4:7], 0 offen sc1
  s_waitcnt vmcnt(0)
  v_subrev_u32 v78, s89, v77
  v_cmp_lt_u32 vcc, 0x7f, v78
  s_cbranch_vccz CHf_kvw_d
  s_sleep 1
  s_add_u32 s59, s59, 2
  s_cmp_lt_u32 s59, s56
  s_cbranch_scc1 CHf_kvw_w
  s_mov_b32 s56, 0
CHf_kvw_d:
  s_mov_b64 exec, -1
  v_readlane_b32 s89, v77, 0
  v_readlane_b32 s77, v77, 1
  s_min_u32 s77, s77, s89
  s_sub_u32 s77, s77, s3
  s_min_u32 s77, s77, 16
  s_and_b32 s89, s65, 0x30
  s_add_u32 s77, s77, s89
CHf_kvok:
  v_xor_b32 v80, 32, v96
  s_mov_b32 m0, 111616
  s_add_u32 s89, s40, 0
  buffer_load_dwordx4 v96, s[4:7], s89 offen sc1 lds
  s_mov_b32 m0, 112640
  s_add_u32 s89, s40, 4096
  buffer_load_dwordx4 v80, s[4:7], s89 offen sc1 lds
  s_mov_b32 m0, 113664
  s_add_u32 s89, s41, 0
  buffer_load_dwordx4 v97, s[4:7], s89 offen sc1 lds
  s_mov_b32 m0, 114688
  s_add_u32 s89, s40, 64
  buffer_load_dwordx4 v96, s[4:7], s89 offen sc1 lds
  s_mov_b32 m0, 115712
  s_add_u32 s89, s40, 4160
  buffer_load_dwordx4 v80, s[4:7], s89 offen sc1 lds
  s_mov_b32 m0, 116736
  s_add_u32 s89, s41, 1024
  buffer_load_dwordx4 v97, s[4:7], s89 offen sc1 lds
  s_mov_b32 m0, 117760
  s_add_u32 s89, s40, 128
  buffer_load_dwordx4 v96, s[4:7], s89 offen sc1 lds
  s_mov_b32 m0, 118784
  s_add_u32 s89, s40, 4224
  buffer_load_dwordx4 v80, s[4:7], s89 offen sc1 lds
  s_mov_b32 m0, 119808
  s_add_u32 s89, s41, 2048
  buffer_load_dwordx4 v97, s[4:7], s89 offen sc1 lds
  s_mov_b32 m0, 120832
  s_add_u32 s89, s40, 192
  buffer_load_dwordx4 v96, s[4:7], s89 offen sc1 lds
  s_mov_b32 m0, 121856
  s_add_u32 s89, s40, 4288
  buffer_load_dwordx4 v80, s[4:7], s89 offen sc1 lds
  s_mov_b32 m0, 122880
  s_add_u32 s89, s41, 3072
  buffer_load_dwordx4 v97, s[4:7], s89 offen sc1 lds
  s_add_u32 s42, s42, 65536
  s_add_u32 s43, s43, 65536
  v_mov_b64 v[40:41], 0
  v_mov_b64 v[42:43], 0
  v_mov_b64 v[44:45], 0
  v_mov_b64 v[46:47], 0
  v_mov_b64 v[48:49], 0
  v_mov_b64 v[50:51], 0
  v_mov_b64 v[52:53], 0
  v_mov_b64 v[54:55], 0
  v_mov_b64 v[56:57], 0
  v_mov_b64 v[58:59], 0
  s_add_u32 s39, s39, 1
  s_mov_b32 s62, s44
  s_mov_b32 s44, s46
  s_mov_b32 s46, s62
  s_xor_b32 s45, s45, 0x8000
  s_add_u32 s72, s72, 1
  s_cmp_eq_u32 s72, 3
  s_cselect_b32 s72, 0, s72
  s_add_u32 s62, s72, 1
  s_cmp_eq_u32 s62, 3
  s_cselect_b32 s62, 0, s62
  s_add_u32 s63, s62, 1
  s_cmp_eq_u32 s63, 3
  s_cselect_b32 s63, 0, s63
  s_lshl_b32 s101, s72, 18
  s_add_u32 s47, s53, s101
  s_add_u32 s48, s73, s101
  s_lshl_b32 s101, s62, 18
  s_add_u32 s101, s101, s53
  s_lshl_b32 s62, s62, 14
  s_lshl_b32 s63, s63, 14
  s_add_u32 s50, s84, s62
  s_add_u32 s88, s49, s62
  s_add_u32 s51, s49, s63
  s_waitcnt vmcnt(0)
  s_branch CHf_mdone
CHf_notw3:
  s_mov_b32 s78, s48
  s_add_u32 s79, s48, 131072
  s_mov_b32 s65, s88
  s_add_u32 s12, s100, 18432
  s_add_u32 s8, s100, s50
  s_add_u32 s13, s100, 21504
  s_add_u32 s9, s100, s50
  s_add_u32 s9, s9, 3072
  s_add_u32 s14, s100, 24576
  s_add_u32 s10, s100, s50
  s_add_u32 s10, s10, 6144
  s_cmp_eq_u32 s32, 0
  s_cselect_b32 s89, 9216, 0
  s_add_u32 s15, s12, s89
  s_add_u32 s11, s8, s89
  v_mov_b64 v[40:41], 0
  v_mov_b64 v[42:43], 0
  v_mov_b64 v[44:45], 0
  v_mov_b64 v[46:47], 0
  v_mov_b64 v[48:49], 0
  v_mov_b64 v[50:51], 0
  v_mov_b64 v[52:53], 0
  v_mov_b64 v[54:55], 0
  v_mov_b64 v[56:57], 0
  v_mov_b64 v[58:59], 0
  s_cmp_eq_u32 s52, 0
  s_cbranch_scc1 CHf_nored
  s_sleep 5
  buffer_load_dwordx4 v[60:63], v105, s[4:7], s78 offen sc1
  buffer_load_dwordx4 v[64:67], v105, s[4:7], s79 offen sc1
  s_add_u32 s39, s39, 1
  s_mov_b32 s62, s44
  s_mov_b32 s44, s46
  s_mov_b32 s46, s62
  s_xor_b32 s45, s45, 0x8000
  s_add_u32 s72, s72, 1
  s_cmp_eq_u32 s72, 3
  s_cselect_b32 s72, 0, s72
  s_add_u32 s62, s72, 1
  s_cmp_eq_u32 s62, 3
  s_cselect_b32 s62, 0, s62
  s_add_u32 s63, s62, 1
  s_cmp_eq_u32 s63, 3
  s_cselect_b32 s63, 0, s63
  s_lshl_b32 s101, s72, 18
  s_add_u32 s47, s53, s101
  s_add_u32 s48, s73, s101
  s_lshl_b32 s101, s62, 18
  s_add_u32 s101, s101, s53
  s_lshl_b32 s62, s62, 14
  s_lshl_b32 s63, s63, 14
  s_add_u32 s50, s84, s62
  s_add_u32 s88, s49, s62
  s_add_u32 s51, s49, s63
  v_and_b32 v94, 15, v0
  v_lshlrev_b32 v94, 8, v94
  v_lshrrev_b32 v95, 4, v0
  v_lshl_add_u32 v94, v95, 4, v94
  s_lshl_b32 s89, s32, 6
  v_add_u32 v94, s89, v94
  s_mov_b64 exec, s[80:81]
  buffer_store_dwordx4 v[24:27], v94, s[4:7], s42 offen sc1
  s_mov_b64 exec, -1
  buffer_store_dword v108, v104, s[4:7], s43 offen sc1
  s_add_u32 s42, s42, 65536
  s_add_u32 s43, s43, 65536
  s_mov_b32 s59, 0
  s_waitcnt vmcnt(2)
  v_mfma_f32_16x16x32_bf16 v[68:71], v[60:63], v[96:99], 0
  v_mfma_f32_16x16x32_bf16 v[68:71], v[64:67], v[96:99], v[68:71]
  v_max3_u32 v92, v60, v61, v62
  v_max3_u32 v93, v63, v64, v65
  v_max3_u32 v92, v92, v66, v67
  v_max_u32 v92, v92, v93
  v_cmp_eq_u32 vcc, -1, v92
  s_cbranch_vccz CHf_pg_s0
  buffer_load_dwordx4 v[60:63], v105, s[4:7], s78 offen sc1
  buffer_load_dwordx4 v[64:67], v105, s[4:7], s79 offen sc1
  s_branch CHf_pg_l1
CHf_pg_l0:
  s_waitcnt vmcnt(0)
  v_mfma_f32_16x16x32_bf16 v[68:71], v[60:63], v[96:99], 0
  v_mfma_f32_16x16x32_bf16 v[68:71], v[64:67], v[96:99], v[68:71]
  v_max3_u32 v92, v60, v61, v62
  v_max3_u32 v93, v63, v64, v65
  v_max3_u32 v92, v92, v66, v67
  v_max_u32 v92, v92, v93
  v_cmp_eq_u32 vcc, -1, v92
  s_cbranch_vccz CHf_pg_s0
  buffer_load_dwordx4 v[60:63], v105, s[4:7], s78 offen sc1
  buffer_load_dwordx4 v[64:67], v105, s[4:7], s79 offen sc1
CHf_pg_l1:
  s_add_u32 s59, s59, 1
  s_cmp_lt_u32 s59, s56
  s_cbranch_scc1 CHf_pg_l0
  s_mov_b32 s56, 0
  s_waitcnt vmcnt(0)
CHf_pg_s0:
  s_nop 1
CHf_pg_done:
  v_cvt_pk_bf16_f32 v68, v68, v69
  v_cvt_pk_bf16_f32 v69, v70, v71
  v_min_u32 v68, -2, v68
  v_min_u32 v69, -2, v69
  s_mov_b64 exec, s[70:71]
  buffer_store_dwordx2 v[68:69], v106, s[4:7], s65 offen
  s_mov_b64 exec, -1
  s_sleep 3
  s_branch CHf_mjoin
CHf_nored:
  s_add_u32 s39, s39, 1
  s_mov_b32 s62, s44
  s_mov_b32 s44, s46
  s_mov_b32 s46, s62
  s_xor_b32 s45, s45, 0x8000
  s_add_u32 s72, s72, 1
  s_cmp_eq_u32 s72, 3
  s_cselect_b32 s72, 0, s72
  s_add_u32 s62, s72, 1
  s_cmp_eq_u32 s62, 3
  s_cselect_b32 s62, 0, s62
  s_add_u32 s63, s62, 1
  s_cmp_eq_u32 s63, 3
  s_cselect_b32 s63, 0, s63
  s_lshl_b32 s101, s72, 18
  s_add_u32 s47, s53, s101
  s_add_u32 s48, s73, s101
  s_lshl_b32 s101, s62, 18
  s_add_u32 s101, s101, s53
  s_lshl_b32 s62, s62, 14
  s_lshl_b32 s63, s63, 14
  s_add_u32 s50, s84, s62
  s_add_u32 s88, s49, s62
  s_add_u32 s51, s49, s63
  v_and_b32 v94, 15, v0
  v_lshlrev_b32 v94, 8, v94
  v_lshrrev_b32 v95, 4, v0
  v_lshl_add_u32 v94, v95, 4, v94
  s_lshl_b32 s89, s32, 6
  v_add_u32 v94, s89, v94
  s_mov_b64 exec, s[80:81]
  buffer_store_dwordx4 v[24:27], v94, s[4:7], s42 offen sc1
  s_mov_b64 exec, -1
  buffer_store_dword v108, v104, s[4:7], s43 offen sc1
  s_add_u32 s42, s42, 65536
  s_add_u32 s43, s43, 65536
  s_sleep 14
CHf_mjoin:
  s_mov_b32 s59, 0
  s_mov_b32 m0, s12
  s_nop 0
  buffer_load_dwordx4 v101, s[4:7], s8 offen sc1 lds
  s_mov_b32 m0, s13
  s_nop 0
  buffer_load_dwordx4 v101, s[4:7], s9 offen sc1 lds
  s_mov_b32 m0, s14
  s_nop 0
  buffer_load_dwordx4 v101, s[4:7], s10 offen sc1 lds
  s_mov_b32 m0, s15
  s_nop 0
  buffer_load_dwordx4 v101, s[4:7], s11 offen sc1 lds
  v_lshlrev_b32 v93, 4, v0
  v_add_u32 v92, s12, v93
  v_add_u32 v93, s15, v93
  s_sleep 3
CHf_mg_poll:
  s_mov_b32 m0, s12
  s_nop 0
  buffer_load_dwordx4 v101, s[4:7], s8 offen sc1 lds
  s_mov_b32 m0, s13
  s_nop 0
  buffer_load_dwordx4 v101, s[4:7], s9 offen sc1 lds
  s_mov_b32 m0, s14
  s_nop 0
  buffer_load_dwordx4 v101, s[4:7], s10 offen sc1 lds
  s_mov_b32 m0, s15
  s_nop 0
  buffer_load_dwordx4 v101, s[4:7], s11 offen sc1 lds
  s_waitcnt vmcnt(4)
  ds_read_b128 v[76:79], v92 offset:0
  ds_read_b128 v[80:83], v92 offset:3072
  ds_read_b128 v[84:87], v92 offset:6144
  ds_read_b128 v[88:91], v93
  s_waitcnt lgkmcnt(2)
  v_max3_u32 v94, v76, v77, v78
  v_max3_u32 v95, v79, v80, v81
  v_max3_u32 v94, v94, v82, v83
  s_waitcnt lgkmcnt(0)
  v_max3_u32 v95, v95, v84, v85
  v_max3_u32 v94, v94, v86, v87
  v_max3_u32 v95, v95, v88, v89
  v_max3_u32 v94, v94, v90, v91
  v_max_u32 v94, v94, v95
  v_cmp_eq_u32 vcc, -1, v94
  s_cbranch_vccz CHf_mdone
  s_add_u32 s59, s59, 1
  s_cmp_lt_u32 s59, s56
  s_cbranch_scc1 CHf_mg_poll
  s_mov_b32 s56, 0
CHf_mdone:
  s_barrier
  s_branch CHf_step
CHf_last:
  s_waitcnt lgkmcnt(0)
  v_smfmac_f32_16x16x64_bf16 v[56:59], v[68:71], v[224:231], v1
  v_smfmac_f32_16x16x64_bf16 v[56:59], v[72:75], v[232:239], v1
  v_smfmac_f32_16x16x64_bf16 v[56:59], v[60:63], v[240:247], v1
  v_smfmac_f32_16x16x64_bf16 v[56:59], v[64:67], v[248:255], v1
  s_nop 7
  v_pk_add_f32 v[56:57], v[56:57], v[58:59]
  v_cvt_pk_bf16_f32 v108, v56, v57
  v_and_b32 v80, 15, v0
  v_lshlrev_b32 v80, 8, v80
  v_lshrrev_b32 v81, 4, v0
  v_lshl_add_u32 v80, v81, 4, v80
  s_lshl_b32 s89, s32, 6
  v_add_u32 v80, s89, v80
  s_mov_b64 exec, s[80:81]
  buffer_store_dwordx4 v[24:27], v80, s[4:7], s42 offen sc1
  s_mov_b64 exec, -1
  buffer_store_dword v108, v104, s[4:7], s43 offen sc1
  s_waitcnt vmcnt(0)
  s_branch CH_join
CH_slow:
CHs_step:
  v_mov_b32 v76, -1
  v_mov_b32 v77, -1
  buffer_store_dword v76, v100, s[4:7], s46 offen sc1
  s_mov_b64 exec, s[68:69]
  buffer_store_dwordx2 v[76:77], v107, s[4:7], s101 offen sc1
  s_cmp_eq_u32 s52, 0
  s_cbranch_scc1 CHs_nr1
  s_mov_b64 exec, s[70:71]
  buffer_store_dwordx2 v[76:77], v106, s[4:7], s51 offen sc1
CHs_nr1:
  s_mov_b64 exec, -1
  s_cmp_eq_u32 s32, 3
  s_cbranch_scc0 CHs_nofl
  v_mov_b32 v80, s39
  v_add_u32 v80, s3, v80
  v_mov_b32 v81, 0
  s_mov_b64 exec, 1
  buffer_store_dword v80, v81, s[4:7], s85 offen sc1
  s_mov_b64 exec, -1
CHs_nofl:
  ds_read_b128 v[60:63], v7 offset:0
  ds_read_b128 v[64:67], v7 offset:1024
  ds_read_b128 v[68:71], v7 offset:2048
  ds_read_b128 v[72:75], v7 offset:3072
  s_waitcnt lgkmcnt(3)
  v_smfmac_f32_16x16x64_bf16 v[40:43], v[60:63], a[0:7], v1
  v_smfmac_f32_16x16x64_bf16 v[44:47], v[60:63], a[80:87], v1
  ds_read_b128 v[60:63], v7 offset:4096
  v_and_b32 v92, 15, v0
  v_lshlrev_b32 v92, 6, v92
  v_lshrrev_b32 v93, 4, v0
  v_lshl_add_u32 v92, v93, 4, v92
  v_add_u32 v92, s98, v92
  ds_read_b128 v[20:23], v92 offset:2048
  s_mov_b64 exec, s[66:67]
  ds_read_b128 v[24:27], v103 offset:0
  ds_read_b128 v[28:31], v103 offset:128
  ds_read_b128 v[32:35], v103 offset:256
  ds_read_b128 v[36:39], v103 offset:384
  s_mov_b64 exec, -1
  s_waitcnt lgkmcnt(8)
  v_smfmac_f32_16x16x64_bf16 v[40:43], v[64:67], a[8:15], v1
  v_smfmac_f32_16x16x64_bf16 v[44:47], v[64:67], a[88:95], v1
  ds_read_b128 v[64:67], v7 offset:5120
  v_mov_b32 v77, 0
  v_mov_b32 v79, 0
  s_waitcnt lgkmcnt(8)
  v_smfmac_f32_16x16x64_bf16 v[40:43], v[68:71], a[16:23], v1
  v_smfmac_f32_16x16x64_bf16 v[44:47], v[68:71], a[96:103], v1
  ds_read_b128 v[68:71], v7 offset:6144
  s_waitcnt lgkmcnt(8)
  v_smfmac_f32_16x16x64_bf16 v[40:43], v[72:75], a[24:31], v1
  v_smfmac_f32_16x16x64_bf16 v[44:47], v[72:75], a[104:111], v1
  ds_read_b128 v[72:75], v7 offset:7168
  s_waitcnt lgkmcnt(8)
  v_smfmac_f32_16x16x64_bf16 v[40:43], v[60:63], a[32:39], v1
  v_smfmac_f32_16x16x64_bf16 v[44:47], v[60:63], a[112:119], v1
  ds_read_b128 v[60:63], v7 offset:8192
  s_waitcnt lgkmcnt(3)
  v_smfmac_f32_16x16x64_bf16 v[40:43], v[64:67], a[40:47], v1
  v_smfmac_f32_16x16x64_bf16 v[44:47], v[64:67], a[120:127], v1
  ds_read_b128 v[64:67], v7 offset:9216
  s_waitcnt lgkmcnt(3)
  v_smfmac_f32_16x16x64_bf16 v[40:43], v[68:71], a[48:55], v1
  v_smfmac_f32_16x16x64_bf16 v[44:47], v[68:71], a[128:135], v1
  ds_read_b128 v[68:71], v7 offset:0
  s_waitcnt lgkmcnt(3)
  v_smfmac_f32_16x16x64_bf16 v[40:43], v[72:75], a[56:63], v1
  v_smfmac_f32_16x16x64_bf16 v[44:47], v[72:75], a[136:143], v1
  ds_read_b128 v[72:75], v7 offset:1024
  s_waitcnt lgkmcnt(3)
  v_smfmac_f32_16x16x64_bf16 v[40:43], v[60:63], a[64:71], v1
  v_smfmac_f32_16x16x64_bf16 v[44:47], v[60:63], a[144:151], v1
  ds_read_b128 v[60:63], v7 offset:2048
  s_waitcnt lgkmcnt(3)
  v_smfmac_f32_16x16x64_bf16 v[40:43], v[64:67], a[72:79], v1
  v_smfmac_f32_16x16x64_bf16 v[44:47], v[64:67], a[152:159], v1
  ds_read_b128 v[64:67], v7 offset:3072
  s_waitcnt lgkmcnt(3)
  v_smfmac_f32_16x16x64_bf16 v[48:51], v[68:71], a[160:167], v1
  v_smfmac_f32_16x16x64_bf16 v[52:55], v[68:71], a[240:247], v1
  ds_read_b128 v[68:71], v7 offset:4096
  s_waitcnt lgkmcnt(3)
  v_smfmac_f32_16x16x64_bf16 v[48:51], v[72:75], a[168:175], v1
  v_smfmac_f32_16x16x64_bf16 v[52:55], v[72:75], a[248:255], v1
  ds_read_b128 v[72:75], v7 offset:5120
  v_pk_add_f32 v[40:41], v[40:41], v[42:43]
  v_pk_add_f32 v[44:45], v[44:45], v[46:47]
  v_cvt_pk_bf16_f32 v76, v40, v41
  v_cvt_pk_bf16_f32 v78, v44, v45
  s_waitcnt lgkmcnt(3)
  v_smfmac_f32_16x16x64_bf16 v[48:51], v[60:63], a[176:183], v1
  v_smfmac_f32_16x16x64_bf16 v[52:55], v[60:63], v[112:119], v1
  ds_read_b128 v[60:63], v7 offset:6144
  v_mfma_f32_16x16x16_bf16 v[40:43], v[76:77], v[2:3], 0
  v_mfma_f32_16x16x16_bf16 v[44:47], v[78:79], v[2:3], 0
  s_waitcnt lgkmcnt(3)
  v_smfmac_f32_16x16x64_bf16 v[48:51], v[64:67], a[184:191], v1
  v_smfmac_f32_16x16x64_bf16 v[52:55], v[64:67], v[120:127], v1
  ds_read_b128 v[64:67], v7 offset:7168
  s_waitcnt lgkmcnt(3)
  v_smfmac_f32_16x16x64_bf16 v[48:51], v[68:71], a[192:199], v1
  v_smfmac_f32_16x16x64_bf16 v[52:55], v[68:71], v[128:135], v1
  ds_read_b128 v[68:71], v7 offset:8192
  s_waitcnt lgkmcnt(3)
  v_smfmac_f32_16x16x64_bf16 v[48:51], v[72:75], a[200:207], v1
  v_smfmac_f32_16x16x64_bf16 v[52:55], v[72:75], v[136:143], v1
  ds_read_b128 v[72:75], v7 offset:9216
  v_cvt_pk_bf16_f32 v80, v40, v41
  v_cvt_pk_bf16_f32 v81, v42, v43
  v_cvt_pk_bf16_f32 v82, v44, v45
  v_cvt_pk_bf16_f32 v83, v46, v47
  s_waitcnt lgkmcnt(3)
  v_smfmac_f32_16x16x64_bf16 v[48:51], v[60:63], a[208:215], v1
  v_smfmac_f32_16x16x64_bf16 v[52:55], v[60:63], v[144:151], v1
  ds_read_b128 v[60:63], v7 offset:0
  v_mov_b32_dpp v84, v80 quad_perm:[2,3,0,1] row_mask:0xf bank_mask:0xf
  v_mov_b32_dpp v85, v81 quad_perm:[2,3,0,1] row_mask:0xf bank_mask:0xf
  v_mov_b32_dpp v86, v82 quad_perm:[2,3,0,1] row_mask:0xf bank_mask:0xf
  v_mov_b32_dpp v87, v83 quad_perm:[2,3,0,1] row_mask:0xf bank_mask:0xf
  s_waitcnt lgkmcnt(3)
  v_smfmac_f32_16x16x64_bf16 v[48:51], v[64:67], a[216:223], v1
  v_smfmac_f32_16x16x64_bf16 v[52:55], v[64:67], v[152:159], v1
  ds_read_b128 v[64:67], v7 offset:1024
  v_mfma_f32_16x16x32_bf16 v[88:91], v[32:35], v[80:83], 0
  v_mfma_f32_16x16x32_bf16 v[92:95], v[28:31], v[84:87], 0
  v_mfma_f32_16x16x32_bf16 v[88:91], v[36:39], v[84:87], v[88:91]
  s_waitcnt lgkmcnt(3)
  v_smfmac_f32_16x16x64_bf16 v[48:51], v[68:71], a[224:231], v1
  v_smfmac_f32_16x16x64_bf16 v[52:55], v[68:71], v[160:167], v1
  ds_read_b128 v[68:71], v7 offset:2048
  s_waitcnt lgkmcnt(3)
  v_smfmac_f32_16x16x64_bf16 v[48:51], v[72:75], a[232:239], v1
  v_smfmac_f32_16x16x64_bf16 v[52:55], v[72:75], v[168:175], v1
  ds_read_b128 v[72:75], v7 offset:3072
  s_waitcnt lgkmcnt(3)
  v_smfmac_f32_16x16x64_bf16 v[56:59], v[60:63], v[176:183], v1
  ds_read_b128 v[60:63], v7 offset:4096
  s_waitcnt lgkmcnt(3)
  v_smfmac_f32_16x16x64_bf16 v[56:59], v[64:67], v[184:191], v1
  ds_read_b128 v[64:67], v7 offset:5120
  v_pk_add_f32 v[48:49], v[48:49], v[50:51]
  v_pk_add_f32 v[52:53], v[52:53], v[54:55]
  v_cvt_pk_bf16_f32 v76, v48, v49
  v_cvt_pk_bf16_f32 v78, v52, v53
  ds_write_b128 v102, v[88:91] offset:1024
  v_mfma_f32_16x16x16_bf16 v[48:51], v[76:77], v[4:5], 0
  v_mfma_f32_16x16x16_bf16 v[52:55], v[78:79], v[4:5], 0
  s_waitcnt lgkmcnt(4)
  v_smfmac_f32_16x16x64_bf16 v[56:59], v[68:71], v[192:199], v1
  ds_read_b128 v[68:71], v7 offset:6144
  s_waitcnt lgkmcnt(4)
  v_smfmac_f32_16x16x64_bf16 v[56:59], v[72:75], v[200:207], v1
  ds_read_b128 v[72:75], v7 offset:7168
  s_mov_b64 exec, s[70:71]
  v_cvt_pk_bf16_f32 v24, v48, v49
  v_cvt_pk_bf16_f32 v25, v50, v51
  v_cvt_pk_bf16_f32 v26, v52, v53
  v_cvt_pk_bf16_f32 v27, v54, v55
  s_mov_b64 exec, -1
  s_nop 1
  v_mfma_f32_16x16x32_bf16 v[92:95], v[24:27], v[80:83], v[92:95]
  s_waitcnt lgkmcnt(4)
  v_smfmac_f32_16x16x64_bf16 v[56:59], v[60:63], v[208:215], v1
  ds_read_b128 v[60:63], v7 offset:8192
  s_waitcnt lgkmcnt(4)
  v_smfmac_f32_16x16x64_bf16 v[56:59], v[64:67], v[216:223], v1
  ds_read_b128 v[64:67], v7 offset:9216
  s_nop 1
  ds_write_b128 v102, v[92:95]
  s_waitcnt lgkmcnt(0)
  s_cmp_eq_u32 s39, 63
  s_cbranch_scc1 CHs_last
  s_barrier
  v_xor_b32 v76, 2048, v102
  v_xor_b32 v77, 4096, v102
  v_xor_b32 v78, 6144, v102
  ds_read_b128 v[40:43], v76
  ds_read_b128 v[44:47], v76 offset:1024
  ds_read_b128 v[48:51], v77
  ds_read_b128 v[52:55], v77 offset:1024
  ds_read_b128 v[80:83], v78
  ds_read_b128 v[84:87], v78 offset:1024
  v_smfmac_f32_16x16x64_bf16 v[56:59], v[68:71], v[224:231], v1
  v_smfmac_f32_16x16x64_bf16 v[56:59], v[72:75], v[232:239], v1
  v_smfmac_f32_16x16x64_bf16 v[56:59], v[60:63], v[240:247], v1
  v_smfmac_f32_16x16x64_bf16 v[56:59], v[64:67], v[248:255], v1
  s_waitcnt lgkmcnt(5)
  v_pk_add_f32 v[92:93], v[92:93], v[40:41]
  v_pk_add_f32 v[94:95], v[94:95], v[42:43]
  s_waitcnt lgkmcnt(4)
  v_pk_add_f32 v[88:89], v[88:89], v[44:45]
  v_pk_add_f32 v[90:91], v[90:91], v[46:47]
  s_waitcnt lgkmcnt(3)
  v_pk_add_f32 v[92:93], v[92:93], v[48:49]
  v_pk_add_f32 v[94:95], v[94:95], v[50:51]
  s_waitcnt lgkmcnt(2)
  v_pk_add_f32 v[88:89], v[88:89], v[52:53]
  v_pk_add_f32 v[90:91], v[90:91], v[54:55]
  s_waitcnt lgkmcnt(1)
  v_pk_add_f32 v[92:93], v[92:93], v[80:81]
  v_pk_add_f32 v[94:95], v[94:95], v[82:83]
  s_waitcnt lgkmcnt(0)
  v_pk_add_f32 v[88:89], v[88:89], v[84:85]
  v_pk_add_f32 v[90:91], v[90:91], v[86:87]
  v_max3_f32 v76, v92, v93, v94
  v_max3_f32 v77, v88, v89, v90
  v_max_f32 v76, v76, v95
  v_max_f32 v77, v77, v91
  v_add_f32 v76, v76, v109
  v_add_f32 v77, v77, v110
  v_max_f32 v76, v76, v77
  v_pk_add_f32 v[56:57], v[56:57], v[58:59]
  v_mov_b32 v40, 0
  v_max_f32_dpp v76, v76, v76 quad_perm:[2,3,0,1] row_mask:0xf bank_mask:0xf
  v_cvt_pk_bf16_f32 v16, v56, v57
  v_mov_b32 v77, v76
  v_mov_b32 v41, 0
  v_mov_b32 v42, 0
  v_permlane16_swap_b32 v76, v77
  v_max_f32 v76, v76, v77
  v_mov_b32 v77, v76
  v_mov_b32 v43, 0
  v_mov_b32 v44, 0
  v_permlane32_swap_b32 v76, v77
  v_max_f32 v76, v76, v77
  v_mul_f32 v76, s54, v76
  v_sub_f32 v80, v109, v76
  v_sub_f32 v82, v110, v76
  v_pk_fma_f32 v[92:93], v[92:93], s[54:55], v[80:81] op_sel_hi:[1,0,0]
  v_pk_fma_f32 v[94:95], v[94:95], s[54:55], v[80:81] op_sel_hi:[1,0,0]
  v_pk_fma_f32 v[88:89], v[88:89], s[54:55], v[82:83] op_sel_hi:[1,0,0]
  v_pk_fma_f32 v[90:91], v[90:91], s[54:55], v[82:83] op_sel_hi:[1,0,0]
  v_exp_f32 v92, v92
  v_exp_f32 v93, v93
  v_exp_f32 v94, v94
  v_exp_f32 v95, v95
  v_exp_f32 v88, v88
  v_exp_f32 v89, v89
  v_cvt_pk_bf16_f32 v76, v92, v93
  v_exp_f32 v90, v90
  v_cvt_pk_bf16_f32 v78, v94, v95
  v_exp_f32 v91, v91
  v_cvt_pk_bf16_f32 v77, v88, v89
  v_mov_b32 v45, 0
  v_mov_b32 v46, 0
  v_cvt_pk_bf16_f32 v79, v90, v91
  v_mov_b32 v47, 0
  v_mov_b32 v108, v16
  v_smfmac_f32_16x16x64_bf16 v[40:43], v[76:79], v[16:23], v1
  v_smfmac_f32_16x16x64_bf16 v[44:47], v[76:79], v[8:15], v1
  v_add_u32 v111, s86, v102
  s_nop 5
  v_pk_add_f32 v[40:41], v[40:41], v[42:43]
  v_pk_add_f32 v[44:45], v[44:45], v[46:47]
  v_rcp_f32 v44, v44
  v_rcp_f32 v45, v45
  s_nop 0
  v_pk_mul_f32 v[40:41], v[40:41], v[44:45]
  v_cvt_pk_bf16_f32 v40, v40, v41
  s_nop 1
  v_mov_b32_dpp v41, v40 quad_perm:[1,0,3,2] row_mask:0xf bank_mask:0xf
  v_perm_b32 v40, v41, v40, v6
  v_min_u32 v40, -2, v40
  buffer_store_dword v40, v100, s[4:7], s44 offen sc1
  s_sleep 1
  buffer_load_dwordx4 v[84:87], v101, s[4:7], s45 offen sc1
  buffer_load_dwordx4 v[88:91], v101, s[4:7], s45 offen offset:1024 sc1
  ds_read_b128 v[60:63], v111 offset:0
  ds_read_b128 v[64:67], v111 offset:1024
  ds_read_b128 v[68:71], v111 offset:10240
  ds_read_b128 v[72:75], v111 offset:11264
  ds_read_b128 v[32:35], v111 offset:2048
  ds_read_b128 v[36:39], v111 offset:3072
  ds_read_b128 v[16:19], v111 offset:12288
  ds_read_b128 v[20:23], v111 offset:13312
  v_mov_b64 v[40:41], 0
  v_mov_b64 v[42:43], 0
  v_mov_b64 v[44:45], 0
  v_mov_b64 v[46:47], 0
  v_mov_b64 v[48:49], 0
  v_mov_b64 v[50:51], 0
  v_mov_b64 v[52:53], 0
  v_mov_b64 v[54:55], 0
  v_mov_b64 v[56:57], 0
  v_mov_b64 v[58:59], 0
  v_lshrrev_b32 v95, 4, v0
  v_bfe_u32 v94, v0, 2, 1
  v_lshlrev_b32 v94, 1, v94
  v_xor_b32 v95, v95, v94
  v_and_b32 v94, 15, v0
  v_lshlrev_b32 v94, 5, v94
  v_lshl_add_u32 v94, v95, 3, v94
  v_add_u32 v94, s99, v94
  buffer_load_dwordx4 v[76:79], v101, s[4:7], s45 offen sc1
  buffer_load_dwordx4 v[80:83], v101, s[4:7], s45 offen offset:1024 sc1
  s_mov_b32 s59, 0
  s_waitcnt vmcnt(2)
  v_max3_u32 v92, v84, v85, v86
  v_max3_u32 v93, v87, v88, v89
  v_max3_u32 v92, v92, v90, v91
  v_max_u32 v92, v92, v93
  v_cmp_eq_u32 vcc, -1, v92
  s_cbranch_vccz CHs_og_s0
  buffer_load_dwordx4 v[84:87], v101, s[4:7], s45 offen sc1
  buffer_load_dwordx4 v[88:91], v101, s[4:7], s45 offen offset:1024 sc1
  s_branch CHs_og_l1
CHs_og_l0:
  s_waitcnt vmcnt(2)
  v_max3_u32 v92, v84, v85, v86
  v_max3_u32 v93, v87, v88, v89
  v_max3_u32 v92, v92, v90, v91
  v_max_u32 v92, v92, v93
  v_cmp_eq_u32 vcc, -1, v92
  s_cbranch_vccz CHs_og_s0
  buffer_load_dwordx4 v[84:87], v101, s[4:7], s45 offen sc1
  buffer_load_dwordx4 v[88:91], v101, s[4:7], s45 offen offset:1024 sc1
CHs_og_l1:
  s_waitcnt vmcnt(2)
  v_max3_u32 v92, v76, v77, v78
  v_max3_u32 v93, v79, v80, v81
  v_max3_u32 v92, v92, v82, v83
  v_max_u32 v92, v92, v93
  v_cmp_eq_u32 vcc, -1, v92
  s_cbranch_vccz CHs_og_s1
  buffer_load_dwordx4 v[76:79], v101, s[4:7], s45 offen sc1
  buffer_load_dwordx4 v[80:83], v101, s[4:7], s45 offen offset:1024 sc1
  s_add_u32 s59, s59, 1
  s_cmp_lt_u32 s59, s56
  s_cbranch_scc1 CHs_og_l0
  s_mov_b32 s56, 0
  s_waitcnt vmcnt(0)
CHs_og_s1:
  v_mov_b64 v[84:85], v[76:77]
  v_mov_b64 v[86:87], v[78:79]
  v_mov_b64 v[88:89], v[80:81]
  v_mov_b64 v[90:91], v[82:83]
  s_branch CHs_og_done
CHs_og_s0:
CHs_og_done:
  s_waitcnt lgkmcnt(6)
  v_smfmac_f32_16x16x64_bf16 v[40:43], v[84:87], v[60:67], v1
  ds_read_b128 v[60:63], v111 offset:4096
  ds_read_b128 v[64:67], v111 offset:5120
  s_waitcnt lgkmcnt(6)
  v_smfmac_f32_16x16x64_bf16 v[40:43], v[88:91], v[68:75], v1
  ds_read_b128 v[68:71], v111 offset:14336
  ds_read_b128 v[72:75], v111 offset:15360
  s_waitcnt lgkmcnt(6)
  v_smfmac_f32_16x16x64_bf16 v[44:47], v[84:87], v[32:39], v1
  ds_read_b128 v[32:35], v111 offset:6144
  ds_read_b128 v[36:39], v111 offset:7168
  s_waitcnt lgkmcnt(6)
  v_smfmac_f32_16x16x64_bf16 v[44:47], v[88:91], v[16:23], v1
  ds_read_b128 v[16:19], v111 offset:16384
  ds_read_b128 v[20:23], v111 offset:17408
  s_waitcnt lgkmcnt(6)
  v_smfmac_f32_16x16x64_bf16 v[48:51], v[84:87], v[60:67], v1
  ds_read_b128 v[60:63], v111 offset:8192
  ds_read_b128 v[64:67], v111 offset:9216
  s_waitcnt lgkmcnt(6)
  v_smfmac_f32_16x16x64_bf16 v[48:51], v[88:91], v[68:75], v1
  ds_read_b128 v[68:71], v111 offset:18432
  ds_read_b128 v[72:75], v111 offset:19456
  v_pk_add_f32 v[40:41], v[40:41], v[42:43]
  ds_write_b64 v94, v[40:41] offset:0
  s_waitcnt lgkmcnt(7)
  v_smfmac_f32_16x16x64_bf16 v[52:55], v[84:87], v[32:39], v1
  s_waitcnt lgkmcnt(5)
  v_smfmac_f32_16x16x64_bf16 v[52:55], v[88:91], v[16:23], v1
  v_pk_add_f32 v[44:45], v[44:45], v[46:47]
  ds_write_b64 v94, v[44:45] offset:512
  s_waitcnt lgkmcnt(4)
  v_smfmac_f32_16x16x64_bf16 v[56:59], v[84:87], v[60:67], v1
  s_waitcnt lgkmcnt(2)
  v_smfmac_f32_16x16x64_bf16 v[56:59], v[88:91], v[68:75], v1
  v_pk_add_f32 v[48:49], v[48:49], v[50:51]
  ds_write_b64 v94, v[48:49] offset:1024
  v_pk_add_f32 v[52:53], v[52:53], v[54:55]
  ds_write_b64 v94, v[52:53] offset:1536
  v_mov_b32 v17, 0
  v_mov_b32 v18, 0
  v_mov_b32 v19, 0
  s_nop 0
  v_pk_add_f32 v[56:57], v[56:57], v[58:59]
  ds_write_b64 v94, v[56:57] offset:2048
  v_lshlrev_b32 v111, 4, v0
  v_add_u32 v111, s76, v111
  s_waitcnt vmcnt(0) lgkmcnt(0)
  s_barrier
  s_mov_b64 exec, s[68:69]
  ds_read_b128 v[76:79], v111 offset:8192
  ds_read_b128 v[80:83], v111 offset:10752
  ds_read_b128 v[84:87], v111 offset:13312
  ds_read_b128 v[88:91], v111 offset:15872
  s_waitcnt lgkmcnt(2)
  v_pk_add_f32 v[76:77], v[76:77], v[80:81]
  v_pk_add_f32 v[78:79], v[78:79], v[82:83]
  s_waitcnt lgkmcnt(0)
  v_pk_add_f32 v[84:85], v[84:85], v[88:89]
  v_pk_add_f32 v[86:87], v[86:87], v[90:91]
  v_pk_add_f32 v[76:77], v[76:77], v[84:85]
  v_pk_add_f32 v[78:79], v[78:79], v[86:87]
  v_cvt_pk_bf16_f32 v76, v76, v77
  v_cvt_pk_bf16_f32 v77, v78, v79
  v_min_u32 v76, -2, v76
  v_min_u32 v77, -2, v77
  buffer_store_dwordx2 v[76:77], v107, s[4:7], s47 offen sc1
  s_mov_b64 exec, -1
  s_cmp_eq_u32 s32, 3
  s_cbranch_scc0 CHs_notw3
  s_add_u32 s40, s40, 8192
  s_add_u32 s41, s41, 8192
  v_and_b32 v84, 15, v0
  v_lshlrev_b32 v84, 8, v84
  v_lshrrev_b32 v85, 4, v0
  v_lshl_add_u32 v84, v85, 4, v84
  s_lshl_b32 s89, s32, 6
  v_add_u32 v84, s89, v84
  s_mov_b64 exec, s[80:81]
  buffer_store_dwordx4 v[24:27], v84, s[4:7], s42 offen sc1
  s_mov_b64 exec, -1
  buffer_store_dword v108, v104, s[4:7], s43 offen sc1
  s_add_u32 s65, s39, 1
  s_cmp_lt_u32 s65, s77
  s_cbranch_scc1 CHs_kvok
  s_min_u32 s65, s65, 63
  s_lshr_b32 s89, s35, 1
  v_lshlrev_b32 v76, 5, v0
  v_add_u32 v76, s89, v76
  v_lshlrev_b32 v76, 2, v76
  s_lshr_b32 s89, s65, 4
  v_add_u32 v76, s89, v76
  v_lshlrev_b32 v76, 7, v76
  v_add_u32 v76, 1835008, v76
  s_and_b32 s89, s65, 15
  s_add_u32 s89, s89, 1
  s_add_u32 s89, s89, s3
  s_mov_b32 s59, 0
  s_mov_b64 exec, 3
CHs_kvw_w:
  buffer_load_dword v77, v76, s[4:7], 0 offen sc1
  s_waitcnt vmcnt(0)
  v_subrev_u32 v78, s89, v77
  v_cmp_lt_u32 vcc, 0x7f, v78
  s_cbranch_vccz CHs_kvw_d
  s_sleep 1
  s_add_u32 s59, s59, 2
  s_cmp_lt_u32 s59, s56
  s_cbranch_scc1 CHs_kvw_w
  s_mov_b32 s56, 0
CHs_kvw_d:
  s_mov_b64 exec, -1
  v_readlane_b32 s89, v77, 0
  v_readlane_b32 s77, v77, 1
  s_min_u32 s77, s77, s89
  s_sub_u32 s77, s77, s3
  s_min_u32 s77, s77, 16
  s_and_b32 s89, s65, 0x30
  s_add_u32 s77, s77, s89
CHs_kvok:
  v_xor_b32 v80, 32, v96
  s_mov_b32 m0, 111616
  s_add_u32 s89, s40, 0
  buffer_load_dwordx4 v96, s[4:7], s89 offen sc1 lds
  s_mov_b32 m0, 112640
  s_add_u32 s89, s40, 4096
  buffer_load_dwordx4 v80, s[4:7], s89 offen sc1 lds
  s_mov_b32 m0, 113664
  s_add_u32 s89, s41, 0
  buffer_load_dwordx4 v97, s[4:7], s89 offen sc1 lds
  s_mov_b32 m0, 114688
  s_add_u32 s89, s40, 64
  buffer_load_dwordx4 v96, s[4:7], s89 offen sc1 lds
  s_mov_b32 m0, 115712
  s_add_u32 s89, s40, 4160
  buffer_load_dwordx4 v80, s[4:7], s89 offen sc1 lds
  s_mov_b32 m0, 116736
  s_add_u32 s89, s41, 1024
  buffer_load_dwordx4 v97, s[4:7], s89 offen sc1 lds
  s_mov_b32 m0, 117760
  s_add_u32 s89, s40, 128
  buffer_load_dwordx4 v96, s[4:7], s89 offen sc1 lds
  s_mov_b32 m0, 118784
  s_add_u32 s89, s40, 4224
  buffer_load_dwordx4 v80, s[4:7], s89 offen sc1 lds
  s_mov_b32 m0, 119808
  s_add_u32 s89, s41, 2048
  buffer_load_dwordx4 v97, s[4:7], s89 offen sc1 lds
  s_mov_b32 m0, 120832
  s_add_u32 s89, s40, 192
  buffer_load_dwordx4 v96, s[4:7], s89 offen sc1 lds
  s_mov_b32 m0, 121856
  s_add_u32 s89, s40, 4288
  buffer_load_dwordx4 v80, s[4:7], s89 offen sc1 lds
  s_mov_b32 m0, 122880
  s_add_u32 s89, s41, 3072
  buffer_load_dwordx4 v97, s[4:7], s89 offen sc1 lds
  s_add_u32 s42, s42, 65536
  s_add_u32 s43, s43, 65536
  v_mov_b64 v[40:41], 0
  v_mov_b64 v[42:43], 0
  v_mov_b64 v[44:45], 0
  v_mov_b64 v[46:47], 0
  v_mov_b64 v[48:49], 0
  v_mov_b64 v[50:51], 0
  v_mov_b64 v[52:53], 0
  v_mov_b64 v[54:55], 0
  v_mov_b64 v[56:57], 0
  v_mov_b64 v[58:59], 0
  s_add_u32 s39, s39, 1
  s_mov_b32 s62, s44
  s_mov_b32 s44, s46
  s_mov_b32 s46, s62
  s_xor_b32 s45, s45, 0x8000
  s_add_u32 s72, s72, 1
  s_cmp_eq_u32 s72, 3
  s_cselect_b32 s72, 0, s72
  s_add_u32 s62, s72, 1
  s_cmp_eq_u32 s62, 3
  s_cselect_b32 s62, 0, s62
  s_add_u32 s63, s62, 1
  s_cmp_eq_u32 s63, 3
  s_cselect_b32 s63, 0, s63
  s_lshl_b32 s101, s72, 18
  s_add_u32 s47, s53, s101
  s_add_u32 s48, s73, s101
  s_lshl_b32 s101, s62, 18
  s_add_u32 s101, s101, s53
  s_lshl_b32 s62, s62, 14
  s_lshl_b32 s63, s63, 14
  s_add_u32 s50, s84, s62
  s_add_u32 s88, s49, s62
  s_add_u32 s51, s49, s63
  s_waitcnt vmcnt(0)
  s_branch CHs_mdone
CHs_notw3:
  s_mov_b32 s78, s48
  s_add_u32 s79, s48, 131072
  s_mov_b32 s65, s88
  s_add_u32 s12, s100, 18432
  s_add_u32 s8, s100, s50
  s_add_u32 s13, s100, 21504
  s_add_u32 s9, s100, s50
  s_add_u32 s9, s9, 3072
  s_add_u32 s14, s100, 24576
  s_add_u32 s10, s100, s50
  s_add_u32 s10, s10, 6144
  s_cmp_eq_u32 s32, 0
  s_cselect_b32 s89, 9216, 0
  s_add_u32 s15, s12, s89
  s_add_u32 s11, s8, s89
  v_mov_b64 v[40:41], 0
  v_mov_b64 v[42:43], 0
  v_mov_b64 v[44:45], 0
  v_mov_b64 v[46:47], 0
  v_mov_b64 v[48:49], 0
  v_mov_b64 v[50:51], 0
  v_mov_b64 v[52:53], 0
  v_mov_b64 v[54:55], 0
  v_mov_b64 v[56:57], 0
  v_mov_b64 v[58:59], 0
  s_cmp_eq_u32 s52, 0
  s_cbranch_scc1 CHs_nored
  s_sleep 5
  buffer_load_dwordx4 v[60:63], v105, s[4:7], s78 offen sc1
  buffer_load_dwordx4 v[64:67], v105, s[4:7], s79 offen sc1
  s_add_u32 s39, s39, 1
  s_mov_b32 s62, s44
  s_mov_b32 s44, s46
  s_mov_b32 s46, s62
  s_xor_b32 s45, s45, 0x8000
  s_add_u32 s72, s72, 1
  s_cmp_eq_u32 s72, 3
  s_cselect_b32 s72, 0, s72
  s_add_u32 s62, s72, 1
  s_cmp_eq_u32 s62, 3
  s_cselect_b32 s62, 0, s62
  s_add_u32 s63, s62, 1
  s_cmp_eq_u32 s63, 3
  s_cselect_b32 s63, 0, s63
  s_lshl_b32 s101, s72, 18
  s_add_u32 s47, s53, s101
  s_add_u32 s48, s73, s101
  s_lshl_b32 s101, s62, 18
  s_add_u32 s101, s101, s53
  s_lshl_b32 s62, s62, 14
  s_lshl_b32 s63, s63, 14
  s_add_u32 s50, s84, s62
  s_add_u32 s88, s49, s62
  s_add_u32 s51, s49, s63
  v_and_b32 v94, 15, v0
  v_lshlrev_b32 v94, 8, v94
  v_lshrrev_b32 v95, 4, v0
  v_lshl_add_u32 v94, v95, 4, v94
  s_lshl_b32 s89, s32, 6
  v_add_u32 v94, s89, v94
  s_mov_b64 exec, s[80:81]
  buffer_store_dwordx4 v[24:27], v94, s[4:7], s42 offen sc1
  s_mov_b64 exec, -1
  buffer_store_dword v108, v104, s[4:7], s43 offen sc1
  s_add_u32 s42, s42, 65536
  s_add_u32 s43, s43, 65536
  s_mov_b32 s59, 0
  s_waitcnt vmcnt(2)
  v_mfma_f32_16x16x32_bf16 v[68:71], v[60:63], v[96:99], 0
  v_mfma_f32_16x16x32_bf16 v[68:71], v[64:67], v[96:99], v[68:71]
  v_max3_u32 v92, v60, v61, v62
  v_max3_u32 v93, v63, v64, v65
  v_max3_u32 v92, v92, v66, v67
  v_max_u32 v92, v92, v93
  v_cmp_eq_u32 vcc, -1, v92
  s_cbranch_vccz CHs_pg_s0
  buffer_load_dwordx4 v[60:63], v105, s[4:7], s78 offen sc1
  buffer_load_dwordx4 v[64:67], v105, s[4:7], s79 offen sc1
  s_branch CHs_pg_l1
CHs_pg_l0:
  s_waitcnt vmcnt(0)
  v_mfma_f32_16x16x32_bf16 v[68:71], v[60:63], v[96:99], 0
  v_mfma_f32_16x16x32_bf16 v[68:71], v[64:67], v[96:99], v[68:71]
  v_max3_u32 v92, v60, v61, v62
  v_max3_u32 v93, v63, v64, v65
  v_max3_u32 v92, v92, v66, v67
  v_max_u32 v92, v92, v93
  v_cmp_eq_u32 vcc, -1, v92
  s_cbranch_vccz CHs_pg_s0
  buffer_load_dwordx4 v[60:63], v105, s[4:7], s78 offen sc1
  buffer_load_dwordx4 v[64:67], v105, s[4:7], s79 offen sc1
CHs_pg_l1:
  s_add_u32 s59, s59, 1
  s_cmp_lt_u32 s59, s56
  s_cbranch_scc1 CHs_pg_l0
  s_mov_b32 s56, 0
  s_waitcnt vmcnt(0)
CHs_pg_s0:
  s_nop 1
CHs_pg_done:
  v_cvt_pk_bf16_f32 v68, v68, v69
  v_cvt_pk_bf16_f32 v69, v70, v71
  v_min_u32 v68, -2, v68
  v_min_u32 v69, -2, v69
  s_mov_b64 exec, s[70:71]
  buffer_store_dwordx2 v[68:69], v106, s[4:7], s65 offen sc1
  s_mov_b64 exec, -1
  s_sleep 3
  s_branch CHs_mjoin
CHs_nored:
  s_add_u32 s39, s39, 1
  s_mov_b32 s62, s44
  s_mov_b32 s44, s46
  s_mov_b32 s46, s62
  s_xor_b32 s45, s45, 0x8000
  s_add_u32 s72, s72, 1
  s_cmp_eq_u32 s72, 3
  s_cselect_b32 s72, 0, s72
  s_add_u32 s62, s72, 1
  s_cmp_eq_u32 s62, 3
  s_cselect_b32 s62, 0, s62
  s_add_u32 s63, s62, 1
  s_cmp_eq_u32 s63, 3
  s_cselect_b32 s63, 0, s63
  s_lshl_b32 s101, s72, 18
  s_add_u32 s47, s53, s101
  s_add_u32 s48, s73, s101
  s_lshl_b32 s101, s62, 18
  s_add_u32 s101, s101, s53
  s_lshl_b32 s62, s62, 14
  s_lshl_b32 s63, s63, 14
  s_add_u32 s50, s84, s62
  s_add_u32 s88, s49, s62
  s_add_u32 s51, s49, s63
  v_and_b32 v94, 15, v0
  v_lshlrev_b32 v94, 8, v94
  v_lshrrev_b32 v95, 4, v0
  v_lshl_add_u32 v94, v95, 4, v94
  s_lshl_b32 s89, s32, 6
  v_add_u32 v94, s89, v94
  s_mov_b64 exec, s[80:81]
  buffer_store_dwordx4 v[24:27], v94, s[4:7], s42 offen sc1
  s_mov_b64 exec, -1
  buffer_store_dword v108, v104, s[4:7], s43 offen sc1
  s_add_u32 s42, s42, 65536
  s_add_u32 s43, s43, 65536
  s_sleep 14
CHs_mjoin:
  s_mov_b32 s59, 0
  s_mov_b32 m0, s12
  s_nop 0
  buffer_load_dwordx4 v101, s[4:7], s8 offen sc1 lds
  s_mov_b32 m0, s13
  s_nop 0
  buffer_load_dwordx4 v101, s[4:7], s9 offen sc1 lds
  s_mov_b32 m0, s14
  s_nop 0
  buffer_load_dwordx4 v101, s[4:7], s10 offen sc1 lds
  s_mov_b32 m0, s15
  s_nop 0
  buffer_load_dwordx4 v101, s[4:7], s11 offen sc1 lds
  v_lshlrev_b32 v93, 4, v0
  v_add_u32 v92, s12, v93
  v_add_u32 v93, s15, v93
  s_sleep 3
CHs_mg_poll:
  s_mov_b32 m0, s12
  s_nop 0
  buffer_load_dwordx4 v101, s[4:7], s8 offen sc1 lds
  s_mov_b32 m0, s13
  s_nop 0
  buffer_load_dwordx4 v101, s[4:7], s9 offen sc1 lds
  s_mov_b32 m0, s14
  s_nop 0
  buffer_load_dwordx4 v101, s[4:7], s10 offen sc1 lds
  s_mov_b32 m0, s15
  s_nop 0
  buffer_load_dwordx4 v101, s[4:7], s11 offen sc1 lds
  s_waitcnt vmcnt(4)
  ds_read_b128 v[76:79], v92 offset:0
  ds_read_b128 v[80:83], v92 offset:3072
  ds_read_b128 v[84:87], v92 offset:6144
  ds_read_b128 v[88:91], v93
  s_waitcnt lgkmcnt(2)
  v_max3_u32 v94, v76, v77, v78
  v_max3_u32 v95, v79, v80, v81
  v_max3_u32 v94, v94, v82, v83
  s_waitcnt lgkmcnt(0)
  v_max3_u32 v95, v95, v84, v85
  v_max3_u32 v94, v94, v86, v87
  v_max3_u32 v95, v95, v88, v89
  v_max3_u32 v94, v94, v90, v91
  v_max_u32 v94, v94, v95
  v_cmp_eq_u32 vcc, -1, v94
  s_cbranch_vccz CHs_mdone
  s_add_u32 s59, s59, 1
  s_cmp_lt_u32 s59, s56
  s_cbranch_scc1 CHs_mg_poll
  s_mov_b32 s56, 0
CHs_mdone:
  s_barrier
  s_branch CHs_step
CHs_last:
  s_waitcnt lgkmcnt(0)
  v_smfmac_f32_16x16x64_bf16 v[56:59], v[68:71], v[224:231], v1
  v_smfmac_f32_16x16x64_bf16 v[56:59], v[72:75], v[232:239], v1
  v_smfmac_f32_16x16x64_bf16 v[56:59], v[60:63], v[240:247], v1
  v_smfmac_f32_16x16x64_bf16 v[56:59], v[64:67], v[248:255], v1
  s_nop 7
  v_pk_add_f32 v[56:57], v[56:57], v[58:59]
  v_cvt_pk_bf16_f32 v108, v56, v57
  v_and_b32 v80, 15, v0
  v_lshlrev_b32 v80, 8, v80
  v_lshrrev_b32 v81, 4, v0
  v_lshl_add_u32 v80, v81, 4, v80
  s_lshl_b32 s89, s32, 6
  v_add_u32 v80, s89, v80
  s_mov_b64 exec, s[80:81]
  buffer_store_dwordx4 v[24:27], v80, s[4:7], s42 offen sc1
  s_mov_b64 exec, -1
  buffer_store_dword v108, v104, s[4:7], s43 offen sc1
  s_waitcnt vmcnt(0)
CH_join:
  s_barrier
  s_cmp_eq_u32 s32, 3
  s_cbranch_scc0 CH_end
  s_mov_b32 s89, 64
  v_mov_b32 v80, s89
  v_add_u32 v80, s3, v80
  v_mov_b32 v81, 0
  s_mov_b64 exec, 1
  buffer_store_dword v80, v81, s[4:7], s85 offen sc1
  s_mov_b64 exec, -1
  s_waitcnt vmcnt(0)
CH_end:
K_fin:
  s_cmp_eq_u32 s56, 0
  s_cbranch_scc0 K_noab
  v_mov_b32 v4, 1
  v_mov_b32 v5, 4
  s_mov_b64 exec, 1
  buffer_atomic_add v4, v5, s[24:27], 0 offen
  s_lshl_b32 s60, s33, 8
  s_add_u32 s60, s60, s34
  v_mov_b32 v4, s60
  v_mov_b32 v5, 8
  buffer_store_dword v4, v5, s[24:27], 0 offen
  s_mov_b64 exec, -1
K_noab:
K_end:
  s_endpgm

.section .rodata,"a"
.p2align 6
.amdhsa_kernel gated_mix__memory_aug_recurrent_mem_tr__sliding_block__prompt_kernel
  .amdhsa_next_free_vgpr 512
  .amdhsa_next_free_sgpr 102
  .amdhsa_accum_offset 256
  .amdhsa_group_segment_fixed_size 0
  .amdhsa_kernarg_size 112
  .amdhsa_user_sgpr_count 2
  .amdhsa_user_sgpr_kernarg_segment_ptr 1
  .amdhsa_system_sgpr_workgroup_id_x 1
.end_amdhsa_kernel
```
